```python
import torch

def _softmax(x, axis=-1):
    return torch.softmax(x, dim=axis)
def _gelu(x):
    return torch.nn.functional.gelu(x, approximate="tanh")
def _silu(x):
    return torch.nn.functional.silu(x)
def _sigmoid(x):
    return torch.sigmoid(x)
def _layernorm(x, axis=-1, eps=1e-5):
    m = x.mean(dim=axis, keepdim=True)
    v = x.var(dim=axis, keepdim=True, unbiased=False)
    return (x - m) / torch.sqrt(v + eps)
def _scatter_add(tgt, idx, src, axis=0):
    return tgt.clone().index_add_(axis, idx, src)
def _segment_sum(src, seg, n):
    out = torch.zeros((n,) + src.shape[1:], dtype=src.dtype)
    return out.index_add_(0, seg, src)
def _pad(x, pw):
    flat = tuple(v for pair in reversed(pw) for v in pair)
    return torch.nn.functional.pad(x, flat)

kernel_name = 'gated_mix__softmax_full_mha__glu_gated_glu__prompt'

def setup_inputs():

    _w = (lambda a: (lambda t: t.to(torch.bfloat16) if t.is_floating_point() else t)(torch.as_tensor(a)))
    def _A_setup():
        B, S, D = 1, 2048, 640
        return {
            "x": _w((lambda *s: torch.randn(*s, dtype=torch.bfloat16) * 0.05)(B, S, D)),
            "wqkv": _w((lambda *s: torch.randn(*s, dtype=torch.bfloat16) * 0.8)(D, 3 * D)),
            "wo": _w((lambda *s: torch.randn(*s, dtype=torch.bfloat16) * 0.1)(D, D)),
        }
    _A_in = _A_setup()

    def _B_setup():
        B, S, D, F = 1, 2048, 640, 1728
        return {
            "x": _w((lambda *s: torch.randn(*s, dtype=torch.bfloat16) * 0.05)(B, S, D)),
            "w_gate": _w((lambda *s: torch.randn(*s, dtype=torch.bfloat16) * 0.8)(D, F)),
            "w_up": _w((lambda *s: torch.randn(*s, dtype=torch.bfloat16) * 0.05)(D, F)),
            "w_down": _w((lambda *s: torch.randn(*s, dtype=torch.bfloat16) * 0.05)(F, D)),
        }
    _B_in = _B_setup()

    return {
        "A_x": _A_in["x"],
        "A_wqkv": _A_in["wqkv"],
        "A_wo": _A_in["wo"],
        "B_x": _B_in["x"],
        "B_w_gate": _B_in["w_gate"],
        "B_w_up": _B_in["w_up"],
        "B_w_down": _B_in["w_down"],
        "gate_w": _w((lambda *s: torch.randn(*s, dtype=torch.bfloat16) * 0.05)(640) * 16.0),
    }

def reference(A_x, A_wqkv, A_wo, B_x, B_w_gate, B_w_up, B_w_down, gate_w):
    def _A_ref(x, wqkv, wo):
        B, S, D = x.shape
        H = 32; Dh = D // H
        qkv = (lambda x, *d: x.permute(*d))((x @ wqkv).reshape(B, S, 3, H, Dh), 2, 0, 3, 1, 4)
        q, k, v = qkv[0], qkv[1], qkv[2]
        scale = Dh ** -0.5
        scores = torch.einsum("bhqd,bhkd->bhqk", q, k) * scale
        p = _softmax(scores, axis=-1)
        o = torch.einsum("bhqk,bhkd->bhqd", p, v)
        return (lambda x, *d: x.permute(*d))(o, 0, 2, 1, 3).reshape(B, S, D) @ wo

    def _B_ref(x, w_gate, w_up, w_down):
        g = torch.einsum("bsd,df->bsf", x, w_gate)
        u = torch.einsum("bsd,df->bsf", x, w_up)
        h = _sigmoid(g) * u
        return torch.einsum("bsf,fd->bsd", h, w_down)

    x = A_x
    g = _sigmoid((x * gate_w).sum(-1, keepdims=True))
    a = _A_ref(x, A_wqkv, A_wo)
    b = _B_ref(x, B_w_gate, B_w_up, B_w_down)
    return g * a + (1 - g) * b
```

```asm
; @launch grid=(256,1,1) block=(768,1,1) lds=163840
.amdgcn_target "amdgcn-amd-amdhsa--gfx950"
.text
.globl gated_mix__softmax_full_mha__glu_gated_glu__prompt_kernel
.p2align 8
.type gated_mix__softmax_full_mha__glu_gated_glu__prompt_kernel,@function
gated_mix__softmax_full_mha__glu_gated_glu__prompt_kernel:
    s_cmp_ge_u32 s2, 256
    s_cbranch_scc1 gated_mix__softmax_full_mha__glu_gated_glu__prompt_kernel_end
    s_load_dwordx16 s[4:19], s[0:1], 0
    s_load_dwordx2 s[20:21], s[0:1], 80
    s_load_dwordx2 s[22:23], s[0:1], 64
    s_load_dwordx2 s[96:97], s[0:1], 72
    v_lshrrev_b32 v2, 6, v0
    v_and_b32 v1, 63, v0
    v_readfirstlane_b32 s38, v2
    s_and_b32 s36, s2, 7
    s_lshr_b32 s37, s2, 3
    s_and_b32 s42, s36, 1
    s_lshr_b32 s41, s37, 2
    s_lshl_b32 s41, s41, 1
    s_add_u32 s39, s41, s42
    s_mul_i32 s42, s42, 18
    s_add_u32 s42, s42, s37
    s_add_u32 s42, s42, 12
    s_lshr_b32 s41, s42, 2
    s_cmp_lt_u32 s37, 12
    s_cselect_b32 s39, s39, s41
    s_cselect_b32 s41, s37, s42
    s_and_b32 s41, s41, 3
    s_lshr_b32 s40, s36, 1
    s_lshl_b32 s40, s40, 2
    s_add_u32 s40, s40, s41
    s_cmp_ge_u32 s37, 30
    s_cbranch_scc1 gated_mix__softmax_full_mha__glu_gated_glu__prompt_kernel_pre
    s_cmp_lt_u32 s38, 8
    s_cbranch_scc1 gated_mix__softmax_full_mha__glu_gated_glu__prompt_kernel_pre
    s_sub_u32 s54, s38, 8
    v_lshrrev_b32 v2, 3, v1
    v_lshrrev_b32 v3, 4, v1
    v_and_b32 v4, 7, v1
    s_lshl_b32 s41, s40, 2
    s_add_u32 s41, s41, s54
    s_mul_i32 s41, s41, 40960
    v_mul_u32_u24 v5, 1280, v2
    v_xor_b32 v6, v3, v4
    v_add_u32 v5, s41, v5
    v_lshl_add_u32 v10, v6, 4, v5
    v_xor_b32 v11, 64, v10
    v_add_u32 v11, 9216, v11
    s_lshl_b32 s45, s54, 12
    v_and_b32 v3, 1, v3
    s_mov_b32 s44, 20480
    s_cmp_ge_u32 s39, 6
    s_cbranch_scc1 gated_mix__softmax_full_mha__glu_gated_glu__prompt_kernel_ld_gu
    v_mul_u32_u24 v2, 3840, v2
    s_and_b32 s41, s54, 1
    s_lshl_b32 s41, s41, 1
    v_or_b32 v3, s41, v3
    v_lshlrev_b32 v3, 1, v3
    s_lshl_b32 s46, s54, 10
    s_mul_i32 s50, s54, 30720
    s_mul_i32 s41, s39, 640
    s_add_u32 s50, s50, s41
    v_xor_b32 v3, v3, v4
    v_lshl_add_u32 v8, v3, 4, v2
    s_mov_b32 s26, 2621440
    s_mov_b32 s27, 0x00020000
    s_mov_b32 s30, 2457600
    s_mov_b32 s31, 0x00020000
    s_waitcnt lgkmcnt(0)
    s_mov_b64 s[28:29], s[6:7]
    s_mov_b64 s[24:25], s[4:5]
    s_add_u32 m0, s45, 98304
    s_nop 0
    buffer_load_dwordx4 v10, s[24:27], 0 offen offset:0 lds
    buffer_load_dwordx4 v11, s[24:27], 0 offen offset:1024 lds
    s_add_u32 m0, s45, 100352
    s_nop 0
    buffer_load_dwordx4 v10, s[24:27], s44 offen offset:0 lds
    buffer_load_dwordx4 v11, s[24:27], s44 offen offset:1024 lds
    s_add_u32 m0, s46, 0
    s_add_u32 s47, s50, 0
    buffer_load_dwordx4 v8, s[28:31], s47 offen lds
    s_add_u32 m0, s46, 4096
    s_add_u32 s47, s50, 128
    buffer_load_dwordx4 v8, s[28:31], s47 offen lds
    s_add_u32 m0, s46, 8192
    s_add_u32 s47, s50, 256
    buffer_load_dwordx4 v8, s[28:31], s47 offen lds
    s_add_u32 m0, s46, 12288
    s_add_u32 s47, s50, 384
    buffer_load_dwordx4 v8, s[28:31], s47 offen lds
    s_add_u32 m0, s46, 16384
    s_add_u32 s47, s50, 512
    buffer_load_dwordx4 v8, s[28:31], s47 offen lds
    s_add_u32 m0, s46, 24576
    s_add_u32 s47, s50, 122880
    buffer_load_dwordx4 v8, s[28:31], s47 offen lds
    s_add_u32 m0, s46, 28672
    s_add_u32 s47, s50, 123008
    buffer_load_dwordx4 v8, s[28:31], s47 offen lds
    s_add_u32 m0, s46, 32768
    s_add_u32 s47, s50, 123136
    buffer_load_dwordx4 v8, s[28:31], s47 offen lds
    s_add_u32 m0, s46, 36864
    s_add_u32 s47, s50, 123264
    buffer_load_dwordx4 v8, s[28:31], s47 offen lds
    s_add_u32 m0, s46, 40960
    s_add_u32 s47, s50, 123392
    buffer_load_dwordx4 v8, s[28:31], s47 offen lds
    s_add_u32 m0, s45, 130944
    s_nop 0
    buffer_load_dwordx4 v10, s[24:27], 0 offen offset:128 lds
    buffer_load_dwordx4 v11, s[24:27], 0 offen offset:1152 lds
    s_add_u32 m0, s45, 132992
    s_nop 0
    buffer_load_dwordx4 v10, s[24:27], s44 offen offset:128 lds
    buffer_load_dwordx4 v11, s[24:27], s44 offen offset:1152 lds
    s_add_u32 m0, s46, 49152
    s_add_u32 s47, s50, 245760
    buffer_load_dwordx4 v8, s[28:31], s47 offen lds
    s_add_u32 m0, s46, 53248
    s_add_u32 s47, s50, 245888
    buffer_load_dwordx4 v8, s[28:31], s47 offen lds
    s_add_u32 m0, s46, 57344
    s_add_u32 s47, s50, 246016
    buffer_load_dwordx4 v8, s[28:31], s47 offen lds
    s_add_u32 m0, s46, 61440
    s_add_u32 s47, s50, 246144
    buffer_load_dwordx4 v8, s[28:31], s47 offen lds
    s_add_u32 m0, s46, 65536
    s_add_u32 s47, s50, 246272
    buffer_load_dwordx4 v8, s[28:31], s47 offen lds
    s_mov_b32 s32, s20
    s_mov_b32 s33, s21
    s_mov_b32 s34, 268435456
    s_mov_b32 s35, 0x00020000
    v_mul_u32_u24 v2, 13108, v1
    v_lshrrev_b32 v2, 16, v2
    v_mul_u32_u24 v3, 5, v2
    v_sub_u32 v3, v1, v3
    v_lshrrev_b32 v4, 1, v2
    v_mul_u32_u24 v4, 30, v4
    v_add_u32 v2, v2, v4
    v_mul_u32_u24 v2, 3840, v2
    v_lshl_add_u32 v2, v3, 7, v2
    v_cmp_gt_u32 vcc, 20, v1
    s_mul_i32 s41, s40, 7680
    s_mul_i32 s42, s39, 640
    s_add_u32 s41, s41, s42
    v_add_u32 v2, s41, v2
    v_mov_b32 v3, 1073741824
    v_cndmask_b32 v12, v3, v2, vcc
    s_mul_i32 s41, s39, 9
    v_min_u32 v2, 8, v1
    v_add_u32 v2, s41, v2
    v_min_u32 v2, 127, v2
    s_lshl_b32 s41, s40, 7
    v_add_u32 v2, s41, v2
    v_mul_u32_u24 v13, 1280, v2
    s_mov_b32 s43, 1073741824
    s_waitcnt vmcnt(14)
    s_barrier
    s_add_u32 m0, s46, 73728
    s_add_u32 s47, s50, 368640
    buffer_load_dwordx4 v8, s[28:31], s47 offen lds
    s_add_u32 m0, s46, 77824
    s_add_u32 s47, s50, 368768
    buffer_load_dwordx4 v8, s[28:31], s47 offen lds
    s_add_u32 m0, s46, 81920
    s_add_u32 s47, s50, 368896
    buffer_load_dwordx4 v8, s[28:31], s47 offen lds
    s_add_u32 m0, s46, 86016
    s_add_u32 s47, s50, 369024
    buffer_load_dwordx4 v8, s[28:31], s47 offen lds
    s_add_u32 m0, s46, 90112
    s_add_u32 s47, s50, 369152
    buffer_load_dwordx4 v8, s[28:31], s47 offen lds
    s_add_u32 m0, s45, 114432
    s_nop 0
    buffer_load_dwordx4 v10, s[24:27], 0 offen offset:256 lds
    buffer_load_dwordx4 v11, s[24:27], 0 offen offset:1280 lds
    s_cmp_eq_u32 s54, 0
    s_cselect_b32 s41, 614400, s43
    buffer_load_dword v14, v12, s[28:31], s41 offen
    s_waitcnt vmcnt(17)
    s_barrier
    s_add_u32 m0, s46, 0
    s_add_u32 s47, s50, 491520
    buffer_load_dwordx4 v8, s[28:31], s47 offen lds
    s_add_u32 m0, s46, 4096
    s_add_u32 s47, s50, 491648
    buffer_load_dwordx4 v8, s[28:31], s47 offen lds
    s_add_u32 m0, s46, 8192
    s_add_u32 s47, s50, 491776
    buffer_load_dwordx4 v8, s[28:31], s47 offen lds
    s_add_u32 m0, s46, 12288
    s_add_u32 s47, s50, 491904
    buffer_load_dwordx4 v8, s[28:31], s47 offen lds
    s_add_u32 m0, s46, 16384
    s_add_u32 s47, s50, 492032
    buffer_load_dwordx4 v8, s[28:31], s47 offen lds
    s_add_u32 m0, s45, 116480
    s_nop 0
    buffer_load_dwordx4 v10, s[24:27], s44 offen offset:256 lds
    buffer_load_dwordx4 v11, s[24:27], s44 offen offset:1280 lds
    s_cmp_eq_u32 s54, 1
    s_cselect_b32 s41, 860160, s43
    buffer_load_dword v14, v12, s[28:31], s41 offen
    s_cmp_eq_u32 s54, 0
    s_cselect_b32 s41, 512, s43
    buffer_load_dword v14, v13, s[24:27], s41 offen
    s_waitcnt vmcnt(17)
    s_barrier
    s_add_u32 m0, s46, 24576
    s_add_u32 s47, s50, 614400
    buffer_load_dwordx4 v8, s[28:31], s47 offen lds
    s_add_u32 m0, s46, 28672
    s_add_u32 s47, s50, 614528
    buffer_load_dwordx4 v8, s[28:31], s47 offen lds
    s_add_u32 m0, s46, 32768
    s_add_u32 s47, s50, 614656
    buffer_load_dwordx4 v8, s[28:31], s47 offen lds
    s_add_u32 m0, s46, 36864
    s_add_u32 s47, s50, 614784
    buffer_load_dwordx4 v8, s[28:31], s47 offen lds
    s_add_u32 m0, s46, 40960
    s_add_u32 s47, s50, 614912
    buffer_load_dwordx4 v8, s[28:31], s47 offen lds
    s_add_u32 m0, s45, 97920
    s_nop 0
    buffer_load_dwordx4 v10, s[24:27], 0 offen offset:384 lds
    buffer_load_dwordx4 v11, s[24:27], 0 offen offset:1408 lds
    s_waitcnt vmcnt(19)
    s_barrier
    s_add_u32 m0, s46, 49152
    s_add_u32 s47, s50, 737280
    buffer_load_dwordx4 v8, s[28:31], s47 offen lds
    s_add_u32 m0, s46, 53248
    s_add_u32 s47, s50, 737408
    buffer_load_dwordx4 v8, s[28:31], s47 offen lds
    s_add_u32 m0, s46, 57344
    s_add_u32 s47, s50, 737536
    buffer_load_dwordx4 v8, s[28:31], s47 offen lds
    s_add_u32 m0, s46, 61440
    s_add_u32 s47, s50, 737664
    buffer_load_dwordx4 v8, s[28:31], s47 offen lds
    s_add_u32 m0, s46, 65536
    s_add_u32 s47, s50, 737792
    buffer_load_dwordx4 v8, s[28:31], s47 offen lds
    s_add_u32 m0, s45, 99968
    s_nop 0
    buffer_load_dwordx4 v10, s[24:27], s44 offen offset:384 lds
    buffer_load_dwordx4 v11, s[24:27], s44 offen offset:1408 lds
    s_cmp_eq_u32 s54, 2
    s_cselect_b32 s41, 1105920, s43
    buffer_load_dword v14, v12, s[28:31], s41 offen
    s_cmp_eq_u32 s54, 1
    s_cselect_b32 s41, 640, s43
    buffer_load_dword v14, v13, s[24:27], s41 offen
    s_waitcnt vmcnt(18)
    s_barrier
    s_add_u32 m0, s46, 73728
    s_add_u32 s47, s50, 860160
    buffer_load_dwordx4 v8, s[28:31], s47 offen lds
    s_add_u32 m0, s46, 77824
    s_add_u32 s47, s50, 860288
    buffer_load_dwordx4 v8, s[28:31], s47 offen lds
    s_add_u32 m0, s46, 81920
    s_add_u32 s47, s50, 860416
    buffer_load_dwordx4 v8, s[28:31], s47 offen lds
    s_add_u32 m0, s46, 86016
    s_add_u32 s47, s50, 860544
    buffer_load_dwordx4 v8, s[28:31], s47 offen lds
    s_add_u32 m0, s46, 90112
    s_add_u32 s47, s50, 860672
    buffer_load_dwordx4 v8, s[28:31], s47 offen lds
    s_add_u32 m0, s45, 130560
    s_nop 0
    buffer_load_dwordx4 v10, s[24:27], 0 offen offset:512 lds
    buffer_load_dwordx4 v11, s[24:27], 0 offen offset:1536 lds
    s_waitcnt vmcnt(18)
    s_barrier
    s_add_u32 m0, s46, 0
    s_add_u32 s47, s50, 983040
    buffer_load_dwordx4 v8, s[28:31], s47 offen lds
    s_add_u32 m0, s46, 4096
    s_add_u32 s47, s50, 983168
    buffer_load_dwordx4 v8, s[28:31], s47 offen lds
    s_add_u32 m0, s46, 8192
    s_add_u32 s47, s50, 983296
    buffer_load_dwordx4 v8, s[28:31], s47 offen lds
    s_add_u32 m0, s46, 12288
    s_add_u32 s47, s50, 983424
    buffer_load_dwordx4 v8, s[28:31], s47 offen lds
    s_add_u32 m0, s46, 16384
    s_add_u32 s47, s50, 983552
    buffer_load_dwordx4 v8, s[28:31], s47 offen lds
    s_add_u32 m0, s45, 132608
    s_nop 0
    buffer_load_dwordx4 v10, s[24:27], s44 offen offset:512 lds
    buffer_load_dwordx4 v11, s[24:27], s44 offen offset:1536 lds
    s_cmp_eq_u32 s54, 3
    s_cselect_b32 s41, 1351680, s43
    buffer_load_dword v14, v12, s[28:31], s41 offen
    s_cmp_eq_u32 s54, 2
    s_cselect_b32 s41, 768, s43
    buffer_load_dword v14, v13, s[24:27], s41 offen
    s_waitcnt vmcnt(18)
    s_barrier
    s_add_u32 m0, s46, 24576
    s_add_u32 s47, s50, 1105920
    buffer_load_dwordx4 v8, s[28:31], s47 offen lds
    s_add_u32 m0, s46, 28672
    s_add_u32 s47, s50, 1106048
    buffer_load_dwordx4 v8, s[28:31], s47 offen lds
    s_add_u32 m0, s46, 32768
    s_add_u32 s47, s50, 1106176
    buffer_load_dwordx4 v8, s[28:31], s47 offen lds
    s_add_u32 m0, s46, 36864
    s_add_u32 s47, s50, 1106304
    buffer_load_dwordx4 v8, s[28:31], s47 offen lds
    s_add_u32 m0, s46, 40960
    s_add_u32 s47, s50, 1106432
    buffer_load_dwordx4 v8, s[28:31], s47 offen lds
    s_add_u32 m0, s45, 114048
    s_nop 0
    buffer_load_dwordx4 v10, s[24:27], 0 offen offset:640 lds
    buffer_load_dwordx4 v11, s[24:27], 0 offen offset:1664 lds
    s_waitcnt vmcnt(18)
    s_barrier
    s_add_u32 m0, s46, 49152
    s_add_u32 s47, s50, 1228800
    buffer_load_dwordx4 v8, s[28:31], s47 offen lds
    s_add_u32 m0, s46, 53248
    s_add_u32 s47, s50, 1228928
    buffer_load_dwordx4 v8, s[28:31], s47 offen lds
    s_add_u32 m0, s46, 57344
    s_add_u32 s47, s50, 1229056
    buffer_load_dwordx4 v8, s[28:31], s47 offen lds
    s_add_u32 m0, s46, 61440
    s_add_u32 s47, s50, 1229184
    buffer_load_dwordx4 v8, s[28:31], s47 offen lds
    s_add_u32 m0, s46, 65536
    s_add_u32 s47, s50, 1229312
    buffer_load_dwordx4 v8, s[28:31], s47 offen lds
    s_add_u32 m0, s45, 116096
    s_nop 0
    buffer_load_dwordx4 v10, s[24:27], s44 offen offset:640 lds
    buffer_load_dwordx4 v11, s[24:27], s44 offen offset:1664 lds
    s_cmp_eq_u32 s54, 0
    s_cselect_b32 s41, 1597440, s43
    buffer_load_dword v14, v12, s[28:31], s41 offen
    s_cmp_eq_u32 s54, 3
    s_cselect_b32 s41, 896, s43
    buffer_load_dword v14, v13, s[24:27], s41 offen
    s_waitcnt vmcnt(18)
    s_barrier
    s_add_u32 m0, s46, 73728
    s_add_u32 s47, s50, 1351680
    buffer_load_dwordx4 v8, s[28:31], s47 offen lds
    s_add_u32 m0, s46, 77824
    s_add_u32 s47, s50, 1351808
    buffer_load_dwordx4 v8, s[28:31], s47 offen lds
    s_add_u32 m0, s46, 81920
    s_add_u32 s47, s50, 1351936
    buffer_load_dwordx4 v8, s[28:31], s47 offen lds
    s_add_u32 m0, s46, 86016
    s_add_u32 s47, s50, 1352064
    buffer_load_dwordx4 v8, s[28:31], s47 offen lds
    s_add_u32 m0, s46, 90112
    s_add_u32 s47, s50, 1352192
    buffer_load_dwordx4 v8, s[28:31], s47 offen lds
    s_add_u32 m0, s45, 97536
    s_nop 0
    buffer_load_dwordx4 v10, s[24:27], 0 offen offset:768 lds
    buffer_load_dwordx4 v11, s[24:27], 0 offen offset:1792 lds
    s_waitcnt vmcnt(18)
    s_barrier
    s_add_u32 m0, s46, 0
    s_add_u32 s47, s50, 1474560
    buffer_load_dwordx4 v8, s[28:31], s47 offen lds
    s_add_u32 m0, s46, 4096
    s_add_u32 s47, s50, 1474688
    buffer_load_dwordx4 v8, s[28:31], s47 offen lds
    s_add_u32 m0, s46, 8192
    s_add_u32 s47, s50, 1474816
    buffer_load_dwordx4 v8, s[28:31], s47 offen lds
    s_add_u32 m0, s46, 12288
    s_add_u32 s47, s50, 1474944
    buffer_load_dwordx4 v8, s[28:31], s47 offen lds
    s_add_u32 m0, s46, 16384
    s_add_u32 s47, s50, 1475072
    buffer_load_dwordx4 v8, s[28:31], s47 offen lds
    s_add_u32 m0, s45, 99584
    s_nop 0
    buffer_load_dwordx4 v10, s[24:27], s44 offen offset:768 lds
    buffer_load_dwordx4 v11, s[24:27], s44 offen offset:1792 lds
    s_cmp_eq_u32 s54, 1
    s_cselect_b32 s41, 1843200, s43
    buffer_load_dword v14, v12, s[28:31], s41 offen
    s_cmp_eq_u32 s54, 0
    s_cselect_b32 s41, 1024, s43
    buffer_load_dword v14, v13, s[24:27], s41 offen
    s_mov_b32 s56, s96
    s_mov_b32 s57, s97
    s_mov_b32 s58, 256
    s_mov_b32 s59, 0x00020000
    s_cmp_eq_u32 s38, 8
    s_cselect_b32 s41, 0, 256
    v_mov_b32 v2, s41
    buffer_load_dword v3, v2, s[56:59], 0 offen sc1
    s_waitcnt vmcnt(19)
    s_barrier
    s_add_u32 m0, s46, 24576
    s_add_u32 s47, s50, 1597440
    buffer_load_dwordx4 v8, s[28:31], s47 offen lds
    s_add_u32 m0, s46, 28672
    s_add_u32 s47, s50, 1597568
    buffer_load_dwordx4 v8, s[28:31], s47 offen lds
    s_add_u32 m0, s46, 32768
    s_add_u32 s47, s50, 1597696
    buffer_load_dwordx4 v8, s[28:31], s47 offen lds
    s_add_u32 m0, s46, 36864
    s_add_u32 s47, s50, 1597824
    buffer_load_dwordx4 v8, s[28:31], s47 offen lds
    s_add_u32 m0, s46, 40960
    s_add_u32 s47, s50, 1597952
    buffer_load_dwordx4 v8, s[28:31], s47 offen lds
    s_add_u32 m0, s45, 130176
    s_nop 0
    buffer_load_dwordx4 v10, s[24:27], 0 offen offset:896 lds
    buffer_load_dwordx4 v11, s[24:27], 0 offen offset:1920 lds
    s_waitcnt vmcnt(19)
    s_barrier
    s_add_u32 m0, s46, 49152
    s_add_u32 s47, s50, 1720320
    buffer_load_dwordx4 v8, s[28:31], s47 offen lds
    s_add_u32 m0, s46, 53248
    s_add_u32 s47, s50, 1720448
    buffer_load_dwordx4 v8, s[28:31], s47 offen lds
    s_add_u32 m0, s46, 57344
    s_add_u32 s47, s50, 1720576
    buffer_load_dwordx4 v8, s[28:31], s47 offen lds
    s_add_u32 m0, s46, 61440
    s_add_u32 s47, s50, 1720704
    buffer_load_dwordx4 v8, s[28:31], s47 offen lds
    s_add_u32 m0, s46, 65536
    s_add_u32 s47, s50, 1720832
    buffer_load_dwordx4 v8, s[28:31], s47 offen lds
    s_add_u32 m0, s45, 132224
    s_nop 0
    buffer_load_dwordx4 v10, s[24:27], s44 offen offset:896 lds
    buffer_load_dwordx4 v11, s[24:27], s44 offen offset:1920 lds
    s_cmp_eq_u32 s54, 2
    s_cselect_b32 s41, 2088960, s43
    buffer_load_dword v14, v12, s[28:31], s41 offen
    s_cmp_eq_u32 s54, 1
    s_cselect_b32 s41, 1152, s43
    buffer_load_dword v14, v13, s[24:27], s41 offen
    s_waitcnt vmcnt(19)
    s_barrier
    s_add_u32 m0, s46, 73728
    s_add_u32 s47, s50, 1843200
    buffer_load_dwordx4 v8, s[28:31], s47 offen lds
    s_add_u32 m0, s46, 77824
    s_add_u32 s47, s50, 1843328
    buffer_load_dwordx4 v8, s[28:31], s47 offen lds
    s_add_u32 m0, s46, 81920
    s_add_u32 s47, s50, 1843456
    buffer_load_dwordx4 v8, s[28:31], s47 offen lds
    s_add_u32 m0, s46, 86016
    s_add_u32 s47, s50, 1843584
    buffer_load_dwordx4 v8, s[28:31], s47 offen lds
    s_add_u32 m0, s46, 90112
    s_add_u32 s47, s50, 1843712
    buffer_load_dwordx4 v8, s[28:31], s47 offen lds
    s_add_u32 m0, s45, 113664
    s_nop 0
    buffer_load_dwordx4 v10, s[24:27], 0 offen offset:1024 lds
    buffer_load_dwordx4 v11, s[24:27], 0 offen offset:2048 lds
    s_waitcnt vmcnt(18)
    s_barrier
    s_add_u32 m0, s46, 0
    s_add_u32 s47, s50, 1966080
    buffer_load_dwordx4 v8, s[28:31], s47 offen lds
    s_add_u32 m0, s46, 4096
    s_add_u32 s47, s50, 1966208
    buffer_load_dwordx4 v8, s[28:31], s47 offen lds
    s_add_u32 m0, s46, 8192
    s_add_u32 s47, s50, 1966336
    buffer_load_dwordx4 v8, s[28:31], s47 offen lds
    s_add_u32 m0, s46, 12288
    s_add_u32 s47, s50, 1966464
    buffer_load_dwordx4 v8, s[28:31], s47 offen lds
    s_add_u32 m0, s46, 16384
    s_add_u32 s47, s50, 1966592
    buffer_load_dwordx4 v8, s[28:31], s47 offen lds
    s_add_u32 m0, s45, 115712
    s_nop 0
    buffer_load_dwordx4 v10, s[24:27], s44 offen offset:1024 lds
    buffer_load_dwordx4 v11, s[24:27], s44 offen offset:2048 lds
    s_cmp_eq_u32 s54, 3
    s_cselect_b32 s41, 2334720, s43
    buffer_load_dword v14, v12, s[28:31], s41 offen
    s_waitcnt vmcnt(17)
    s_barrier
    s_add_u32 m0, s46, 24576
    s_add_u32 s47, s50, 2088960
    buffer_load_dwordx4 v8, s[28:31], s47 offen lds
    s_add_u32 m0, s46, 28672
    s_add_u32 s47, s50, 2089088
    buffer_load_dwordx4 v8, s[28:31], s47 offen lds
    s_add_u32 m0, s46, 32768
    s_add_u32 s47, s50, 2089216
    buffer_load_dwordx4 v8, s[28:31], s47 offen lds
    s_add_u32 m0, s46, 36864
    s_add_u32 s47, s50, 2089344
    buffer_load_dwordx4 v8, s[28:31], s47 offen lds
    s_add_u32 m0, s46, 40960
    s_add_u32 s47, s50, 2089472
    buffer_load_dwordx4 v8, s[28:31], s47 offen lds
    s_add_u32 m0, s45, 97152
    s_nop 0
    buffer_load_dwordx4 v10, s[24:27], 0 offen offset:1152 lds
    buffer_load_dwordx4 v11, s[24:27], 0 offen offset:2176 lds
    s_cmp_lg_u32 s38, 8
    s_cbranch_scc1 gated_mix__softmax_full_mha__glu_gated_glu__prompt_kernel_clr0_ok
    v_cmp_gt_u32 vcc, 44, v3
    s_cbranch_vccz gated_mix__softmax_full_mha__glu_gated_glu__prompt_kernel_clr0_ok
    s_mov_b32 s48, 0x40000
gated_mix__softmax_full_mha__glu_gated_glu__prompt_kernel_clr0:
    buffer_load_dword v3, v2, s[56:59], 0 offen sc1
    s_waitcnt vmcnt(0)
    v_cmp_gt_u32 vcc, 44, v3
    s_cbranch_vccz gated_mix__softmax_full_mha__glu_gated_glu__prompt_kernel_clr0_ok
    s_sleep 6
    s_sub_u32 s48, s48, 1
    s_cbranch_scc0 gated_mix__softmax_full_mha__glu_gated_glu__prompt_kernel_clr0
gated_mix__softmax_full_mha__glu_gated_glu__prompt_kernel_clr0_ok:
    s_waitcnt vmcnt(17)
    s_barrier
    s_add_u32 m0, s46, 49152
    s_add_u32 s47, s50, 2211840
    buffer_load_dwordx4 v8, s[28:31], s47 offen lds
    s_add_u32 m0, s46, 53248
    s_add_u32 s47, s50, 2211968
    buffer_load_dwordx4 v8, s[28:31], s47 offen lds
    s_add_u32 m0, s46, 57344
    s_add_u32 s47, s50, 2212096
    buffer_load_dwordx4 v8, s[28:31], s47 offen lds
    s_add_u32 m0, s46, 61440
    s_add_u32 s47, s50, 2212224
    buffer_load_dwordx4 v8, s[28:31], s47 offen lds
    s_add_u32 m0, s46, 65536
    s_add_u32 s47, s50, 2212352
    buffer_load_dwordx4 v8, s[28:31], s47 offen lds
    s_add_u32 m0, s45, 99200
    s_nop 0
    buffer_load_dwordx4 v10, s[24:27], s44 offen offset:1152 lds
    buffer_load_dwordx4 v11, s[24:27], s44 offen offset:2176 lds
    s_waitcnt vmcnt(15)
    s_barrier
    s_add_u32 m0, s46, 73728
    s_add_u32 s47, s50, 2334720
    buffer_load_dwordx4 v8, s[28:31], s47 offen lds
    s_add_u32 m0, s46, 77824
    s_add_u32 s47, s50, 2334848
    buffer_load_dwordx4 v8, s[28:31], s47 offen lds
    s_add_u32 m0, s46, 81920
    s_add_u32 s47, s50, 2334976
    buffer_load_dwordx4 v8, s[28:31], s47 offen lds
    s_add_u32 m0, s46, 86016
    s_add_u32 s47, s50, 2335104
    buffer_load_dwordx4 v8, s[28:31], s47 offen lds
    s_add_u32 m0, s46, 90112
    s_add_u32 s47, s50, 2335232
    buffer_load_dwordx4 v8, s[28:31], s47 offen lds
    s_waitcnt vmcnt(0)
    s_barrier
    s_branch gated_mix__softmax_full_mha__glu_gated_glu__prompt_kernel_aux
gated_mix__softmax_full_mha__glu_gated_glu__prompt_kernel_ld_gu:
    v_mul_u32_u24 v2, 3456, v2
    s_lshr_b32 s43, s54, 1
    s_and_b32 s42, s54, 1
    v_lshlrev_b32 v3, 1, v3
    s_mul_i32 s46, s43, 12288
    s_lshl_b32 s41, s42, 11
    s_add_u32 s46, s46, s41
    s_mul_i32 s50, s42, 55296
    s_mul_i32 s41, s39, 384
    s_add_u32 s50, s50, s41
    s_sub_u32 s50, s50, 2304
    v_xor_b32 v3, v3, v4
    v_lshl_add_u32 v8, v3, 4, v2
    v_xor_b32 v9, 64, v8
    s_mov_b32 s26, 2621440
    s_mov_b32 s27, 0x00020000
    s_mov_b32 s30, 2211840
    s_mov_b32 s31, 0x00020000
    s_cmp_eq_u32 s43, 0
    s_waitcnt lgkmcnt(0)
    s_cselect_b32 s28, s12, s14
    s_cselect_b32 s29, s13, s15
    s_mov_b64 s[24:25], s[4:5]
    s_add_u32 m0, s45, 98304
    s_nop 0
    buffer_load_dwordx4 v10, s[24:27], 0 offen offset:0 lds
    buffer_load_dwordx4 v11, s[24:27], 0 offen offset:1024 lds
    s_add_u32 m0, s45, 100352
    s_nop 0
    buffer_load_dwordx4 v10, s[24:27], s44 offen offset:0 lds
    buffer_load_dwordx4 v11, s[24:27], s44 offen offset:1024 lds
    s_add_u32 m0, s46, 0
    s_add_u32 s47, s50, 0
    buffer_load_dwordx4 v8, s[28:31], s47 offen lds
    s_add_u32 m0, s46, 4096
    s_add_u32 s47, s50, 128
    buffer_load_dwordx4 v8, s[28:31], s47 offen lds
    s_add_u32 m0, s46, 8192
    s_add_u32 s47, s50, 256
    buffer_load_dwordx4 v8, s[28:31], s47 offen lds
    s_add_u32 m0, s46, 1024
    s_add_u32 s47, s50, 27648
    buffer_load_dwordx4 v9, s[28:31], s47 offen lds
    s_add_u32 m0, s46, 5120
    s_add_u32 s47, s50, 27776
    buffer_load_dwordx4 v9, s[28:31], s47 offen lds
    s_add_u32 m0, s46, 9216
    s_add_u32 s47, s50, 27904
    buffer_load_dwordx4 v9, s[28:31], s47 offen lds
    s_add_u32 m0, s46, 24576
    s_add_u32 s47, s50, 110592
    buffer_load_dwordx4 v8, s[28:31], s47 offen lds
    s_add_u32 m0, s46, 28672
    s_add_u32 s47, s50, 110720
    buffer_load_dwordx4 v8, s[28:31], s47 offen lds
    s_add_u32 m0, s46, 32768
    s_add_u32 s47, s50, 110848
    buffer_load_dwordx4 v8, s[28:31], s47 offen lds
    s_add_u32 m0, s46, 25600
    s_add_u32 s47, s50, 138240
    buffer_load_dwordx4 v9, s[28:31], s47 offen lds
    s_add_u32 m0, s46, 29696
    s_add_u32 s47, s50, 138368
    buffer_load_dwordx4 v9, s[28:31], s47 offen lds
    s_add_u32 m0, s46, 33792
    s_add_u32 s47, s50, 138496
    buffer_load_dwordx4 v9, s[28:31], s47 offen lds
    s_add_u32 m0, s45, 130944
    s_nop 0
    buffer_load_dwordx4 v10, s[24:27], 0 offen offset:128 lds
    buffer_load_dwordx4 v11, s[24:27], 0 offen offset:1152 lds
    s_add_u32 m0, s45, 132992
    s_nop 0
    buffer_load_dwordx4 v10, s[24:27], s44 offen offset:128 lds
    buffer_load_dwordx4 v11, s[24:27], s44 offen offset:1152 lds
    s_add_u32 m0, s46, 49152
    s_add_u32 s47, s50, 221184
    buffer_load_dwordx4 v8, s[28:31], s47 offen lds
    s_add_u32 m0, s46, 53248
    s_add_u32 s47, s50, 221312
    buffer_load_dwordx4 v8, s[28:31], s47 offen lds
    s_add_u32 m0, s46, 57344
    s_add_u32 s47, s50, 221440
    buffer_load_dwordx4 v8, s[28:31], s47 offen lds
    s_add_u32 m0, s46, 50176
    s_add_u32 s47, s50, 248832
    buffer_load_dwordx4 v9, s[28:31], s47 offen lds
    s_add_u32 m0, s46, 54272
    s_add_u32 s47, s50, 248960
    buffer_load_dwordx4 v9, s[28:31], s47 offen lds
    s_add_u32 m0, s46, 58368
    s_add_u32 s47, s50, 249088
    buffer_load_dwordx4 v9, s[28:31], s47 offen lds
    s_mov_b32 s32, s20
    s_mov_b32 s33, s21
    s_mov_b32 s34, 268435456
    s_mov_b32 s35, 0x00020000
    v_mul_u32_u24 v2, 21846, v1
    v_lshrrev_b32 v2, 16, v2
    v_mul_u32_u24 v3, 3, v2
    v_sub_u32 v3, v1, v3
    v_lshrrev_b32 v4, 1, v2
    v_mul_u32_u24 v4, 30, v4
    v_add_u32 v2, v2, v4
    v_mul_u32_u24 v2, 3456, v2
    v_lshl_add_u32 v2, v3, 7, v2
    v_cmp_gt_u32 vcc, 12, v1
    s_mul_i32 s41, s40, 6912
    s_mul_i32 s42, s39, 384
    s_add_u32 s41, s41, s42
    s_sub_u32 s41, s41, 2304
    v_add_u32 v2, s41, v2
    v_mov_b32 v3, 1073741824
    v_cndmask_b32 v12, v3, v2, vcc
    s_mul_i32 s41, s39, 9
    v_min_u32 v2, 8, v1
    v_add_u32 v2, s41, v2
    v_min_u32 v2, 127, v2
    s_lshl_b32 s41, s40, 7
    v_add_u32 v2, s41, v2
    v_mul_u32_u24 v13, 1280, v2
    s_mov_b32 s43, 1073741824
    s_waitcnt vmcnt(16)
    s_barrier
    s_add_u32 m0, s46, 73728
    s_add_u32 s47, s50, 331776
    buffer_load_dwordx4 v8, s[28:31], s47 offen lds
    s_add_u32 m0, s46, 77824
    s_add_u32 s47, s50, 331904
    buffer_load_dwordx4 v8, s[28:31], s47 offen lds
    s_add_u32 m0, s46, 81920
    s_add_u32 s47, s50, 332032
    buffer_load_dwordx4 v8, s[28:31], s47 offen lds
    s_add_u32 m0, s46, 74752
    s_add_u32 s47, s50, 359424
    buffer_load_dwordx4 v9, s[28:31], s47 offen lds
    s_add_u32 m0, s46, 78848
    s_add_u32 s47, s50, 359552
    buffer_load_dwordx4 v9, s[28:31], s47 offen lds
    s_add_u32 m0, s46, 82944
    s_add_u32 s47, s50, 359680
    buffer_load_dwordx4 v9, s[28:31], s47 offen lds
    s_add_u32 m0, s45, 114432
    s_nop 0
    buffer_load_dwordx4 v10, s[24:27], 0 offen offset:256 lds
    buffer_load_dwordx4 v11, s[24:27], 0 offen offset:1280 lds
    s_bitcmp0_b32 s54, 0
    s_cselect_b32 s41, 552960, s43
    buffer_load_dword v14, v12, s[28:31], s41 offen
    s_waitcnt vmcnt(19)
    s_barrier
    s_add_u32 m0, s46, 0
    s_add_u32 s47, s50, 442368
    buffer_load_dwordx4 v8, s[28:31], s47 offen lds
    s_add_u32 m0, s46, 4096
    s_add_u32 s47, s50, 442496
    buffer_load_dwordx4 v8, s[28:31], s47 offen lds
    s_add_u32 m0, s46, 8192
    s_add_u32 s47, s50, 442624
    buffer_load_dwordx4 v8, s[28:31], s47 offen lds
    s_add_u32 m0, s46, 1024
    s_add_u32 s47, s50, 470016
    buffer_load_dwordx4 v9, s[28:31], s47 offen lds
    s_add_u32 m0, s46, 5120
    s_add_u32 s47, s50, 470144
    buffer_load_dwordx4 v9, s[28:31], s47 offen lds
    s_add_u32 m0, s46, 9216
    s_add_u32 s47, s50, 470272
    buffer_load_dwordx4 v9, s[28:31], s47 offen lds
    s_add_u32 m0, s45, 116480
    s_nop 0
    buffer_load_dwordx4 v10, s[24:27], s44 offen offset:256 lds
    buffer_load_dwordx4 v11, s[24:27], s44 offen offset:1280 lds
    s_bitcmp1_b32 s54, 0
    s_cselect_b32 s41, 774144, s43
    buffer_load_dword v14, v12, s[28:31], s41 offen
    s_cmp_eq_u32 s54, 0
    s_cselect_b32 s41, 512, s43
    buffer_load_dword v14, v13, s[24:27], s41 offen
    s_waitcnt vmcnt(19)
    s_barrier
    s_add_u32 m0, s46, 24576
    s_add_u32 s47, s50, 552960
    buffer_load_dwordx4 v8, s[28:31], s47 offen lds
    s_add_u32 m0, s46, 28672
    s_add_u32 s47, s50, 553088
    buffer_load_dwordx4 v8, s[28:31], s47 offen lds
    s_add_u32 m0, s46, 32768
    s_add_u32 s47, s50, 553216
    buffer_load_dwordx4 v8, s[28:31], s47 offen lds
    s_add_u32 m0, s46, 25600
    s_add_u32 s47, s50, 580608
    buffer_load_dwordx4 v9, s[28:31], s47 offen lds
    s_add_u32 m0, s46, 29696
    s_add_u32 s47, s50, 580736
    buffer_load_dwordx4 v9, s[28:31], s47 offen lds
    s_add_u32 m0, s46, 33792
    s_add_u32 s47, s50, 580864
    buffer_load_dwordx4 v9, s[28:31], s47 offen lds
    s_add_u32 m0, s45, 97920
    s_nop 0
    buffer_load_dwordx4 v10, s[24:27], 0 offen offset:384 lds
    buffer_load_dwordx4 v11, s[24:27], 0 offen offset:1408 lds
    s_waitcnt vmcnt(21)
    s_barrier
    s_add_u32 m0, s46, 49152
    s_add_u32 s47, s50, 663552
    buffer_load_dwordx4 v8, s[28:31], s47 offen lds
    s_add_u32 m0, s46, 53248
    s_add_u32 s47, s50, 663680
    buffer_load_dwordx4 v8, s[28:31], s47 offen lds
    s_add_u32 m0, s46, 57344
    s_add_u32 s47, s50, 663808
    buffer_load_dwordx4 v8, s[28:31], s47 offen lds
    s_add_u32 m0, s46, 50176
    s_add_u32 s47, s50, 691200
    buffer_load_dwordx4 v9, s[28:31], s47 offen lds
    s_add_u32 m0, s46, 54272
    s_add_u32 s47, s50, 691328
    buffer_load_dwordx4 v9, s[28:31], s47 offen lds
    s_add_u32 m0, s46, 58368
    s_add_u32 s47, s50, 691456
    buffer_load_dwordx4 v9, s[28:31], s47 offen lds
    s_add_u32 m0, s45, 99968
    s_nop 0
    buffer_load_dwordx4 v10, s[24:27], s44 offen offset:384 lds
    buffer_load_dwordx4 v11, s[24:27], s44 offen offset:1408 lds
    s_bitcmp0_b32 s54, 0
    s_cselect_b32 s41, 995328, s43
    buffer_load_dword v14, v12, s[28:31], s41 offen
    s_cmp_eq_u32 s54, 1
    s_cselect_b32 s41, 640, s43
    buffer_load_dword v14, v13, s[24:27], s41 offen
    s_waitcnt vmcnt(20)
    s_barrier
    s_add_u32 m0, s46, 73728
    s_add_u32 s47, s50, 774144
    buffer_load_dwordx4 v8, s[28:31], s47 offen lds
    s_add_u32 m0, s46, 77824
    s_add_u32 s47, s50, 774272
    buffer_load_dwordx4 v8, s[28:31], s47 offen lds
    s_add_u32 m0, s46, 81920
    s_add_u32 s47, s50, 774400
    buffer_load_dwordx4 v8, s[28:31], s47 offen lds
    s_add_u32 m0, s46, 74752
    s_add_u32 s47, s50, 801792
    buffer_load_dwordx4 v9, s[28:31], s47 offen lds
    s_add_u32 m0, s46, 78848
    s_add_u32 s47, s50, 801920
    buffer_load_dwordx4 v9, s[28:31], s47 offen lds
    s_add_u32 m0, s46, 82944
    s_add_u32 s47, s50, 802048
    buffer_load_dwordx4 v9, s[28:31], s47 offen lds
    s_add_u32 m0, s45, 130560
    s_nop 0
    buffer_load_dwordx4 v10, s[24:27], 0 offen offset:512 lds
    buffer_load_dwordx4 v11, s[24:27], 0 offen offset:1536 lds
    s_waitcnt vmcnt(20)
    s_barrier
    s_add_u32 m0, s46, 0
    s_add_u32 s47, s50, 884736
    buffer_load_dwordx4 v8, s[28:31], s47 offen lds
    s_add_u32 m0, s46, 4096
    s_add_u32 s47, s50, 884864
    buffer_load_dwordx4 v8, s[28:31], s47 offen lds
    s_add_u32 m0, s46, 8192
    s_add_u32 s47, s50, 884992
    buffer_load_dwordx4 v8, s[28:31], s47 offen lds
    s_add_u32 m0, s46, 1024
    s_add_u32 s47, s50, 912384
    buffer_load_dwordx4 v9, s[28:31], s47 offen lds
    s_add_u32 m0, s46, 5120
    s_add_u32 s47, s50, 912512
    buffer_load_dwordx4 v9, s[28:31], s47 offen lds
    s_add_u32 m0, s46, 9216
    s_add_u32 s47, s50, 912640
    buffer_load_dwordx4 v9, s[28:31], s47 offen lds
    s_add_u32 m0, s45, 132608
    s_nop 0
    buffer_load_dwordx4 v10, s[24:27], s44 offen offset:512 lds
    buffer_load_dwordx4 v11, s[24:27], s44 offen offset:1536 lds
    s_bitcmp1_b32 s54, 0
    s_cselect_b32 s41, 1216512, s43
    buffer_load_dword v14, v12, s[28:31], s41 offen
    s_cmp_eq_u32 s54, 2
    s_cselect_b32 s41, 768, s43
    buffer_load_dword v14, v13, s[24:27], s41 offen
    s_waitcnt vmcnt(20)
    s_barrier
    s_add_u32 m0, s46, 24576
    s_add_u32 s47, s50, 995328
    buffer_load_dwordx4 v8, s[28:31], s47 offen lds
    s_add_u32 m0, s46, 28672
    s_add_u32 s47, s50, 995456
    buffer_load_dwordx4 v8, s[28:31], s47 offen lds
    s_add_u32 m0, s46, 32768
    s_add_u32 s47, s50, 995584
    buffer_load_dwordx4 v8, s[28:31], s47 offen lds
    s_add_u32 m0, s46, 25600
    s_add_u32 s47, s50, 1022976
    buffer_load_dwordx4 v9, s[28:31], s47 offen lds
    s_add_u32 m0, s46, 29696
    s_add_u32 s47, s50, 1023104
    buffer_load_dwordx4 v9, s[28:31], s47 offen lds
    s_add_u32 m0, s46, 33792
    s_add_u32 s47, s50, 1023232
    buffer_load_dwordx4 v9, s[28:31], s47 offen lds
    s_add_u32 m0, s45, 114048
    s_nop 0
    buffer_load_dwordx4 v10, s[24:27], 0 offen offset:640 lds
    buffer_load_dwordx4 v11, s[24:27], 0 offen offset:1664 lds
    s_waitcnt vmcnt(20)
    s_barrier
    s_add_u32 m0, s46, 49152
    s_add_u32 s47, s50, 1105920
    buffer_load_dwordx4 v8, s[28:31], s47 offen lds
    s_add_u32 m0, s46, 53248
    s_add_u32 s47, s50, 1106048
    buffer_load_dwordx4 v8, s[28:31], s47 offen lds
    s_add_u32 m0, s46, 57344
    s_add_u32 s47, s50, 1106176
    buffer_load_dwordx4 v8, s[28:31], s47 offen lds
    s_add_u32 m0, s46, 50176
    s_add_u32 s47, s50, 1133568
    buffer_load_dwordx4 v9, s[28:31], s47 offen lds
    s_add_u32 m0, s46, 54272
    s_add_u32 s47, s50, 1133696
    buffer_load_dwordx4 v9, s[28:31], s47 offen lds
    s_add_u32 m0, s46, 58368
    s_add_u32 s47, s50, 1133824
    buffer_load_dwordx4 v9, s[28:31], s47 offen lds
    s_add_u32 m0, s45, 116096
    s_nop 0
    buffer_load_dwordx4 v10, s[24:27], s44 offen offset:640 lds
    buffer_load_dwordx4 v11, s[24:27], s44 offen offset:1664 lds
    s_bitcmp0_b32 s54, 0
    s_cselect_b32 s41, 1437696, s43
    buffer_load_dword v14, v12, s[28:31], s41 offen
    s_cmp_eq_u32 s54, 3
    s_cselect_b32 s41, 896, s43
    buffer_load_dword v14, v13, s[24:27], s41 offen
    s_waitcnt vmcnt(20)
    s_barrier
    s_add_u32 m0, s46, 73728
    s_add_u32 s47, s50, 1216512
    buffer_load_dwordx4 v8, s[28:31], s47 offen lds
    s_add_u32 m0, s46, 77824
    s_add_u32 s47, s50, 1216640
    buffer_load_dwordx4 v8, s[28:31], s47 offen lds
    s_add_u32 m0, s46, 81920
    s_add_u32 s47, s50, 1216768
    buffer_load_dwordx4 v8, s[28:31], s47 offen lds
    s_add_u32 m0, s46, 74752
    s_add_u32 s47, s50, 1244160
    buffer_load_dwordx4 v9, s[28:31], s47 offen lds
    s_add_u32 m0, s46, 78848
    s_add_u32 s47, s50, 1244288
    buffer_load_dwordx4 v9, s[28:31], s47 offen lds
    s_add_u32 m0, s46, 82944
    s_add_u32 s47, s50, 1244416
    buffer_load_dwordx4 v9, s[28:31], s47 offen lds
    s_add_u32 m0, s45, 97536
    s_nop 0
    buffer_load_dwordx4 v10, s[24:27], 0 offen offset:768 lds
    buffer_load_dwordx4 v11, s[24:27], 0 offen offset:1792 lds
    s_waitcnt vmcnt(20)
    s_barrier
    s_add_u32 m0, s46, 0
    s_add_u32 s47, s50, 1327104
    buffer_load_dwordx4 v8, s[28:31], s47 offen lds
    s_add_u32 m0, s46, 4096
    s_add_u32 s47, s50, 1327232
    buffer_load_dwordx4 v8, s[28:31], s47 offen lds
    s_add_u32 m0, s46, 8192
    s_add_u32 s47, s50, 1327360
    buffer_load_dwordx4 v8, s[28:31], s47 offen lds
    s_add_u32 m0, s46, 1024
    s_add_u32 s47, s50, 1354752
    buffer_load_dwordx4 v9, s[28:31], s47 offen lds
    s_add_u32 m0, s46, 5120
    s_add_u32 s47, s50, 1354880
    buffer_load_dwordx4 v9, s[28:31], s47 offen lds
    s_add_u32 m0, s46, 9216
    s_add_u32 s47, s50, 1355008
    buffer_load_dwordx4 v9, s[28:31], s47 offen lds
    s_add_u32 m0, s45, 99584
    s_nop 0
    buffer_load_dwordx4 v10, s[24:27], s44 offen offset:768 lds
    buffer_load_dwordx4 v11, s[24:27], s44 offen offset:1792 lds
    s_bitcmp1_b32 s54, 0
    s_cselect_b32 s41, 1658880, s43
    buffer_load_dword v14, v12, s[28:31], s41 offen
    s_cmp_eq_u32 s54, 0
    s_cselect_b32 s41, 1024, s43
    buffer_load_dword v14, v13, s[24:27], s41 offen
    s_mov_b32 s56, s96
    s_mov_b32 s57, s97
    s_mov_b32 s58, 256
    s_mov_b32 s59, 0x00020000
    s_cmp_eq_u32 s38, 8
    s_cselect_b32 s41, 0, 256
    v_mov_b32 v2, s41
    buffer_load_dword v3, v2, s[56:59], 0 offen sc1
    s_waitcnt vmcnt(21)
    s_barrier
    s_add_u32 m0, s46, 24576
    s_add_u32 s47, s50, 1437696
    buffer_load_dwordx4 v8, s[28:31], s47 offen lds
    s_add_u32 m0, s46, 28672
    s_add_u32 s47, s50, 1437824
    buffer_load_dwordx4 v8, s[28:31], s47 offen lds
    s_add_u32 m0, s46, 32768
    s_add_u32 s47, s50, 1437952
    buffer_load_dwordx4 v8, s[28:31], s47 offen lds
    s_add_u32 m0, s46, 25600
    s_add_u32 s47, s50, 1465344
    buffer_load_dwordx4 v9, s[28:31], s47 offen lds
    s_add_u32 m0, s46, 29696
    s_add_u32 s47, s50, 1465472
    buffer_load_dwordx4 v9, s[28:31], s47 offen lds
    s_add_u32 m0, s46, 33792
    s_add_u32 s47, s50, 1465600
    buffer_load_dwordx4 v9, s[28:31], s47 offen lds
    s_add_u32 m0, s45, 130176
    s_nop 0
    buffer_load_dwordx4 v10, s[24:27], 0 offen offset:896 lds
    buffer_load_dwordx4 v11, s[24:27], 0 offen offset:1920 lds
    s_waitcnt vmcnt(21)
    s_barrier
    s_add_u32 m0, s46, 49152
    s_add_u32 s47, s50, 1548288
    buffer_load_dwordx4 v8, s[28:31], s47 offen lds
    s_add_u32 m0, s46, 53248
    s_add_u32 s47, s50, 1548416
    buffer_load_dwordx4 v8, s[28:31], s47 offen lds
    s_add_u32 m0, s46, 57344
    s_add_u32 s47, s50, 1548544
    buffer_load_dwordx4 v8, s[28:31], s47 offen lds
    s_add_u32 m0, s46, 50176
    s_add_u32 s47, s50, 1575936
    buffer_load_dwordx4 v9, s[28:31], s47 offen lds
    s_add_u32 m0, s46, 54272
    s_add_u32 s47, s50, 1576064
    buffer_load_dwordx4 v9, s[28:31], s47 offen lds
    s_add_u32 m0, s46, 58368
    s_add_u32 s47, s50, 1576192
    buffer_load_dwordx4 v9, s[28:31], s47 offen lds
    s_add_u32 m0, s45, 132224
    s_nop 0
    buffer_load_dwordx4 v10, s[24:27], s44 offen offset:896 lds
    buffer_load_dwordx4 v11, s[24:27], s44 offen offset:1920 lds
    s_bitcmp0_b32 s54, 0
    s_cselect_b32 s41, 1880064, s43
    buffer_load_dword v14, v12, s[28:31], s41 offen
    s_cmp_eq_u32 s54, 1
    s_cselect_b32 s41, 1152, s43
    buffer_load_dword v14, v13, s[24:27], s41 offen
    s_waitcnt vmcnt(21)
    s_barrier
    s_add_u32 m0, s46, 73728
    s_add_u32 s47, s50, 1658880
    buffer_load_dwordx4 v8, s[28:31], s47 offen lds
    s_add_u32 m0, s46, 77824
    s_add_u32 s47, s50, 1659008
    buffer_load_dwordx4 v8, s[28:31], s47 offen lds
    s_add_u32 m0, s46, 81920
    s_add_u32 s47, s50, 1659136
    buffer_load_dwordx4 v8, s[28:31], s47 offen lds
    s_add_u32 m0, s46, 74752
    s_add_u32 s47, s50, 1686528
    buffer_load_dwordx4 v9, s[28:31], s47 offen lds
    s_add_u32 m0, s46, 78848
    s_add_u32 s47, s50, 1686656
    buffer_load_dwordx4 v9, s[28:31], s47 offen lds
    s_add_u32 m0, s46, 82944
    s_add_u32 s47, s50, 1686784
    buffer_load_dwordx4 v9, s[28:31], s47 offen lds
    s_add_u32 m0, s45, 113664
    s_nop 0
    buffer_load_dwordx4 v10, s[24:27], 0 offen offset:1024 lds
    buffer_load_dwordx4 v11, s[24:27], 0 offen offset:2048 lds
    s_waitcnt vmcnt(20)
    s_barrier
    s_add_u32 m0, s46, 0
    s_add_u32 s47, s50, 1769472
    buffer_load_dwordx4 v8, s[28:31], s47 offen lds
    s_add_u32 m0, s46, 4096
    s_add_u32 s47, s50, 1769600
    buffer_load_dwordx4 v8, s[28:31], s47 offen lds
    s_add_u32 m0, s46, 8192
    s_add_u32 s47, s50, 1769728
    buffer_load_dwordx4 v8, s[28:31], s47 offen lds
    s_add_u32 m0, s46, 1024
    s_add_u32 s47, s50, 1797120
    buffer_load_dwordx4 v9, s[28:31], s47 offen lds
    s_add_u32 m0, s46, 5120
    s_add_u32 s47, s50, 1797248
    buffer_load_dwordx4 v9, s[28:31], s47 offen lds
    s_add_u32 m0, s46, 9216
    s_add_u32 s47, s50, 1797376
    buffer_load_dwordx4 v9, s[28:31], s47 offen lds
    s_add_u32 m0, s45, 115712
    s_nop 0
    buffer_load_dwordx4 v10, s[24:27], s44 offen offset:1024 lds
    buffer_load_dwordx4 v11, s[24:27], s44 offen offset:2048 lds
    s_bitcmp1_b32 s54, 0
    s_cselect_b32 s41, 2101248, s43
    buffer_load_dword v14, v12, s[28:31], s41 offen
    s_waitcnt vmcnt(19)
    s_barrier
    s_add_u32 m0, s46, 24576
    s_add_u32 s47, s50, 1880064
    buffer_load_dwordx4 v8, s[28:31], s47 offen lds
    s_add_u32 m0, s46, 28672
    s_add_u32 s47, s50, 1880192
    buffer_load_dwordx4 v8, s[28:31], s47 offen lds
    s_add_u32 m0, s46, 32768
    s_add_u32 s47, s50, 1880320
    buffer_load_dwordx4 v8, s[28:31], s47 offen lds
    s_add_u32 m0, s46, 25600
    s_add_u32 s47, s50, 1907712
    buffer_load_dwordx4 v9, s[28:31], s47 offen lds
    s_add_u32 m0, s46, 29696
    s_add_u32 s47, s50, 1907840
    buffer_load_dwordx4 v9, s[28:31], s47 offen lds
    s_add_u32 m0, s46, 33792
    s_add_u32 s47, s50, 1907968
    buffer_load_dwordx4 v9, s[28:31], s47 offen lds
    s_add_u32 m0, s45, 97152
    s_nop 0
    buffer_load_dwordx4 v10, s[24:27], 0 offen offset:1152 lds
    buffer_load_dwordx4 v11, s[24:27], 0 offen offset:2176 lds
    s_cmp_lg_u32 s38, 8
    s_cbranch_scc1 gated_mix__softmax_full_mha__glu_gated_glu__prompt_kernel_clr1_ok
    v_cmp_gt_u32 vcc, 44, v3
    s_cbranch_vccz gated_mix__softmax_full_mha__glu_gated_glu__prompt_kernel_clr1_ok
    s_mov_b32 s48, 0x40000
gated_mix__softmax_full_mha__glu_gated_glu__prompt_kernel_clr1:
    buffer_load_dword v3, v2, s[56:59], 0 offen sc1
    s_waitcnt vmcnt(0)
    v_cmp_gt_u32 vcc, 44, v3
    s_cbranch_vccz gated_mix__softmax_full_mha__glu_gated_glu__prompt_kernel_clr1_ok
    s_sleep 6
    s_sub_u32 s48, s48, 1
    s_cbranch_scc0 gated_mix__softmax_full_mha__glu_gated_glu__prompt_kernel_clr1
gated_mix__softmax_full_mha__glu_gated_glu__prompt_kernel_clr1_ok:
    s_waitcnt vmcnt(19)
    s_barrier
    s_add_u32 m0, s46, 49152
    s_add_u32 s47, s50, 1990656
    buffer_load_dwordx4 v8, s[28:31], s47 offen lds
    s_add_u32 m0, s46, 53248
    s_add_u32 s47, s50, 1990784
    buffer_load_dwordx4 v8, s[28:31], s47 offen lds
    s_add_u32 m0, s46, 57344
    s_add_u32 s47, s50, 1990912
    buffer_load_dwordx4 v8, s[28:31], s47 offen lds
    s_add_u32 m0, s46, 50176
    s_add_u32 s47, s50, 2018304
    buffer_load_dwordx4 v9, s[28:31], s47 offen lds
    s_add_u32 m0, s46, 54272
    s_add_u32 s47, s50, 2018432
    buffer_load_dwordx4 v9, s[28:31], s47 offen lds
    s_add_u32 m0, s46, 58368
    s_add_u32 s47, s50, 2018560
    buffer_load_dwordx4 v9, s[28:31], s47 offen lds
    s_add_u32 m0, s45, 99200
    s_nop 0
    buffer_load_dwordx4 v10, s[24:27], s44 offen offset:1152 lds
    buffer_load_dwordx4 v11, s[24:27], s44 offen offset:2176 lds
    s_waitcnt vmcnt(17)
    s_barrier
    s_add_u32 m0, s46, 73728
    s_add_u32 s47, s50, 2101248
    buffer_load_dwordx4 v8, s[28:31], s47 offen lds
    s_add_u32 m0, s46, 77824
    s_add_u32 s47, s50, 2101376
    buffer_load_dwordx4 v8, s[28:31], s47 offen lds
    s_add_u32 m0, s46, 81920
    s_add_u32 s47, s50, 2101504
    buffer_load_dwordx4 v8, s[28:31], s47 offen lds
    s_add_u32 m0, s46, 74752
    s_add_u32 s47, s50, 2128896
    buffer_load_dwordx4 v9, s[28:31], s47 offen lds
    s_add_u32 m0, s46, 78848
    s_add_u32 s47, s50, 2129024
    buffer_load_dwordx4 v9, s[28:31], s47 offen lds
    s_add_u32 m0, s46, 82944
    s_add_u32 s47, s50, 2129152
    buffer_load_dwordx4 v9, s[28:31], s47 offen lds
    s_waitcnt vmcnt(0)
    s_barrier
    s_branch gated_mix__softmax_full_mha__glu_gated_glu__prompt_kernel_aux
gated_mix__softmax_full_mha__glu_gated_glu__prompt_kernel_pre:
    s_cmp_lg_u32 s38, 7
    s_cbranch_scc1 gated_mix__softmax_full_mha__glu_gated_glu__prompt_kernel_nocp
    s_getpc_b64 s[56:57]
gated_mix__softmax_full_mha__glu_gated_glu__prompt_kernel_pc:
    s_sub_u32 s56, s56, gated_mix__softmax_full_mha__glu_gated_glu__prompt_kernel_pc-gated_mix__softmax_full_mha__glu_gated_glu__prompt_kernel
    s_subb_u32 s57, s57, 0
    s_mov_b32 s58, gated_mix__softmax_full_mha__glu_gated_glu__prompt_kernel_end-gated_mix__softmax_full_mha__glu_gated_glu__prompt_kernel
    s_mov_b32 s59, 0x00020000
    s_lshl_b32 s41, s37, 13
    v_lshlrev_b32 v7, 7, v1
    buffer_load_dword v167, v7, s[56:59], s41 offen
gated_mix__softmax_full_mha__glu_gated_glu__prompt_kernel_nocp:
    s_lshl_b32 s41, s39, 7
    s_lshl_b32 s42, s40, 2
    s_add_u32 s45, s41, s42
    s_add_u32 s45, s45, 23224320
    s_cmp_lt_u32 s39, 6
    s_cbranch_scc1 gated_mix__softmax_full_mha__glu_gated_glu__prompt_kernel_pubq
    s_lshl_b32 s41, s40, 7
    s_lshl_b32 s42, s39, 2
    s_add_u32 s45, s41, s42
    s_add_u32 s45, s45, 23232488
gated_mix__softmax_full_mha__glu_gated_glu__prompt_kernel_pubq:
    s_cmp_lt_u32 s37, 30
    s_cbranch_scc1 gated_mix__softmax_full_mha__glu_gated_glu__prompt_kernel_pubg
    s_lshl_b32 s41, s36, 1
    s_add_u32 s41, s41, s37
    s_lshl_b32 s41, s41, 2
    s_add_u32 s45, s41, 23224968
gated_mix__softmax_full_mha__glu_gated_glu__prompt_kernel_pubg:
    s_cmp_lg_u32 s38, 0
    s_cbranch_scc1 gated_mix__softmax_full_mha__glu_gated_glu__prompt_kernel_noreset
    v_mov_b32 v2, 161792
    v_mov_b32 v4, 0
    v_mov_b32 v5, 0
    v_mov_b32 v6, 0
    v_mov_b32 v7, 0
    ds_write_b128 v2, v[4:7]
    ds_write_b128 v2, v[4:7] offset:16
    v_lshlrev_b32 v2, 4, v1
    s_waitcnt lgkmcnt(0)
    s_cmp_ge_u32 s2, 44
    s_cbranch_scc1 gated_mix__softmax_full_mha__glu_gated_glu__prompt_kernel_noreset
    s_mov_b32 s32, s20
    s_mov_b32 s33, s21
    s_mov_b32 s34, 268435456
    s_mov_b32 s35, 0x00020000
    s_mov_b32 s56, s96
    s_mov_b32 s57, s97
    s_mov_b32 s58, 256
    s_mov_b32 s59, 0x00020000
    s_lshl_b32 s41, s2, 10
    s_add_u32 s41, s41, 23224320
    buffer_store_dwordx4 v[4:7], v2, s[32:35], s41 offen sc1
gated_mix__softmax_full_mha__glu_gated_glu__prompt_kernel_noreset:
    s_cmp_ge_u32 s37, 30
    s_cbranch_scc1 gated_mix__softmax_full_mha__glu_gated_glu__prompt_kernel_misc
    s_cmp_ge_u32 s39, 6
    s_cbranch_scc1 gated_mix__softmax_full_mha__glu_gated_glu__prompt_kernel_gu
    s_and_b32 s52, s38, 1
    s_lshr_b32 s53, s38, 1
    v_and_b32 v2, 15, v1
    v_lshrrev_b32 v3, 4, v1
    v_lshrrev_b32 v4, 1, v2
    v_xor_b32 v4, v3, v4
    s_lshl_b32 s41, s52, 13
    s_add_u32 s41, s41, 98304
    v_lshl_add_u32 v2, v2, 7, s41
    v_lshl_add_u32 v8, v4, 4, v2
    v_xor_b32 v9, 64, v8
    v_bfe_u32 v4, v1, 2, 2
    v_lshl_add_u32 v2, v3, 3, v4
    v_lshlrev_b32 v2, 7, v2
    v_and_b32 v5, 3, v1
    v_lshl_add_u32 v2, v5, 3, v2
    v_lshrrev_b32 v4, 1, v4
    v_and_b32 v3, 1, v3
    v_lshl_or_b32 v3, v3, 1, v4
    s_mul_i32 s41, s53, 5
    s_add_u32 s42, s41, 0
    s_lshr_b32 s43, s42, 2
    s_lshl_b32 s43, s43, 7
    s_and_b32 s42, s42, 3
    s_or_b32 s42, s42, s43
    v_xor_b32 v5, s42, v3
    v_lshl_add_u32 v10, v5, 5, v2
    v_add_u32 v15, 49152, v10
    s_add_u32 s42, s41, 1
    s_lshr_b32 s43, s42, 2
    s_lshl_b32 s43, s43, 7
    s_and_b32 s42, s42, 3
    s_or_b32 s42, s42, s43
    v_xor_b32 v5, s42, v3
    v_lshl_add_u32 v11, v5, 5, v2
    v_add_u32 v16, 49152, v11
    s_add_u32 s42, s41, 2
    s_lshr_b32 s43, s42, 2
    s_lshl_b32 s43, s43, 7
    s_and_b32 s42, s42, 3
    s_or_b32 s42, s42, s43
    v_xor_b32 v5, s42, v3
    v_lshl_add_u32 v12, v5, 5, v2
    v_add_u32 v17, 49152, v12
    s_add_u32 s42, s41, 3
    s_lshr_b32 s43, s42, 2
    s_lshl_b32 s43, s43, 7
    s_and_b32 s42, s42, 3
    s_or_b32 s42, s42, s43
    v_xor_b32 v5, s42, v3
    v_lshl_add_u32 v13, v5, 5, v2
    v_add_u32 v18, 49152, v13
    s_add_u32 s42, s41, 4
    s_lshr_b32 s43, s42, 2
    s_lshl_b32 s43, s43, 7
    s_and_b32 s42, s42, 3
    s_or_b32 s42, s42, s43
    v_xor_b32 v5, s42, v3
    v_lshl_add_u32 v14, v5, 5, v2
    v_add_u32 v19, 49152, v14
    s_cmp_ge_u32 s39, 4
    s_cbranch_scc1 gated_mix__softmax_full_mha__glu_gated_glu__prompt_kernel_v
    s_waitcnt lgkmcnt(0)
    s_mov_b32 s32, s20
    s_mov_b32 s33, s21
    s_mov_b32 s34, 268435456
    s_mov_b32 s35, 0x00020000
    s_barrier
    ds_read_b128 v[20:23], v8 offset:0
    ds_read_b64_tr_b16 v[36:37], v10 offset:0
    ds_read_b64_tr_b16 v[38:39], v10 offset:512
    ds_read_b64_tr_b16 v[40:41], v11 offset:0
    ds_read_b64_tr_b16 v[42:43], v11 offset:512
    ds_read_b64_tr_b16 v[44:45], v12 offset:0
    ds_read_b64_tr_b16 v[46:47], v12 offset:512
    ds_read_b128 v[24:27], v8 offset:2048
    ds_read_b128 v[28:31], v8 offset:4096
    ds_read_b128 v[32:35], v8 offset:6144
    s_waitcnt lgkmcnt(9)
    s_waitcnt lgkmcnt(7)
    v_mfma_f32_16x16x32_bf16 v[60:63], v[36:39], v[20:23], 0
    ds_read_b64_tr_b16 v[48:49], v13 offset:0
    s_waitcnt lgkmcnt(6)
    v_mfma_f32_16x16x32_bf16 v[68:71], v[40:43], v[20:23], 0
    ds_read_b64_tr_b16 v[50:51], v13 offset:512
    s_waitcnt lgkmcnt(5)
    v_mfma_f32_16x16x32_bf16 v[76:79], v[44:47], v[20:23], 0
    ds_read_b64_tr_b16 v[52:53], v14 offset:0
    s_waitcnt lgkmcnt(5)
    v_mfma_f32_16x16x32_bf16 v[64:67], v[36:39], v[24:27], 0
    ds_read_b64_tr_b16 v[54:55], v14 offset:512
    v_mfma_f32_16x16x32_bf16 v[72:75], v[40:43], v[24:27], 0
    v_mfma_f32_16x16x32_bf16 v[80:83], v[44:47], v[24:27], 0
    s_waitcnt lgkmcnt(5)
    v_mfma_f32_16x16x32_bf16 v[100:103], v[36:39], v[28:31], 0
    v_mfma_f32_16x16x32_bf16 v[108:111], v[40:43], v[28:31], 0
    v_mfma_f32_16x16x32_bf16 v[116:119], v[44:47], v[28:31], 0
    s_waitcnt lgkmcnt(4)
    v_mfma_f32_16x16x32_bf16 v[104:107], v[36:39], v[32:35], 0
    v_mfma_f32_16x16x32_bf16 v[112:115], v[40:43], v[32:35], 0
    v_mfma_f32_16x16x32_bf16 v[120:123], v[44:47], v[32:35], 0
    s_waitcnt lgkmcnt(0)
    s_barrier
    v_mfma_f32_16x16x32_bf16 v[84:87], v[48:51], v[20:23], 0
    ds_read_b64_tr_b16 v[36:37], v10 offset:24576
    v_mfma_f32_16x16x32_bf16 v[92:95], v[52:55], v[20:23], 0
    ds_read_b64_tr_b16 v[38:39], v10 offset:25088
    ds_read_b128 v[20:23], v9 offset:0
    v_mfma_f32_16x16x32_bf16 v[88:91], v[48:51], v[24:27], 0
    ds_read_b64_tr_b16 v[40:41], v11 offset:24576
    v_mfma_f32_16x16x32_bf16 v[96:99], v[52:55], v[24:27], 0
    ds_read_b64_tr_b16 v[42:43], v11 offset:25088
    ds_read_b128 v[24:27], v9 offset:2048
    v_mfma_f32_16x16x32_bf16 v[124:127], v[48:51], v[28:31], 0
    ds_read_b64_tr_b16 v[44:45], v12 offset:24576
    v_mfma_f32_16x16x32_bf16 v[132:135], v[52:55], v[28:31], 0
    ds_read_b64_tr_b16 v[46:47], v12 offset:25088
    ds_read_b128 v[28:31], v9 offset:4096
    v_mfma_f32_16x16x32_bf16 v[128:131], v[48:51], v[32:35], 0
    v_mfma_f32_16x16x32_bf16 v[136:139], v[52:55], v[32:35], 0
    ds_read_b128 v[32:35], v9 offset:6144
    s_waitcnt lgkmcnt(7)
    v_mfma_f32_16x16x32_bf16 v[60:63], v[36:39], v[20:23], v[60:63]
    ds_read_b64_tr_b16 v[48:49], v13 offset:24576
    s_waitcnt lgkmcnt(6)
    v_mfma_f32_16x16x32_bf16 v[68:71], v[40:43], v[20:23], v[68:71]
    ds_read_b64_tr_b16 v[50:51], v13 offset:25088
    s_waitcnt lgkmcnt(4)
    v_mfma_f32_16x16x32_bf16 v[76:79], v[44:47], v[20:23], v[76:79]
    ds_read_b64_tr_b16 v[52:53], v14 offset:24576
    v_mfma_f32_16x16x32_bf16 v[64:67], v[36:39], v[24:27], v[64:67]
    ds_read_b64_tr_b16 v[54:55], v14 offset:25088
    v_mfma_f32_16x16x32_bf16 v[72:75], v[40:43], v[24:27], v[72:75]
    v_mfma_f32_16x16x32_bf16 v[80:83], v[44:47], v[24:27], v[80:83]
    s_waitcnt lgkmcnt(5)
    v_mfma_f32_16x16x32_bf16 v[100:103], v[36:39], v[28:31], v[100:103]
    v_mfma_f32_16x16x32_bf16 v[108:111], v[40:43], v[28:31], v[108:111]
    v_mfma_f32_16x16x32_bf16 v[116:119], v[44:47], v[28:31], v[116:119]
    s_waitcnt lgkmcnt(4)
    v_mfma_f32_16x16x32_bf16 v[104:107], v[36:39], v[32:35], v[104:107]
    v_mfma_f32_16x16x32_bf16 v[112:115], v[40:43], v[32:35], v[112:115]
    v_mfma_f32_16x16x32_bf16 v[120:123], v[44:47], v[32:35], v[120:123]
    s_waitcnt lgkmcnt(0)
    s_barrier
    v_mfma_f32_16x16x32_bf16 v[84:87], v[48:51], v[20:23], v[84:87]
    ds_read_b64_tr_b16 v[36:37], v15 offset:0
    v_mfma_f32_16x16x32_bf16 v[92:95], v[52:55], v[20:23], v[92:95]
    ds_read_b64_tr_b16 v[38:39], v15 offset:512
    ds_read_b128 v[20:23], v8 offset:32768
    v_mfma_f32_16x16x32_bf16 v[88:91], v[48:51], v[24:27], v[88:91]
    ds_read_b64_tr_b16 v[40:41], v16 offset:0
    v_mfma_f32_16x16x32_bf16 v[96:99], v[52:55], v[24:27], v[96:99]
    ds_read_b64_tr_b16 v[42:43], v16 offset:512
    ds_read_b128 v[24:27], v8 offset:34816
    v_mfma_f32_16x16x32_bf16 v[124:127], v[48:51], v[28:31], v[124:127]
    ds_read_b64_tr_b16 v[44:45], v17 offset:0
    v_mfma_f32_16x16x32_bf16 v[132:135], v[52:55], v[28:31], v[132:135]
    ds_read_b64_tr_b16 v[46:47], v17 offset:512
    ds_read_b128 v[28:31], v8 offset:36864
    v_mfma_f32_16x16x32_bf16 v[128:131], v[48:51], v[32:35], v[128:131]
    v_mfma_f32_16x16x32_bf16 v[136:139], v[52:55], v[32:35], v[136:139]
    ds_read_b128 v[32:35], v8 offset:38912
    s_waitcnt lgkmcnt(7)
    v_mfma_f32_16x16x32_bf16 v[60:63], v[36:39], v[20:23], v[60:63]
    ds_read_b64_tr_b16 v[48:49], v18 offset:0
    s_waitcnt lgkmcnt(6)
    v_mfma_f32_16x16x32_bf16 v[68:71], v[40:43], v[20:23], v[68:71]
    ds_read_b64_tr_b16 v[50:51], v18 offset:512
    s_waitcnt lgkmcnt(4)
    v_mfma_f32_16x16x32_bf16 v[76:79], v[44:47], v[20:23], v[76:79]
    ds_read_b64_tr_b16 v[52:53], v19 offset:0
    v_mfma_f32_16x16x32_bf16 v[64:67], v[36:39], v[24:27], v[64:67]
    ds_read_b64_tr_b16 v[54:55], v19 offset:512
    v_mfma_f32_16x16x32_bf16 v[72:75], v[40:43], v[24:27], v[72:75]
    v_mfma_f32_16x16x32_bf16 v[80:83], v[44:47], v[24:27], v[80:83]
    s_waitcnt lgkmcnt(5)
    v_mfma_f32_16x16x32_bf16 v[100:103], v[36:39], v[28:31], v[100:103]
    v_mfma_f32_16x16x32_bf16 v[108:111], v[40:43], v[28:31], v[108:111]
    v_mfma_f32_16x16x32_bf16 v[116:119], v[44:47], v[28:31], v[116:119]
    s_waitcnt lgkmcnt(4)
    v_mfma_f32_16x16x32_bf16 v[104:107], v[36:39], v[32:35], v[104:107]
    v_mfma_f32_16x16x32_bf16 v[112:115], v[40:43], v[32:35], v[112:115]
    v_mfma_f32_16x16x32_bf16 v[120:123], v[44:47], v[32:35], v[120:123]
    s_waitcnt lgkmcnt(0)
    s_barrier
    v_mfma_f32_16x16x32_bf16 v[84:87], v[48:51], v[20:23], v[84:87]
    ds_read_b64_tr_b16 v[36:37], v15 offset:24576
    v_mfma_f32_16x16x32_bf16 v[92:95], v[52:55], v[20:23], v[92:95]
    ds_read_b64_tr_b16 v[38:39], v15 offset:25088
    ds_read_b128 v[20:23], v9 offset:32768
    v_mfma_f32_16x16x32_bf16 v[88:91], v[48:51], v[24:27], v[88:91]
    ds_read_b64_tr_b16 v[40:41], v16 offset:24576
    v_mfma_f32_16x16x32_bf16 v[96:99], v[52:55], v[24:27], v[96:99]
    ds_read_b64_tr_b16 v[42:43], v16 offset:25088
    ds_read_b128 v[24:27], v9 offset:34816
    v_mfma_f32_16x16x32_bf16 v[124:127], v[48:51], v[28:31], v[124:127]
    ds_read_b64_tr_b16 v[44:45], v17 offset:24576
    v_mfma_f32_16x16x32_bf16 v[132:135], v[52:55], v[28:31], v[132:135]
    ds_read_b64_tr_b16 v[46:47], v17 offset:25088
    ds_read_b128 v[28:31], v9 offset:36864
    v_mfma_f32_16x16x32_bf16 v[128:131], v[48:51], v[32:35], v[128:131]
    v_mfma_f32_16x16x32_bf16 v[136:139], v[52:55], v[32:35], v[136:139]
    ds_read_b128 v[32:35], v9 offset:38912
    s_waitcnt lgkmcnt(7)
    v_mfma_f32_16x16x32_bf16 v[60:63], v[36:39], v[20:23], v[60:63]
    ds_read_b64_tr_b16 v[48:49], v18 offset:24576
    s_waitcnt lgkmcnt(6)
    v_mfma_f32_16x16x32_bf16 v[68:71], v[40:43], v[20:23], v[68:71]
    ds_read_b64_tr_b16 v[50:51], v18 offset:25088
    s_waitcnt lgkmcnt(4)
    v_mfma_f32_16x16x32_bf16 v[76:79], v[44:47], v[20:23], v[76:79]
    ds_read_b64_tr_b16 v[52:53], v19 offset:24576
    v_mfma_f32_16x16x32_bf16 v[64:67], v[36:39], v[24:27], v[64:67]
    ds_read_b64_tr_b16 v[54:55], v19 offset:25088
    v_mfma_f32_16x16x32_bf16 v[72:75], v[40:43], v[24:27], v[72:75]
    v_mfma_f32_16x16x32_bf16 v[80:83], v[44:47], v[24:27], v[80:83]
    s_waitcnt lgkmcnt(5)
    v_mfma_f32_16x16x32_bf16 v[100:103], v[36:39], v[28:31], v[100:103]
    v_mfma_f32_16x16x32_bf16 v[108:111], v[40:43], v[28:31], v[108:111]
    v_mfma_f32_16x16x32_bf16 v[116:119], v[44:47], v[28:31], v[116:119]
    s_waitcnt lgkmcnt(4)
    v_mfma_f32_16x16x32_bf16 v[104:107], v[36:39], v[32:35], v[104:107]
    v_mfma_f32_16x16x32_bf16 v[112:115], v[40:43], v[32:35], v[112:115]
    v_mfma_f32_16x16x32_bf16 v[120:123], v[44:47], v[32:35], v[120:123]
    s_waitcnt lgkmcnt(0)
    s_barrier
    v_mfma_f32_16x16x32_bf16 v[84:87], v[48:51], v[20:23], v[84:87]
    ds_read_b64_tr_b16 v[36:37], v10 offset:0
    v_mfma_f32_16x16x32_bf16 v[92:95], v[52:55], v[20:23], v[92:95]
    ds_read_b64_tr_b16 v[38:39], v10 offset:512
    ds_read_b128 v[20:23], v8 offset:16384
    v_mfma_f32_16x16x32_bf16 v[88:91], v[48:51], v[24:27], v[88:91]
    ds_read_b64_tr_b16 v[40:41], v11 offset:0
    v_mfma_f32_16x16x32_bf16 v[96:99], v[52:55], v[24:27], v[96:99]
    ds_read_b64_tr_b16 v[42:43], v11 offset:512
    ds_read_b128 v[24:27], v8 offset:18432
    v_mfma_f32_16x16x32_bf16 v[124:127], v[48:51], v[28:31], v[124:127]
    ds_read_b64_tr_b16 v[44:45], v12 offset:0
    v_mfma_f32_16x16x32_bf16 v[132:135], v[52:55], v[28:31], v[132:135]
    ds_read_b64_tr_b16 v[46:47], v12 offset:512
    ds_read_b128 v[28:31], v8 offset:20480
    v_mfma_f32_16x16x32_bf16 v[128:131], v[48:51], v[32:35], v[128:131]
    v_mfma_f32_16x16x32_bf16 v[136:139], v[52:55], v[32:35], v[136:139]
    ds_read_b128 v[32:35], v8 offset:22528
    s_waitcnt lgkmcnt(7)
    v_mfma_f32_16x16x32_bf16 v[60:63], v[36:39], v[20:23], v[60:63]
    ds_read_b64_tr_b16 v[48:49], v13 offset:0
    s_waitcnt lgkmcnt(6)
    v_mfma_f32_16x16x32_bf16 v[68:71], v[40:43], v[20:23], v[68:71]
    ds_read_b64_tr_b16 v[50:51], v13 offset:512
    s_waitcnt lgkmcnt(4)
    v_mfma_f32_16x16x32_bf16 v[76:79], v[44:47], v[20:23], v[76:79]
    ds_read_b64_tr_b16 v[52:53], v14 offset:0
    v_mfma_f32_16x16x32_bf16 v[64:67], v[36:39], v[24:27], v[64:67]
    ds_read_b64_tr_b16 v[54:55], v14 offset:512
    v_mfma_f32_16x16x32_bf16 v[72:75], v[40:43], v[24:27], v[72:75]
    v_mfma_f32_16x16x32_bf16 v[80:83], v[44:47], v[24:27], v[80:83]
    s_waitcnt lgkmcnt(5)
    v_mfma_f32_16x16x32_bf16 v[100:103], v[36:39], v[28:31], v[100:103]
    v_mfma_f32_16x16x32_bf16 v[108:111], v[40:43], v[28:31], v[108:111]
    v_mfma_f32_16x16x32_bf16 v[116:119], v[44:47], v[28:31], v[116:119]
    s_waitcnt lgkmcnt(4)
    v_mfma_f32_16x16x32_bf16 v[104:107], v[36:39], v[32:35], v[104:107]
    v_mfma_f32_16x16x32_bf16 v[112:115], v[40:43], v[32:35], v[112:115]
    v_mfma_f32_16x16x32_bf16 v[120:123], v[44:47], v[32:35], v[120:123]
    s_waitcnt lgkmcnt(0)
    s_barrier
    v_mfma_f32_16x16x32_bf16 v[84:87], v[48:51], v[20:23], v[84:87]
    ds_read_b64_tr_b16 v[36:37], v10 offset:24576
    v_mfma_f32_16x16x32_bf16 v[92:95], v[52:55], v[20:23], v[92:95]
    ds_read_b64_tr_b16 v[38:39], v10 offset:25088
    ds_read_b128 v[20:23], v9 offset:16384
    v_mfma_f32_16x16x32_bf16 v[88:91], v[48:51], v[24:27], v[88:91]
    ds_read_b64_tr_b16 v[40:41], v11 offset:24576
    v_mfma_f32_16x16x32_bf16 v[96:99], v[52:55], v[24:27], v[96:99]
    ds_read_b64_tr_b16 v[42:43], v11 offset:25088
    ds_read_b128 v[24:27], v9 offset:18432
    v_mfma_f32_16x16x32_bf16 v[124:127], v[48:51], v[28:31], v[124:127]
    ds_read_b64_tr_b16 v[44:45], v12 offset:24576
    v_mfma_f32_16x16x32_bf16 v[132:135], v[52:55], v[28:31], v[132:135]
    ds_read_b64_tr_b16 v[46:47], v12 offset:25088
    ds_read_b128 v[28:31], v9 offset:20480
    v_mfma_f32_16x16x32_bf16 v[128:131], v[48:51], v[32:35], v[128:131]
    v_mfma_f32_16x16x32_bf16 v[136:139], v[52:55], v[32:35], v[136:139]
    ds_read_b128 v[32:35], v9 offset:22528
    s_cmp_lg_u32 s38, 0
    s_cbranch_scc1 gated_mix__softmax_full_mha__glu_gated_glu__prompt_kernel_cntqk
    s_cmp_ge_u32 s2, 44
    s_cbranch_scc1 gated_mix__softmax_full_mha__glu_gated_glu__prompt_kernel_cntqk
    s_mov_b32 s56, s96
    s_mov_b32 s57, s97
    s_mov_b32 s58, 256
    s_mov_b32 s59, 0x00020000
    v_mov_b32 v2, 0
    v_mov_b32 v3, 1
    s_waitcnt vmcnt(0)
    s_mov_b64 exec, 1
    buffer_atomic_add v3, v2, s[56:59], 0 offen
    s_mov_b64 exec, -1
gated_mix__softmax_full_mha__glu_gated_glu__prompt_kernel_cntqk:
    s_waitcnt lgkmcnt(7)
    v_mfma_f32_16x16x32_bf16 v[60:63], v[36:39], v[20:23], v[60:63]
    ds_read_b64_tr_b16 v[48:49], v13 offset:24576
    s_waitcnt lgkmcnt(6)
    v_mfma_f32_16x16x32_bf16 v[68:71], v[40:43], v[20:23], v[68:71]
    ds_read_b64_tr_b16 v[50:51], v13 offset:25088
    s_waitcnt lgkmcnt(4)
    v_mfma_f32_16x16x32_bf16 v[76:79], v[44:47], v[20:23], v[76:79]
    ds_read_b64_tr_b16 v[52:53], v14 offset:24576
    v_mfma_f32_16x16x32_bf16 v[64:67], v[36:39], v[24:27], v[64:67]
    ds_read_b64_tr_b16 v[54:55], v14 offset:25088
    v_mfma_f32_16x16x32_bf16 v[72:75], v[40:43], v[24:27], v[72:75]
    v_mfma_f32_16x16x32_bf16 v[80:83], v[44:47], v[24:27], v[80:83]
    s_waitcnt lgkmcnt(5)
    v_mfma_f32_16x16x32_bf16 v[100:103], v[36:39], v[28:31], v[100:103]
    v_mfma_f32_16x16x32_bf16 v[108:111], v[40:43], v[28:31], v[108:111]
    v_mfma_f32_16x16x32_bf16 v[116:119], v[44:47], v[28:31], v[116:119]
    s_waitcnt lgkmcnt(4)
    v_mfma_f32_16x16x32_bf16 v[104:107], v[36:39], v[32:35], v[104:107]
    v_mfma_f32_16x16x32_bf16 v[112:115], v[40:43], v[32:35], v[112:115]
    v_mfma_f32_16x16x32_bf16 v[120:123], v[44:47], v[32:35], v[120:123]
    s_waitcnt lgkmcnt(0)
    s_barrier
    v_mfma_f32_16x16x32_bf16 v[84:87], v[48:51], v[20:23], v[84:87]
    ds_read_b64_tr_b16 v[36:37], v15 offset:0
    v_mfma_f32_16x16x32_bf16 v[92:95], v[52:55], v[20:23], v[92:95]
    ds_read_b64_tr_b16 v[38:39], v15 offset:512
    ds_read_b128 v[20:23], v8 offset:0
    v_mfma_f32_16x16x32_bf16 v[88:91], v[48:51], v[24:27], v[88:91]
    ds_read_b64_tr_b16 v[40:41], v16 offset:0
    v_mfma_f32_16x16x32_bf16 v[96:99], v[52:55], v[24:27], v[96:99]
    ds_read_b64_tr_b16 v[42:43], v16 offset:512
    ds_read_b128 v[24:27], v8 offset:2048
    v_mfma_f32_16x16x32_bf16 v[124:127], v[48:51], v[28:31], v[124:127]
    ds_read_b64_tr_b16 v[44:45], v17 offset:0
    v_mfma_f32_16x16x32_bf16 v[132:135], v[52:55], v[28:31], v[132:135]
    ds_read_b64_tr_b16 v[46:47], v17 offset:512
    ds_read_b128 v[28:31], v8 offset:4096
    v_mfma_f32_16x16x32_bf16 v[128:131], v[48:51], v[32:35], v[128:131]
    v_mfma_f32_16x16x32_bf16 v[136:139], v[52:55], v[32:35], v[136:139]
    ds_read_b128 v[32:35], v8 offset:6144
    s_waitcnt lgkmcnt(7)
    v_mfma_f32_16x16x32_bf16 v[60:63], v[36:39], v[20:23], v[60:63]
    ds_read_b64_tr_b16 v[48:49], v18 offset:0
    s_waitcnt lgkmcnt(6)
    v_mfma_f32_16x16x32_bf16 v[68:71], v[40:43], v[20:23], v[68:71]
    ds_read_b64_tr_b16 v[50:51], v18 offset:512
    s_waitcnt lgkmcnt(4)
    v_mfma_f32_16x16x32_bf16 v[76:79], v[44:47], v[20:23], v[76:79]
    ds_read_b64_tr_b16 v[52:53], v19 offset:0
    v_mfma_f32_16x16x32_bf16 v[64:67], v[36:39], v[24:27], v[64:67]
    ds_read_b64_tr_b16 v[54:55], v19 offset:512
    v_mfma_f32_16x16x32_bf16 v[72:75], v[40:43], v[24:27], v[72:75]
    v_mfma_f32_16x16x32_bf16 v[80:83], v[44:47], v[24:27], v[80:83]
    s_waitcnt lgkmcnt(5)
    v_mfma_f32_16x16x32_bf16 v[100:103], v[36:39], v[28:31], v[100:103]
    v_mfma_f32_16x16x32_bf16 v[108:111], v[40:43], v[28:31], v[108:111]
    v_mfma_f32_16x16x32_bf16 v[116:119], v[44:47], v[28:31], v[116:119]
    s_waitcnt lgkmcnt(4)
    v_mfma_f32_16x16x32_bf16 v[104:107], v[36:39], v[32:35], v[104:107]
    v_mfma_f32_16x16x32_bf16 v[112:115], v[40:43], v[32:35], v[112:115]
    v_mfma_f32_16x16x32_bf16 v[120:123], v[44:47], v[32:35], v[120:123]
    s_waitcnt lgkmcnt(0)
    s_barrier
    v_mfma_f32_16x16x32_bf16 v[84:87], v[48:51], v[20:23], v[84:87]
    ds_read_b64_tr_b16 v[36:37], v15 offset:24576
    v_mfma_f32_16x16x32_bf16 v[92:95], v[52:55], v[20:23], v[92:95]
    ds_read_b64_tr_b16 v[38:39], v15 offset:25088
    ds_read_b128 v[20:23], v9 offset:0
    v_mfma_f32_16x16x32_bf16 v[88:91], v[48:51], v[24:27], v[88:91]
    ds_read_b64_tr_b16 v[40:41], v16 offset:24576
    v_mfma_f32_16x16x32_bf16 v[96:99], v[52:55], v[24:27], v[96:99]
    ds_read_b64_tr_b16 v[42:43], v16 offset:25088
    ds_read_b128 v[24:27], v9 offset:2048
    v_mfma_f32_16x16x32_bf16 v[124:127], v[48:51], v[28:31], v[124:127]
    ds_read_b64_tr_b16 v[44:45], v17 offset:24576
    v_mfma_f32_16x16x32_bf16 v[132:135], v[52:55], v[28:31], v[132:135]
    ds_read_b64_tr_b16 v[46:47], v17 offset:25088
    ds_read_b128 v[28:31], v9 offset:4096
    v_mfma_f32_16x16x32_bf16 v[128:131], v[48:51], v[32:35], v[128:131]
    v_mfma_f32_16x16x32_bf16 v[136:139], v[52:55], v[32:35], v[136:139]
    ds_read_b128 v[32:35], v9 offset:6144
    s_waitcnt lgkmcnt(7)
    v_mfma_f32_16x16x32_bf16 v[60:63], v[36:39], v[20:23], v[60:63]
    ds_read_b64_tr_b16 v[48:49], v18 offset:24576
    s_waitcnt lgkmcnt(6)
    v_mfma_f32_16x16x32_bf16 v[68:71], v[40:43], v[20:23], v[68:71]
    ds_read_b64_tr_b16 v[50:51], v18 offset:25088
    s_waitcnt lgkmcnt(4)
    v_mfma_f32_16x16x32_bf16 v[76:79], v[44:47], v[20:23], v[76:79]
    ds_read_b64_tr_b16 v[52:53], v19 offset:24576
    v_mfma_f32_16x16x32_bf16 v[64:67], v[36:39], v[24:27], v[64:67]
    ds_read_b64_tr_b16 v[54:55], v19 offset:25088
    v_mfma_f32_16x16x32_bf16 v[72:75], v[40:43], v[24:27], v[72:75]
    v_mfma_f32_16x16x32_bf16 v[80:83], v[44:47], v[24:27], v[80:83]
    s_waitcnt lgkmcnt(5)
    v_mfma_f32_16x16x32_bf16 v[100:103], v[36:39], v[28:31], v[100:103]
    v_mfma_f32_16x16x32_bf16 v[108:111], v[40:43], v[28:31], v[108:111]
    v_mfma_f32_16x16x32_bf16 v[116:119], v[44:47], v[28:31], v[116:119]
    s_waitcnt lgkmcnt(4)
    v_mfma_f32_16x16x32_bf16 v[104:107], v[36:39], v[32:35], v[104:107]
    v_mfma_f32_16x16x32_bf16 v[112:115], v[40:43], v[32:35], v[112:115]
    v_mfma_f32_16x16x32_bf16 v[120:123], v[44:47], v[32:35], v[120:123]
    s_waitcnt lgkmcnt(0)
    s_barrier
    v_mfma_f32_16x16x32_bf16 v[84:87], v[48:51], v[20:23], v[84:87]
    ds_read_b64_tr_b16 v[36:37], v10 offset:0
    v_mfma_f32_16x16x32_bf16 v[92:95], v[52:55], v[20:23], v[92:95]
    ds_read_b64_tr_b16 v[38:39], v10 offset:512
    ds_read_b128 v[20:23], v8 offset:32768
    v_mfma_f32_16x16x32_bf16 v[88:91], v[48:51], v[24:27], v[88:91]
    ds_read_b64_tr_b16 v[40:41], v11 offset:0
    v_mfma_f32_16x16x32_bf16 v[96:99], v[52:55], v[24:27], v[96:99]
    ds_read_b64_tr_b16 v[42:43], v11 offset:512
    ds_read_b128 v[24:27], v8 offset:34816
    v_mfma_f32_16x16x32_bf16 v[124:127], v[48:51], v[28:31], v[124:127]
    ds_read_b64_tr_b16 v[44:45], v12 offset:0
    v_mfma_f32_16x16x32_bf16 v[132:135], v[52:55], v[28:31], v[132:135]
    ds_read_b64_tr_b16 v[46:47], v12 offset:512
    ds_read_b128 v[28:31], v8 offset:36864
    v_mfma_f32_16x16x32_bf16 v[128:131], v[48:51], v[32:35], v[128:131]
    v_mfma_f32_16x16x32_bf16 v[136:139], v[52:55], v[32:35], v[136:139]
    ds_read_b128 v[32:35], v8 offset:38912
    s_waitcnt lgkmcnt(7)
    v_mfma_f32_16x16x32_bf16 v[60:63], v[36:39], v[20:23], v[60:63]
    ds_read_b64_tr_b16 v[48:49], v13 offset:0
    s_waitcnt lgkmcnt(6)
    v_mfma_f32_16x16x32_bf16 v[68:71], v[40:43], v[20:23], v[68:71]
    ds_read_b64_tr_b16 v[50:51], v13 offset:512
    s_waitcnt lgkmcnt(4)
    v_mfma_f32_16x16x32_bf16 v[76:79], v[44:47], v[20:23], v[76:79]
    ds_read_b64_tr_b16 v[52:53], v14 offset:0
    v_mfma_f32_16x16x32_bf16 v[64:67], v[36:39], v[24:27], v[64:67]
    ds_read_b64_tr_b16 v[54:55], v14 offset:512
    v_mfma_f32_16x16x32_bf16 v[72:75], v[40:43], v[24:27], v[72:75]
    v_mfma_f32_16x16x32_bf16 v[80:83], v[44:47], v[24:27], v[80:83]
    s_waitcnt lgkmcnt(5)
    v_mfma_f32_16x16x32_bf16 v[100:103], v[36:39], v[28:31], v[100:103]
    v_mfma_f32_16x16x32_bf16 v[108:111], v[40:43], v[28:31], v[108:111]
    v_mfma_f32_16x16x32_bf16 v[116:119], v[44:47], v[28:31], v[116:119]
    s_waitcnt lgkmcnt(4)
    v_mfma_f32_16x16x32_bf16 v[104:107], v[36:39], v[32:35], v[104:107]
    v_mfma_f32_16x16x32_bf16 v[112:115], v[40:43], v[32:35], v[112:115]
    v_mfma_f32_16x16x32_bf16 v[120:123], v[44:47], v[32:35], v[120:123]
    s_waitcnt lgkmcnt(0)
    s_barrier
    v_mfma_f32_16x16x32_bf16 v[84:87], v[48:51], v[20:23], v[84:87]
    ds_read_b64_tr_b16 v[36:37], v10 offset:24576
    v_mfma_f32_16x16x32_bf16 v[92:95], v[52:55], v[20:23], v[92:95]
    ds_read_b64_tr_b16 v[38:39], v10 offset:25088
    ds_read_b128 v[20:23], v9 offset:32768
    v_mfma_f32_16x16x32_bf16 v[88:91], v[48:51], v[24:27], v[88:91]
    ds_read_b64_tr_b16 v[40:41], v11 offset:24576
    v_mfma_f32_16x16x32_bf16 v[96:99], v[52:55], v[24:27], v[96:99]
    ds_read_b64_tr_b16 v[42:43], v11 offset:25088
    ds_read_b128 v[24:27], v9 offset:34816
    v_mfma_f32_16x16x32_bf16 v[124:127], v[48:51], v[28:31], v[124:127]
    ds_read_b64_tr_b16 v[44:45], v12 offset:24576
    v_mfma_f32_16x16x32_bf16 v[132:135], v[52:55], v[28:31], v[132:135]
    ds_read_b64_tr_b16 v[46:47], v12 offset:25088
    ds_read_b128 v[28:31], v9 offset:36864
    v_mfma_f32_16x16x32_bf16 v[128:131], v[48:51], v[32:35], v[128:131]
    v_mfma_f32_16x16x32_bf16 v[136:139], v[52:55], v[32:35], v[136:139]
    ds_read_b128 v[32:35], v9 offset:38912
    s_waitcnt lgkmcnt(7)
    v_mfma_f32_16x16x32_bf16 v[60:63], v[36:39], v[20:23], v[60:63]
    ds_read_b64_tr_b16 v[48:49], v13 offset:24576
    s_waitcnt lgkmcnt(6)
    v_mfma_f32_16x16x32_bf16 v[68:71], v[40:43], v[20:23], v[68:71]
    ds_read_b64_tr_b16 v[50:51], v13 offset:25088
    s_waitcnt lgkmcnt(4)
    v_mfma_f32_16x16x32_bf16 v[76:79], v[44:47], v[20:23], v[76:79]
    ds_read_b64_tr_b16 v[52:53], v14 offset:24576
    v_mfma_f32_16x16x32_bf16 v[64:67], v[36:39], v[24:27], v[64:67]
    ds_read_b64_tr_b16 v[54:55], v14 offset:25088
    v_mfma_f32_16x16x32_bf16 v[72:75], v[40:43], v[24:27], v[72:75]
    v_mfma_f32_16x16x32_bf16 v[80:83], v[44:47], v[24:27], v[80:83]
    s_waitcnt lgkmcnt(5)
    v_mfma_f32_16x16x32_bf16 v[100:103], v[36:39], v[28:31], v[100:103]
    v_mfma_f32_16x16x32_bf16 v[108:111], v[40:43], v[28:31], v[108:111]
    v_mfma_f32_16x16x32_bf16 v[116:119], v[44:47], v[28:31], v[116:119]
    s_waitcnt lgkmcnt(4)
    v_mfma_f32_16x16x32_bf16 v[104:107], v[36:39], v[32:35], v[104:107]
    v_mfma_f32_16x16x32_bf16 v[112:115], v[40:43], v[32:35], v[112:115]
    v_mfma_f32_16x16x32_bf16 v[120:123], v[44:47], v[32:35], v[120:123]
    s_waitcnt lgkmcnt(0)
    s_barrier
    v_mfma_f32_16x16x32_bf16 v[84:87], v[48:51], v[20:23], v[84:87]
    ds_read_b64_tr_b16 v[36:37], v15 offset:0
    v_mfma_f32_16x16x32_bf16 v[92:95], v[52:55], v[20:23], v[92:95]
    ds_read_b64_tr_b16 v[38:39], v15 offset:512
    ds_read_b128 v[20:23], v8 offset:16384
    v_mfma_f32_16x16x32_bf16 v[88:91], v[48:51], v[24:27], v[88:91]
    ds_read_b64_tr_b16 v[40:41], v16 offset:0
    v_mfma_f32_16x16x32_bf16 v[96:99], v[52:55], v[24:27], v[96:99]
    ds_read_b64_tr_b16 v[42:43], v16 offset:512
    ds_read_b128 v[24:27], v8 offset:18432
    v_mfma_f32_16x16x32_bf16 v[124:127], v[48:51], v[28:31], v[124:127]
    ds_read_b64_tr_b16 v[44:45], v17 offset:0
    v_mfma_f32_16x16x32_bf16 v[132:135], v[52:55], v[28:31], v[132:135]
    ds_read_b64_tr_b16 v[46:47], v17 offset:512
    ds_read_b128 v[28:31], v8 offset:20480
    v_mfma_f32_16x16x32_bf16 v[128:131], v[48:51], v[32:35], v[128:131]
    v_mfma_f32_16x16x32_bf16 v[136:139], v[52:55], v[32:35], v[136:139]
    ds_read_b128 v[32:35], v8 offset:22528
    s_waitcnt lgkmcnt(7)
    v_mfma_f32_16x16x32_bf16 v[60:63], v[36:39], v[20:23], v[60:63]
    ds_read_b64_tr_b16 v[48:49], v18 offset:0
    s_waitcnt lgkmcnt(6)
    v_mfma_f32_16x16x32_bf16 v[68:71], v[40:43], v[20:23], v[68:71]
    ds_read_b64_tr_b16 v[50:51], v18 offset:512
    s_waitcnt lgkmcnt(4)
    v_mfma_f32_16x16x32_bf16 v[76:79], v[44:47], v[20:23], v[76:79]
    ds_read_b64_tr_b16 v[52:53], v19 offset:0
    v_mfma_f32_16x16x32_bf16 v[64:67], v[36:39], v[24:27], v[64:67]
    ds_read_b64_tr_b16 v[54:55], v19 offset:512
    v_mfma_f32_16x16x32_bf16 v[72:75], v[40:43], v[24:27], v[72:75]
    v_mfma_f32_16x16x32_bf16 v[80:83], v[44:47], v[24:27], v[80:83]
    s_waitcnt lgkmcnt(5)
    v_mfma_f32_16x16x32_bf16 v[100:103], v[36:39], v[28:31], v[100:103]
    v_mfma_f32_16x16x32_bf16 v[108:111], v[40:43], v[28:31], v[108:111]
    v_mfma_f32_16x16x32_bf16 v[116:119], v[44:47], v[28:31], v[116:119]
    s_waitcnt lgkmcnt(4)
    v_mfma_f32_16x16x32_bf16 v[104:107], v[36:39], v[32:35], v[104:107]
    v_mfma_f32_16x16x32_bf16 v[112:115], v[40:43], v[32:35], v[112:115]
    v_mfma_f32_16x16x32_bf16 v[120:123], v[44:47], v[32:35], v[120:123]
    s_waitcnt lgkmcnt(0)
    s_barrier
    v_mfma_f32_16x16x32_bf16 v[84:87], v[48:51], v[20:23], v[84:87]
    ds_read_b64_tr_b16 v[36:37], v15 offset:24576
    v_mfma_f32_16x16x32_bf16 v[92:95], v[52:55], v[20:23], v[92:95]
    ds_read_b64_tr_b16 v[38:39], v15 offset:25088
    ds_read_b128 v[20:23], v9 offset:16384
    v_mfma_f32_16x16x32_bf16 v[88:91], v[48:51], v[24:27], v[88:91]
    ds_read_b64_tr_b16 v[40:41], v16 offset:24576
    v_mfma_f32_16x16x32_bf16 v[96:99], v[52:55], v[24:27], v[96:99]
    ds_read_b64_tr_b16 v[42:43], v16 offset:25088
    ds_read_b128 v[24:27], v9 offset:18432
    v_mfma_f32_16x16x32_bf16 v[124:127], v[48:51], v[28:31], v[124:127]
    ds_read_b64_tr_b16 v[44:45], v17 offset:24576
    v_mfma_f32_16x16x32_bf16 v[132:135], v[52:55], v[28:31], v[132:135]
    ds_read_b64_tr_b16 v[46:47], v17 offset:25088
    ds_read_b128 v[28:31], v9 offset:20480
    v_mfma_f32_16x16x32_bf16 v[128:131], v[48:51], v[32:35], v[128:131]
    v_mfma_f32_16x16x32_bf16 v[136:139], v[52:55], v[32:35], v[136:139]
    ds_read_b128 v[32:35], v9 offset:22528
    s_waitcnt lgkmcnt(7)
    v_mfma_f32_16x16x32_bf16 v[60:63], v[36:39], v[20:23], v[60:63]
    ds_read_b64_tr_b16 v[48:49], v18 offset:24576
    s_waitcnt lgkmcnt(6)
    v_mfma_f32_16x16x32_bf16 v[68:71], v[40:43], v[20:23], v[68:71]
    ds_read_b64_tr_b16 v[50:51], v18 offset:25088
    s_waitcnt lgkmcnt(4)
    v_mfma_f32_16x16x32_bf16 v[76:79], v[44:47], v[20:23], v[76:79]
    ds_read_b64_tr_b16 v[52:53], v19 offset:24576
    v_mfma_f32_16x16x32_bf16 v[64:67], v[36:39], v[24:27], v[64:67]
    ds_read_b64_tr_b16 v[54:55], v19 offset:25088
    v_mfma_f32_16x16x32_bf16 v[72:75], v[40:43], v[24:27], v[72:75]
    v_mfma_f32_16x16x32_bf16 v[80:83], v[44:47], v[24:27], v[80:83]
    s_waitcnt lgkmcnt(5)
    v_mfma_f32_16x16x32_bf16 v[100:103], v[36:39], v[28:31], v[100:103]
    v_mfma_f32_16x16x32_bf16 v[108:111], v[40:43], v[28:31], v[108:111]
    v_mfma_f32_16x16x32_bf16 v[116:119], v[44:47], v[28:31], v[116:119]
    s_waitcnt lgkmcnt(4)
    v_mfma_f32_16x16x32_bf16 v[104:107], v[36:39], v[32:35], v[104:107]
    v_mfma_f32_16x16x32_bf16 v[112:115], v[40:43], v[32:35], v[112:115]
    v_mfma_f32_16x16x32_bf16 v[120:123], v[44:47], v[32:35], v[120:123]
    s_waitcnt lgkmcnt(0)
    s_barrier
    v_mfma_f32_16x16x32_bf16 v[84:87], v[48:51], v[20:23], v[84:87]
    ds_read_b64_tr_b16 v[36:37], v10 offset:0
    v_mfma_f32_16x16x32_bf16 v[92:95], v[52:55], v[20:23], v[92:95]
    ds_read_b64_tr_b16 v[38:39], v10 offset:512
    ds_read_b128 v[20:23], v8 offset:0
    v_mfma_f32_16x16x32_bf16 v[88:91], v[48:51], v[24:27], v[88:91]
    ds_read_b64_tr_b16 v[40:41], v11 offset:0
    v_mfma_f32_16x16x32_bf16 v[96:99], v[52:55], v[24:27], v[96:99]
    ds_read_b64_tr_b16 v[42:43], v11 offset:512
    ds_read_b128 v[24:27], v8 offset:2048
    v_mfma_f32_16x16x32_bf16 v[124:127], v[48:51], v[28:31], v[124:127]
    ds_read_b64_tr_b16 v[44:45], v12 offset:0
    v_mfma_f32_16x16x32_bf16 v[132:135], v[52:55], v[28:31], v[132:135]
    ds_read_b64_tr_b16 v[46:47], v12 offset:512
    ds_read_b128 v[28:31], v8 offset:4096
    v_mfma_f32_16x16x32_bf16 v[128:131], v[48:51], v[32:35], v[128:131]
    v_mfma_f32_16x16x32_bf16 v[136:139], v[52:55], v[32:35], v[136:139]
    ds_read_b128 v[32:35], v8 offset:6144
    s_waitcnt lgkmcnt(7)
    v_mfma_f32_16x16x32_bf16 v[60:63], v[36:39], v[20:23], v[60:63]
    ds_read_b64_tr_b16 v[48:49], v13 offset:0
    s_waitcnt lgkmcnt(6)
    v_mfma_f32_16x16x32_bf16 v[68:71], v[40:43], v[20:23], v[68:71]
    ds_read_b64_tr_b16 v[50:51], v13 offset:512
    s_waitcnt lgkmcnt(4)
    v_mfma_f32_16x16x32_bf16 v[76:79], v[44:47], v[20:23], v[76:79]
    ds_read_b64_tr_b16 v[52:53], v14 offset:0
    v_mfma_f32_16x16x32_bf16 v[64:67], v[36:39], v[24:27], v[64:67]
    ds_read_b64_tr_b16 v[54:55], v14 offset:512
    v_mfma_f32_16x16x32_bf16 v[72:75], v[40:43], v[24:27], v[72:75]
    v_mfma_f32_16x16x32_bf16 v[80:83], v[44:47], v[24:27], v[80:83]
    s_waitcnt lgkmcnt(5)
    v_mfma_f32_16x16x32_bf16 v[100:103], v[36:39], v[28:31], v[100:103]
    v_mfma_f32_16x16x32_bf16 v[108:111], v[40:43], v[28:31], v[108:111]
    v_mfma_f32_16x16x32_bf16 v[116:119], v[44:47], v[28:31], v[116:119]
    s_waitcnt lgkmcnt(4)
    v_mfma_f32_16x16x32_bf16 v[104:107], v[36:39], v[32:35], v[104:107]
    v_mfma_f32_16x16x32_bf16 v[112:115], v[40:43], v[32:35], v[112:115]
    v_mfma_f32_16x16x32_bf16 v[120:123], v[44:47], v[32:35], v[120:123]
    s_waitcnt lgkmcnt(0)
    s_barrier
    v_mfma_f32_16x16x32_bf16 v[84:87], v[48:51], v[20:23], v[84:87]
    ds_read_b64_tr_b16 v[36:37], v10 offset:24576
    v_mfma_f32_16x16x32_bf16 v[92:95], v[52:55], v[20:23], v[92:95]
    ds_read_b64_tr_b16 v[38:39], v10 offset:25088
    ds_read_b128 v[20:23], v9 offset:0
    v_mfma_f32_16x16x32_bf16 v[88:91], v[48:51], v[24:27], v[88:91]
    ds_read_b64_tr_b16 v[40:41], v11 offset:24576
    v_mfma_f32_16x16x32_bf16 v[96:99], v[52:55], v[24:27], v[96:99]
    ds_read_b64_tr_b16 v[42:43], v11 offset:25088
    ds_read_b128 v[24:27], v9 offset:2048
    v_mfma_f32_16x16x32_bf16 v[124:127], v[48:51], v[28:31], v[124:127]
    ds_read_b64_tr_b16 v[44:45], v12 offset:24576
    v_mfma_f32_16x16x32_bf16 v[132:135], v[52:55], v[28:31], v[132:135]
    ds_read_b64_tr_b16 v[46:47], v12 offset:25088
    ds_read_b128 v[28:31], v9 offset:4096
    v_mfma_f32_16x16x32_bf16 v[128:131], v[48:51], v[32:35], v[128:131]
    v_mfma_f32_16x16x32_bf16 v[136:139], v[52:55], v[32:35], v[136:139]
    ds_read_b128 v[32:35], v9 offset:6144
    s_waitcnt lgkmcnt(7)
    v_mfma_f32_16x16x32_bf16 v[60:63], v[36:39], v[20:23], v[60:63]
    ds_read_b64_tr_b16 v[48:49], v13 offset:24576
    s_waitcnt lgkmcnt(6)
    v_mfma_f32_16x16x32_bf16 v[68:71], v[40:43], v[20:23], v[68:71]
    ds_read_b64_tr_b16 v[50:51], v13 offset:25088
    s_waitcnt lgkmcnt(4)
    v_mfma_f32_16x16x32_bf16 v[76:79], v[44:47], v[20:23], v[76:79]
    ds_read_b64_tr_b16 v[52:53], v14 offset:24576
    v_mfma_f32_16x16x32_bf16 v[64:67], v[36:39], v[24:27], v[64:67]
    ds_read_b64_tr_b16 v[54:55], v14 offset:25088
    v_mfma_f32_16x16x32_bf16 v[72:75], v[40:43], v[24:27], v[72:75]
    v_mfma_f32_16x16x32_bf16 v[80:83], v[44:47], v[24:27], v[80:83]
    s_waitcnt lgkmcnt(5)
    v_mfma_f32_16x16x32_bf16 v[100:103], v[36:39], v[28:31], v[100:103]
    v_mfma_f32_16x16x32_bf16 v[108:111], v[40:43], v[28:31], v[108:111]
    v_mfma_f32_16x16x32_bf16 v[116:119], v[44:47], v[28:31], v[116:119]
    s_waitcnt lgkmcnt(4)
    v_mfma_f32_16x16x32_bf16 v[104:107], v[36:39], v[32:35], v[104:107]
    v_mfma_f32_16x16x32_bf16 v[112:115], v[40:43], v[32:35], v[112:115]
    v_mfma_f32_16x16x32_bf16 v[120:123], v[44:47], v[32:35], v[120:123]
    s_waitcnt lgkmcnt(0)
    s_barrier
    v_mfma_f32_16x16x32_bf16 v[84:87], v[48:51], v[20:23], v[84:87]
    ds_read_b64_tr_b16 v[36:37], v15 offset:0
    v_mfma_f32_16x16x32_bf16 v[92:95], v[52:55], v[20:23], v[92:95]
    ds_read_b64_tr_b16 v[38:39], v15 offset:512
    ds_read_b128 v[20:23], v8 offset:32768
    v_mfma_f32_16x16x32_bf16 v[88:91], v[48:51], v[24:27], v[88:91]
    ds_read_b64_tr_b16 v[40:41], v16 offset:0
    v_mfma_f32_16x16x32_bf16 v[96:99], v[52:55], v[24:27], v[96:99]
    ds_read_b64_tr_b16 v[42:43], v16 offset:512
    ds_read_b128 v[24:27], v8 offset:34816
    v_mfma_f32_16x16x32_bf16 v[124:127], v[48:51], v[28:31], v[124:127]
    ds_read_b64_tr_b16 v[44:45], v17 offset:0
    v_mfma_f32_16x16x32_bf16 v[132:135], v[52:55], v[28:31], v[132:135]
    ds_read_b64_tr_b16 v[46:47], v17 offset:512
    ds_read_b128 v[28:31], v8 offset:36864
    v_mfma_f32_16x16x32_bf16 v[128:131], v[48:51], v[32:35], v[128:131]
    v_mfma_f32_16x16x32_bf16 v[136:139], v[52:55], v[32:35], v[136:139]
    ds_read_b128 v[32:35], v8 offset:38912
    s_waitcnt lgkmcnt(7)
    v_mfma_f32_16x16x32_bf16 v[60:63], v[36:39], v[20:23], v[60:63]
    ds_read_b64_tr_b16 v[48:49], v18 offset:0
    s_waitcnt lgkmcnt(6)
    v_mfma_f32_16x16x32_bf16 v[68:71], v[40:43], v[20:23], v[68:71]
    ds_read_b64_tr_b16 v[50:51], v18 offset:512
    s_waitcnt lgkmcnt(4)
    v_mfma_f32_16x16x32_bf16 v[76:79], v[44:47], v[20:23], v[76:79]
    ds_read_b64_tr_b16 v[52:53], v19 offset:0
    v_mfma_f32_16x16x32_bf16 v[64:67], v[36:39], v[24:27], v[64:67]
    ds_read_b64_tr_b16 v[54:55], v19 offset:512
    v_mfma_f32_16x16x32_bf16 v[72:75], v[40:43], v[24:27], v[72:75]
    v_mfma_f32_16x16x32_bf16 v[80:83], v[44:47], v[24:27], v[80:83]
    s_waitcnt lgkmcnt(5)
    v_mfma_f32_16x16x32_bf16 v[100:103], v[36:39], v[28:31], v[100:103]
    v_mfma_f32_16x16x32_bf16 v[108:111], v[40:43], v[28:31], v[108:111]
    v_mfma_f32_16x16x32_bf16 v[116:119], v[44:47], v[28:31], v[116:119]
    s_waitcnt lgkmcnt(4)
    v_mfma_f32_16x16x32_bf16 v[104:107], v[36:39], v[32:35], v[104:107]
    v_mfma_f32_16x16x32_bf16 v[112:115], v[40:43], v[32:35], v[112:115]
    v_mfma_f32_16x16x32_bf16 v[120:123], v[44:47], v[32:35], v[120:123]
    s_waitcnt lgkmcnt(0)
    s_barrier
    v_mfma_f32_16x16x32_bf16 v[84:87], v[48:51], v[20:23], v[84:87]
    ds_read_b64_tr_b16 v[36:37], v15 offset:24576
    v_mfma_f32_16x16x32_bf16 v[92:95], v[52:55], v[20:23], v[92:95]
    ds_read_b64_tr_b16 v[38:39], v15 offset:25088
    ds_read_b128 v[20:23], v9 offset:32768
    v_mfma_f32_16x16x32_bf16 v[88:91], v[48:51], v[24:27], v[88:91]
    ds_read_b64_tr_b16 v[40:41], v16 offset:24576
    v_mfma_f32_16x16x32_bf16 v[96:99], v[52:55], v[24:27], v[96:99]
    ds_read_b64_tr_b16 v[42:43], v16 offset:25088
    ds_read_b128 v[24:27], v9 offset:34816
    v_mfma_f32_16x16x32_bf16 v[124:127], v[48:51], v[28:31], v[124:127]
    ds_read_b64_tr_b16 v[44:45], v17 offset:24576
    v_mfma_f32_16x16x32_bf16 v[132:135], v[52:55], v[28:31], v[132:135]
    ds_read_b64_tr_b16 v[46:47], v17 offset:25088
    ds_read_b128 v[28:31], v9 offset:36864
    v_mfma_f32_16x16x32_bf16 v[128:131], v[48:51], v[32:35], v[128:131]
    v_mfma_f32_16x16x32_bf16 v[136:139], v[52:55], v[32:35], v[136:139]
    ds_read_b128 v[32:35], v9 offset:38912
    s_waitcnt lgkmcnt(7)
    v_mfma_f32_16x16x32_bf16 v[60:63], v[36:39], v[20:23], v[60:63]
    ds_read_b64_tr_b16 v[48:49], v18 offset:24576
    s_waitcnt lgkmcnt(6)
    v_mfma_f32_16x16x32_bf16 v[68:71], v[40:43], v[20:23], v[68:71]
    ds_read_b64_tr_b16 v[50:51], v18 offset:25088
    s_waitcnt lgkmcnt(4)
    v_mfma_f32_16x16x32_bf16 v[76:79], v[44:47], v[20:23], v[76:79]
    ds_read_b64_tr_b16 v[52:53], v19 offset:24576
    v_mfma_f32_16x16x32_bf16 v[64:67], v[36:39], v[24:27], v[64:67]
    ds_read_b64_tr_b16 v[54:55], v19 offset:25088
    v_mfma_f32_16x16x32_bf16 v[72:75], v[40:43], v[24:27], v[72:75]
    v_mfma_f32_16x16x32_bf16 v[80:83], v[44:47], v[24:27], v[80:83]
    s_waitcnt lgkmcnt(5)
    v_mfma_f32_16x16x32_bf16 v[100:103], v[36:39], v[28:31], v[100:103]
    v_mfma_f32_16x16x32_bf16 v[108:111], v[40:43], v[28:31], v[108:111]
    v_mfma_f32_16x16x32_bf16 v[116:119], v[44:47], v[28:31], v[116:119]
    s_waitcnt lgkmcnt(4)
    v_mfma_f32_16x16x32_bf16 v[104:107], v[36:39], v[32:35], v[104:107]
    v_mfma_f32_16x16x32_bf16 v[112:115], v[40:43], v[32:35], v[112:115]
    v_mfma_f32_16x16x32_bf16 v[120:123], v[44:47], v[32:35], v[120:123]
    s_waitcnt lgkmcnt(0)
    s_barrier
    v_mfma_f32_16x16x32_bf16 v[84:87], v[48:51], v[20:23], v[84:87]
    ds_read_b64_tr_b16 v[36:37], v10 offset:0
    v_mfma_f32_16x16x32_bf16 v[92:95], v[52:55], v[20:23], v[92:95]
    ds_read_b64_tr_b16 v[38:39], v10 offset:512
    ds_read_b128 v[20:23], v8 offset:16384
    v_mfma_f32_16x16x32_bf16 v[88:91], v[48:51], v[24:27], v[88:91]
    ds_read_b64_tr_b16 v[40:41], v11 offset:0
    v_mfma_f32_16x16x32_bf16 v[96:99], v[52:55], v[24:27], v[96:99]
    ds_read_b64_tr_b16 v[42:43], v11 offset:512
    ds_read_b128 v[24:27], v8 offset:18432
    v_mfma_f32_16x16x32_bf16 v[124:127], v[48:51], v[28:31], v[124:127]
    ds_read_b64_tr_b16 v[44:45], v12 offset:0
    v_mfma_f32_16x16x32_bf16 v[132:135], v[52:55], v[28:31], v[132:135]
    ds_read_b64_tr_b16 v[46:47], v12 offset:512
    ds_read_b128 v[28:31], v8 offset:20480
    v_mfma_f32_16x16x32_bf16 v[128:131], v[48:51], v[32:35], v[128:131]
    v_mfma_f32_16x16x32_bf16 v[136:139], v[52:55], v[32:35], v[136:139]
    ds_read_b128 v[32:35], v8 offset:22528
    s_waitcnt lgkmcnt(7)
    v_mfma_f32_16x16x32_bf16 v[60:63], v[36:39], v[20:23], v[60:63]
    ds_read_b64_tr_b16 v[48:49], v13 offset:0
    s_waitcnt lgkmcnt(6)
    v_mfma_f32_16x16x32_bf16 v[68:71], v[40:43], v[20:23], v[68:71]
    ds_read_b64_tr_b16 v[50:51], v13 offset:512
    s_waitcnt lgkmcnt(4)
    v_mfma_f32_16x16x32_bf16 v[76:79], v[44:47], v[20:23], v[76:79]
    ds_read_b64_tr_b16 v[52:53], v14 offset:0
    v_mfma_f32_16x16x32_bf16 v[64:67], v[36:39], v[24:27], v[64:67]
    ds_read_b64_tr_b16 v[54:55], v14 offset:512
    v_mfma_f32_16x16x32_bf16 v[72:75], v[40:43], v[24:27], v[72:75]
    v_mfma_f32_16x16x32_bf16 v[80:83], v[44:47], v[24:27], v[80:83]
    s_waitcnt lgkmcnt(5)
    v_mfma_f32_16x16x32_bf16 v[100:103], v[36:39], v[28:31], v[100:103]
    v_mfma_f32_16x16x32_bf16 v[108:111], v[40:43], v[28:31], v[108:111]
    v_mfma_f32_16x16x32_bf16 v[116:119], v[44:47], v[28:31], v[116:119]
    s_waitcnt lgkmcnt(4)
    v_mfma_f32_16x16x32_bf16 v[104:107], v[36:39], v[32:35], v[104:107]
    v_mfma_f32_16x16x32_bf16 v[112:115], v[40:43], v[32:35], v[112:115]
    v_mfma_f32_16x16x32_bf16 v[120:123], v[44:47], v[32:35], v[120:123]
    s_waitcnt lgkmcnt(0)
    s_barrier
    s_cmp_ge_u32 s38, 4
    s_cbranch_scc1 gated_mix__softmax_full_mha__glu_gated_glu__prompt_kernel_npqk
    s_setprio 1
gated_mix__softmax_full_mha__glu_gated_glu__prompt_kernel_npqk:
    v_mfma_f32_16x16x32_bf16 v[84:87], v[48:51], v[20:23], v[84:87]
    ds_read_b64_tr_b16 v[36:37], v10 offset:24576
    v_mfma_f32_16x16x32_bf16 v[92:95], v[52:55], v[20:23], v[92:95]
    ds_read_b64_tr_b16 v[38:39], v10 offset:25088
    ds_read_b128 v[20:23], v9 offset:16384
    v_mfma_f32_16x16x32_bf16 v[88:91], v[48:51], v[24:27], v[88:91]
    ds_read_b64_tr_b16 v[40:41], v11 offset:24576
    v_mfma_f32_16x16x32_bf16 v[96:99], v[52:55], v[24:27], v[96:99]
    ds_read_b64_tr_b16 v[42:43], v11 offset:25088
    ds_read_b128 v[24:27], v9 offset:18432
    v_mfma_f32_16x16x32_bf16 v[124:127], v[48:51], v[28:31], v[124:127]
    ds_read_b64_tr_b16 v[44:45], v12 offset:24576
    v_mfma_f32_16x16x32_bf16 v[132:135], v[52:55], v[28:31], v[132:135]
    ds_read_b64_tr_b16 v[46:47], v12 offset:25088
    ds_read_b128 v[28:31], v9 offset:20480
    v_mfma_f32_16x16x32_bf16 v[128:131], v[48:51], v[32:35], v[128:131]
    v_mfma_f32_16x16x32_bf16 v[136:139], v[52:55], v[32:35], v[136:139]
    ds_read_b128 v[32:35], v9 offset:22528
    s_waitcnt lgkmcnt(7)
    v_mfma_f32_16x16x32_bf16 v[60:63], v[36:39], v[20:23], v[60:63]
    ds_read_b64_tr_b16 v[48:49], v13 offset:24576
    s_waitcnt lgkmcnt(6)
    v_mfma_f32_16x16x32_bf16 v[68:71], v[40:43], v[20:23], v[68:71]
    ds_read_b64_tr_b16 v[50:51], v13 offset:25088
    s_waitcnt lgkmcnt(4)
    v_mfma_f32_16x16x32_bf16 v[76:79], v[44:47], v[20:23], v[76:79]
    ds_read_b64_tr_b16 v[52:53], v14 offset:24576
    v_mfma_f32_16x16x32_bf16 v[64:67], v[36:39], v[24:27], v[64:67]
    ds_read_b64_tr_b16 v[54:55], v14 offset:25088
    v_mfma_f32_16x16x32_bf16 v[72:75], v[40:43], v[24:27], v[72:75]
    v_mfma_f32_16x16x32_bf16 v[80:83], v[44:47], v[24:27], v[80:83]
    s_waitcnt lgkmcnt(5)
    v_mfma_f32_16x16x32_bf16 v[100:103], v[36:39], v[28:31], v[100:103]
    v_mfma_f32_16x16x32_bf16 v[108:111], v[40:43], v[28:31], v[108:111]
    v_mfma_f32_16x16x32_bf16 v[116:119], v[44:47], v[28:31], v[116:119]
    s_waitcnt lgkmcnt(4)
    v_mfma_f32_16x16x32_bf16 v[104:107], v[36:39], v[32:35], v[104:107]
    v_mfma_f32_16x16x32_bf16 v[112:115], v[40:43], v[32:35], v[112:115]
    v_mfma_f32_16x16x32_bf16 v[120:123], v[44:47], v[32:35], v[120:123]
    s_waitcnt lgkmcnt(2)
    v_mfma_f32_16x16x32_bf16 v[84:87], v[48:51], v[20:23], v[84:87]
    ds_read_b64_tr_b16 v[36:37], v15 offset:0
    s_waitcnt lgkmcnt(1)
    v_mfma_f32_16x16x32_bf16 v[92:95], v[52:55], v[20:23], v[92:95]
    ds_read_b64_tr_b16 v[38:39], v15 offset:512
    ds_read_b128 v[20:23], v8 offset:0
    v_mfma_f32_16x16x32_bf16 v[88:91], v[48:51], v[24:27], v[88:91]
    ds_read_b64_tr_b16 v[40:41], v16 offset:0
    v_mfma_f32_16x16x32_bf16 v[96:99], v[52:55], v[24:27], v[96:99]
    ds_read_b64_tr_b16 v[42:43], v16 offset:512
    ds_read_b128 v[24:27], v8 offset:2048
    v_mfma_f32_16x16x32_bf16 v[124:127], v[48:51], v[28:31], v[124:127]
    ds_read_b64_tr_b16 v[44:45], v17 offset:0
    v_mfma_f32_16x16x32_bf16 v[132:135], v[52:55], v[28:31], v[132:135]
    ds_read_b64_tr_b16 v[46:47], v17 offset:512
    ds_read_b128 v[28:31], v8 offset:4096
    v_mfma_f32_16x16x32_bf16 v[128:131], v[48:51], v[32:35], v[128:131]
    v_mfma_f32_16x16x32_bf16 v[136:139], v[52:55], v[32:35], v[136:139]
    ds_read_b128 v[32:35], v8 offset:6144
    s_waitcnt lgkmcnt(7)
    v_mfma_f32_16x16x32_bf16 v[60:63], v[36:39], v[20:23], v[60:63]
    ds_read_b64_tr_b16 v[48:49], v18 offset:0
    s_waitcnt lgkmcnt(6)
    v_mfma_f32_16x16x32_bf16 v[68:71], v[40:43], v[20:23], v[68:71]
    ds_read_b64_tr_b16 v[50:51], v18 offset:512
    s_waitcnt lgkmcnt(4)
    v_mfma_f32_16x16x32_bf16 v[76:79], v[44:47], v[20:23], v[76:79]
    ds_read_b64_tr_b16 v[52:53], v19 offset:0
    v_mfma_f32_16x16x32_bf16 v[64:67], v[36:39], v[24:27], v[64:67]
    ds_read_b64_tr_b16 v[54:55], v19 offset:512
    v_mfma_f32_16x16x32_bf16 v[72:75], v[40:43], v[24:27], v[72:75]
    v_mfma_f32_16x16x32_bf16 v[80:83], v[44:47], v[24:27], v[80:83]
    s_waitcnt lgkmcnt(5)
    v_mfma_f32_16x16x32_bf16 v[100:103], v[36:39], v[28:31], v[100:103]
    v_mfma_f32_16x16x32_bf16 v[108:111], v[40:43], v[28:31], v[108:111]
    v_mfma_f32_16x16x32_bf16 v[116:119], v[44:47], v[28:31], v[116:119]
    s_waitcnt lgkmcnt(4)
    v_mfma_f32_16x16x32_bf16 v[104:107], v[36:39], v[32:35], v[104:107]
    v_mfma_f32_16x16x32_bf16 v[112:115], v[40:43], v[32:35], v[112:115]
    v_mfma_f32_16x16x32_bf16 v[120:123], v[44:47], v[32:35], v[120:123]
    s_waitcnt lgkmcnt(2)
    v_mfma_f32_16x16x32_bf16 v[84:87], v[48:51], v[20:23], v[84:87]
    ds_read_b64_tr_b16 v[36:37], v15 offset:24576
    s_waitcnt lgkmcnt(1)
    v_mfma_f32_16x16x32_bf16 v[92:95], v[52:55], v[20:23], v[92:95]
    ds_read_b64_tr_b16 v[38:39], v15 offset:25088
    ds_read_b128 v[20:23], v9 offset:0
    v_mfma_f32_16x16x32_bf16 v[88:91], v[48:51], v[24:27], v[88:91]
    ds_read_b64_tr_b16 v[40:41], v16 offset:24576
    v_mfma_f32_16x16x32_bf16 v[96:99], v[52:55], v[24:27], v[96:99]
    ds_read_b64_tr_b16 v[42:43], v16 offset:25088
    ds_read_b128 v[24:27], v9 offset:2048
    v_mfma_f32_16x16x32_bf16 v[124:127], v[48:51], v[28:31], v[124:127]
    ds_read_b64_tr_b16 v[44:45], v17 offset:24576
    v_mfma_f32_16x16x32_bf16 v[132:135], v[52:55], v[28:31], v[132:135]
    ds_read_b64_tr_b16 v[46:47], v17 offset:25088
    ds_read_b128 v[28:31], v9 offset:4096
    v_mfma_f32_16x16x32_bf16 v[128:131], v[48:51], v[32:35], v[128:131]
    v_mfma_f32_16x16x32_bf16 v[136:139], v[52:55], v[32:35], v[136:139]
    ds_read_b128 v[32:35], v9 offset:6144
    s_waitcnt lgkmcnt(7)
    v_mfma_f32_16x16x32_bf16 v[60:63], v[36:39], v[20:23], v[60:63]
    ds_read_b64_tr_b16 v[48:49], v18 offset:24576
    s_waitcnt lgkmcnt(6)
    v_mfma_f32_16x16x32_bf16 v[68:71], v[40:43], v[20:23], v[68:71]
    ds_read_b64_tr_b16 v[50:51], v18 offset:25088
    s_waitcnt lgkmcnt(4)
    v_mfma_f32_16x16x32_bf16 v[76:79], v[44:47], v[20:23], v[76:79]
    ds_read_b64_tr_b16 v[52:53], v19 offset:24576
    v_mfma_f32_16x16x32_bf16 v[64:67], v[36:39], v[24:27], v[64:67]
    ds_read_b64_tr_b16 v[54:55], v19 offset:25088
    v_mfma_f32_16x16x32_bf16 v[72:75], v[40:43], v[24:27], v[72:75]
    v_mfma_f32_16x16x32_bf16 v[80:83], v[44:47], v[24:27], v[80:83]
    s_waitcnt lgkmcnt(5)
    v_mfma_f32_16x16x32_bf16 v[100:103], v[36:39], v[28:31], v[100:103]
    v_mfma_f32_16x16x32_bf16 v[108:111], v[40:43], v[28:31], v[108:111]
    v_mfma_f32_16x16x32_bf16 v[116:119], v[44:47], v[28:31], v[116:119]
    s_waitcnt lgkmcnt(4)
    v_mfma_f32_16x16x32_bf16 v[104:107], v[36:39], v[32:35], v[104:107]
    v_mfma_f32_16x16x32_bf16 v[112:115], v[40:43], v[32:35], v[112:115]
    v_mfma_f32_16x16x32_bf16 v[120:123], v[44:47], v[32:35], v[120:123]
    s_waitcnt lgkmcnt(2)
    v_mfma_f32_16x16x32_bf16 v[84:87], v[48:51], v[20:23], v[84:87]
    s_waitcnt lgkmcnt(0)
    v_mfma_f32_16x16x32_bf16 v[92:95], v[52:55], v[20:23], v[92:95]
    v_mfma_f32_16x16x32_bf16 v[88:91], v[48:51], v[24:27], v[88:91]
    v_mfma_f32_16x16x32_bf16 v[96:99], v[52:55], v[24:27], v[96:99]
    v_mfma_f32_16x16x32_bf16 v[124:127], v[48:51], v[28:31], v[124:127]
    v_mfma_f32_16x16x32_bf16 v[132:135], v[52:55], v[28:31], v[132:135]
    v_mfma_f32_16x16x32_bf16 v[128:131], v[48:51], v[32:35], v[128:131]
    v_mfma_f32_16x16x32_bf16 v[136:139], v[52:55], v[32:35], v[136:139]
    s_waitcnt vmcnt(0)
    s_and_b32 s41, s39, 1
    s_lshl_b32 s41, s41, 2
    s_add_u32 s41, s41, s53
    s_mul_i32 s41, s41, 327680
    s_lshl_b32 s42, s40, 1
    s_add_u32 s42, s42, s52
    s_mul_i32 s42, s42, 2560
    s_add_u32 s41, s41, s42
    s_lshr_b32 s42, s39, 1
    s_mul_i32 s42, s42, 2621440
    s_add_u32 s41, s41, s42
    v_and_b32 v5, 15, v1
    v_bfe_u32 v6, v1, 4, 1
    v_mul_u32_u24 v3, 81920, v6
    v_lshl_add_u32 v3, v5, 4, v3
    v_add_u32 v3, 1024, v3
    v_lshrrev_b32 v4, 5, v1
    v_and_b32 v2, 31, v1
    s_mov_b32 s50, -1
    s_mov_b32 s51, 0
    s_cmp_lt_u32 s39, 2
    s_cbranch_scc1 gated_mix__softmax_full_mha__glu_gated_glu__prompt_kernel_isq
    v_and_b32 v2, 7, v1
    v_lshl_or_b32 v2, v6, 3, v2
    v_bfe_u32 v6, v1, 3, 1
    v_lshl_or_b32 v2, v6, 4, v2
    v_lshlrev_b32 v2, 4, v2
    v_cvt_pk_bf16_f32 v20, v60, v61
    v_cvt_pk_bf16_f32 v21, v62, v63
    v_cvt_pk_bf16_f32 v22, v64, v65
    v_cvt_pk_bf16_f32 v23, v66, v67
    s_mov_b32 s43, 512
    s_add_u32 s42, s41, 0
    v_mad_i32_i24 v5, v4, s43, v2
    v_permlane16_swap_b32 v20, v22
    v_permlane16_swap_b32 v21, v23
    buffer_store_dwordx4 v[20:23], v5, s[32:35], s42 offen offset:0 sc1
    v_cvt_pk_bf16_f32 v24, v100, v101
    v_cvt_pk_bf16_f32 v25, v102, v103
    v_cvt_pk_bf16_f32 v26, v104, v105
    v_cvt_pk_bf16_f32 v27, v106, v107
    s_nop 1
    v_permlane16_swap_b32 v24, v26
    v_permlane16_swap_b32 v25, v27
    buffer_store_dwordx4 v[24:27], v5, s[32:35], s42 offen offset:1280 sc1
    v_cvt_pk_bf16_f32 v28, v68, v69
    v_cvt_pk_bf16_f32 v29, v70, v71
    v_cvt_pk_bf16_f32 v30, v72, v73
    v_cvt_pk_bf16_f32 v31, v74, v75
    s_mov_b32 s43, 81920
    s_add_u32 s42, s41, 0
    v_cndmask_b32 v5, v2, v3, s[50:51]
    v_mad_i32_i24 v5, v4, s43, v5
    s_not_b64 exec, s[50:51]
    s_nop 0
    v_permlane16_swap_b32 v28, v30
    v_permlane16_swap_b32 v29, v31
    s_mov_b64 exec, -1
    buffer_store_dwordx4 v[28:31], v5, s[32:35], s42 offen offset:0 sc1
    v_cvt_pk_bf16_f32 v32, v108, v109
    v_cvt_pk_bf16_f32 v33, v110, v111
    v_cvt_pk_bf16_f32 v34, v112, v113
    v_cvt_pk_bf16_f32 v35, v114, v115
    s_not_b64 exec, s[50:51]
    s_nop 0
    v_permlane16_swap_b32 v32, v34
    v_permlane16_swap_b32 v33, v35
    s_mov_b64 exec, -1
    buffer_store_dwordx4 v[32:35], v5, s[32:35], s42 offen offset:1280 sc1
    v_cvt_pk_bf16_f32 v36, v76, v77
    v_cvt_pk_bf16_f32 v37, v78, v79
    v_cvt_pk_bf16_f32 v38, v80, v81
    v_cvt_pk_bf16_f32 v39, v82, v83
    s_mov_b32 s43, 81408
    s_add_u32 s42, s41, 82432
    v_mad_i32_i24 v5, v4, s43, v2
    v_permlane16_swap_b32 v36, v38
    v_permlane16_swap_b32 v37, v39
    buffer_store_dwordx4 v[36:39], v5, s[32:35], s42 offen offset:0 sc1
    v_cvt_pk_bf16_f32 v40, v116, v117
    v_cvt_pk_bf16_f32 v41, v118, v119
    v_cvt_pk_bf16_f32 v42, v120, v121
    v_cvt_pk_bf16_f32 v43, v122, v123
    s_nop 1
    v_permlane16_swap_b32 v40, v42
    v_permlane16_swap_b32 v41, v43
    buffer_store_dwordx4 v[40:43], v5, s[32:35], s42 offen offset:1280 sc1
    v_cvt_pk_bf16_f32 v44, v84, v85
    v_cvt_pk_bf16_f32 v45, v86, v87
    v_cvt_pk_bf16_f32 v46, v88, v89
    v_cvt_pk_bf16_f32 v47, v90, v91
    s_mov_b32 s43, -512
    s_add_u32 s42, s41, 164352
    v_cndmask_b32 v5, v3, v2, s[50:51]
    v_mad_i32_i24 v5, v4, s43, v5
    s_mov_b64 exec, s[50:51]
    s_nop 0
    v_permlane16_swap_b32 v44, v46
    v_permlane16_swap_b32 v45, v47
    s_mov_b64 exec, -1
    buffer_store_dwordx4 v[44:47], v5, s[32:35], s42 offen offset:0 sc1
    v_cvt_pk_bf16_f32 v48, v124, v125
    v_cvt_pk_bf16_f32 v49, v126, v127
    v_cvt_pk_bf16_f32 v50, v128, v129
    v_cvt_pk_bf16_f32 v51, v130, v131
    s_mov_b64 exec, s[50:51]
    s_nop 0
    v_permlane16_swap_b32 v48, v50
    v_permlane16_swap_b32 v49, v51
    s_mov_b64 exec, -1
    buffer_store_dwordx4 v[48:51], v5, s[32:35], s42 offen offset:1280 sc1
    v_cvt_pk_bf16_f32 v20, v92, v93
    v_cvt_pk_bf16_f32 v21, v94, v95
    v_cvt_pk_bf16_f32 v22, v96, v97
    v_cvt_pk_bf16_f32 v23, v98, v99
    s_mov_b32 s43, 512
    s_add_u32 s42, s41, 245760
    v_mad_i32_i24 v5, v4, s43, v2
    v_permlane16_swap_b32 v20, v22
    v_permlane16_swap_b32 v21, v23
    buffer_store_dwordx4 v[20:23], v5, s[32:35], s42 offen offset:0 sc1
    v_cvt_pk_bf16_f32 v24, v132, v133
    v_cvt_pk_bf16_f32 v25, v134, v135
    v_cvt_pk_bf16_f32 v26, v136, v137
    v_cvt_pk_bf16_f32 v27, v138, v139
    s_nop 1
    v_permlane16_swap_b32 v24, v26
    v_permlane16_swap_b32 v25, v27
    buffer_store_dwordx4 v[24:27], v5, s[32:35], s42 offen offset:1280 sc1
    s_branch gated_mix__softmax_full_mha__glu_gated_glu__prompt_kernel_qkdone
gated_mix__softmax_full_mha__glu_gated_glu__prompt_kernel_isq:
    s_mov_b32 s48, 0x3ea52b5c
    v_lshlrev_b32 v2, 4, v2
    v_mul_f32 v60, s48, v60
    v_mul_f32 v61, s48, v61
    v_mul_f32 v62, s48, v62
    v_mul_f32 v63, s48, v63
    v_mul_f32 v64, s48, v64
    v_mul_f32 v65, s48, v65
    v_mul_f32 v66, s48, v66
    v_mul_f32 v67, s48, v67
    v_cvt_pk_bf16_f32 v20, v60, v61
    v_cvt_pk_bf16_f32 v21, v62, v63
    v_cvt_pk_bf16_f32 v22, v64, v65
    v_cvt_pk_bf16_f32 v23, v66, v67
    s_mov_b32 s43, 512
    s_add_u32 s42, s41, 0
    v_mad_i32_i24 v5, v4, s43, v2
    v_permlane16_swap_b32 v20, v22
    v_permlane16_swap_b32 v21, v23
    buffer_store_dwordx4 v[20:23], v5, s[32:35], s42 offen offset:0 sc1
    v_mul_f32 v100, s48, v100
    v_mul_f32 v101, s48, v101
    v_mul_f32 v102, s48, v102
    v_mul_f32 v103, s48, v103
    v_mul_f32 v104, s48, v104
    v_mul_f32 v105, s48, v105
    v_mul_f32 v106, s48, v106
    v_mul_f32 v107, s48, v107
    v_cvt_pk_bf16_f32 v24, v100, v101
    v_cvt_pk_bf16_f32 v25, v102, v103
    v_cvt_pk_bf16_f32 v26, v104, v105
    v_cvt_pk_bf16_f32 v27, v106, v107
    s_nop 1
    v_permlane16_swap_b32 v24, v26
    v_permlane16_swap_b32 v25, v27
    buffer_store_dwordx4 v[24:27], v5, s[32:35], s42 offen offset:1280 sc1
    v_mul_f32 v68, s48, v68
    v_mul_f32 v69, s48, v69
    v_mul_f32 v70, s48, v70
    v_mul_f32 v71, s48, v71
    v_mul_f32 v72, s48, v72
    v_mul_f32 v73, s48, v73
    v_mul_f32 v74, s48, v74
    v_mul_f32 v75, s48, v75
    v_cvt_pk_bf16_f32 v28, v68, v69
    v_cvt_pk_bf16_f32 v29, v70, v71
    v_cvt_pk_bf16_f32 v30, v72, v73
    v_cvt_pk_bf16_f32 v31, v74, v75
    s_mov_b32 s43, 81920
    s_add_u32 s42, s41, 0
    v_cndmask_b32 v5, v2, v3, s[50:51]
    v_mad_i32_i24 v5, v4, s43, v5
    s_not_b64 exec, s[50:51]
    s_nop 0
    v_permlane16_swap_b32 v28, v30
    v_permlane16_swap_b32 v29, v31
    s_mov_b64 exec, -1
    buffer_store_dwordx4 v[28:31], v5, s[32:35], s42 offen offset:0 sc1
    v_mul_f32 v108, s48, v108
    v_mul_f32 v109, s48, v109
    v_mul_f32 v110, s48, v110
    v_mul_f32 v111, s48, v111
    v_mul_f32 v112, s48, v112
    v_mul_f32 v113, s48, v113
    v_mul_f32 v114, s48, v114
    v_mul_f32 v115, s48, v115
    v_cvt_pk_bf16_f32 v32, v108, v109
    v_cvt_pk_bf16_f32 v33, v110, v111
    v_cvt_pk_bf16_f32 v34, v112, v113
    v_cvt_pk_bf16_f32 v35, v114, v115
    s_not_b64 exec, s[50:51]
    s_nop 0
    v_permlane16_swap_b32 v32, v34
    v_permlane16_swap_b32 v33, v35
    s_mov_b64 exec, -1
    buffer_store_dwordx4 v[32:35], v5, s[32:35], s42 offen offset:1280 sc1
    v_mul_f32 v76, s48, v76
    v_mul_f32 v77, s48, v77
    v_mul_f32 v78, s48, v78
    v_mul_f32 v79, s48, v79
    v_mul_f32 v80, s48, v80
    v_mul_f32 v81, s48, v81
    v_mul_f32 v82, s48, v82
    v_mul_f32 v83, s48, v83
    v_cvt_pk_bf16_f32 v36, v76, v77
    v_cvt_pk_bf16_f32 v37, v78, v79
    v_cvt_pk_bf16_f32 v38, v80, v81
    v_cvt_pk_bf16_f32 v39, v82, v83
    s_mov_b32 s43, 81408
    s_add_u32 s42, s41, 82432
    v_mad_i32_i24 v5, v4, s43, v2
    v_permlane16_swap_b32 v36, v38
    v_permlane16_swap_b32 v37, v39
    buffer_store_dwordx4 v[36:39], v5, s[32:35], s42 offen offset:0 sc1
    v_mul_f32 v116, s48, v116
    v_mul_f32 v117, s48, v117
    v_mul_f32 v118, s48, v118
    v_mul_f32 v119, s48, v119
    v_mul_f32 v120, s48, v120
    v_mul_f32 v121, s48, v121
    v_mul_f32 v122, s48, v122
    v_mul_f32 v123, s48, v123
    v_cvt_pk_bf16_f32 v40, v116, v117
    v_cvt_pk_bf16_f32 v41, v118, v119
    v_cvt_pk_bf16_f32 v42, v120, v121
    v_cvt_pk_bf16_f32 v43, v122, v123
    s_nop 1
    v_permlane16_swap_b32 v40, v42
    v_permlane16_swap_b32 v41, v43
    buffer_store_dwordx4 v[40:43], v5, s[32:35], s42 offen offset:1280 sc1
    v_mul_f32 v84, s48, v84
    v_mul_f32 v85, s48, v85
    v_mul_f32 v86, s48, v86
    v_mul_f32 v87, s48, v87
    v_mul_f32 v88, s48, v88
    v_mul_f32 v89, s48, v89
    v_mul_f32 v90, s48, v90
    v_mul_f32 v91, s48, v91
    v_cvt_pk_bf16_f32 v44, v84, v85
    v_cvt_pk_bf16_f32 v45, v86, v87
    v_cvt_pk_bf16_f32 v46, v88, v89
    v_cvt_pk_bf16_f32 v47, v90, v91
    s_mov_b32 s43, -512
    s_add_u32 s42, s41, 164352
    v_cndmask_b32 v5, v3, v2, s[50:51]
    v_mad_i32_i24 v5, v4, s43, v5
    s_mov_b64 exec, s[50:51]
    s_nop 0
    v_permlane16_swap_b32 v44, v46
    v_permlane16_swap_b32 v45, v47
    s_mov_b64 exec, -1
    buffer_store_dwordx4 v[44:47], v5, s[32:35], s42 offen offset:0 sc1
    v_mul_f32 v124, s48, v124
    v_mul_f32 v125, s48, v125
    v_mul_f32 v126, s48, v126
    v_mul_f32 v127, s48, v127
    v_mul_f32 v128, s48, v128
    v_mul_f32 v129, s48, v129
    v_mul_f32 v130, s48, v130
    v_mul_f32 v131, s48, v131
    v_cvt_pk_bf16_f32 v48, v124, v125
    v_cvt_pk_bf16_f32 v49, v126, v127
    v_cvt_pk_bf16_f32 v50, v128, v129
    v_cvt_pk_bf16_f32 v51, v130, v131
    s_mov_b64 exec, s[50:51]
    s_nop 0
    v_permlane16_swap_b32 v48, v50
    v_permlane16_swap_b32 v49, v51
    s_mov_b64 exec, -1
    buffer_store_dwordx4 v[48:51], v5, s[32:35], s42 offen offset:1280 sc1
    v_mul_f32 v92, s48, v92
    v_mul_f32 v93, s48, v93
    v_mul_f32 v94, s48, v94
    v_mul_f32 v95, s48, v95
    v_mul_f32 v96, s48, v96
    v_mul_f32 v97, s48, v97
    v_mul_f32 v98, s48, v98
    v_mul_f32 v99, s48, v99
    v_cvt_pk_bf16_f32 v20, v92, v93
    v_cvt_pk_bf16_f32 v21, v94, v95
    v_cvt_pk_bf16_f32 v22, v96, v97
    v_cvt_pk_bf16_f32 v23, v98, v99
    s_mov_b32 s43, 512
    s_add_u32 s42, s41, 245760
    v_mad_i32_i24 v5, v4, s43, v2
    v_permlane16_swap_b32 v20, v22
    v_permlane16_swap_b32 v21, v23
    buffer_store_dwordx4 v[20:23], v5, s[32:35], s42 offen offset:0 sc1
    v_mul_f32 v132, s48, v132
    v_mul_f32 v133, s48, v133
    v_mul_f32 v134, s48, v134
    v_mul_f32 v135, s48, v135
    v_mul_f32 v136, s48, v136
    v_mul_f32 v137, s48, v137
    v_mul_f32 v138, s48, v138
    v_mul_f32 v139, s48, v139
    v_cvt_pk_bf16_f32 v24, v132, v133
    v_cvt_pk_bf16_f32 v25, v134, v135
    v_cvt_pk_bf16_f32 v26, v136, v137
    v_cvt_pk_bf16_f32 v27, v138, v139
    s_nop 1
    v_permlane16_swap_b32 v24, v26
    v_permlane16_swap_b32 v25, v27
    buffer_store_dwordx4 v[24:27], v5, s[32:35], s42 offen offset:1280 sc1
gated_mix__softmax_full_mha__glu_gated_glu__prompt_kernel_qkdone:
    s_waitcnt vmcnt(0)
    v_mov_b32 v2, 161792
    v_mov_b32 v3, 1
    s_mov_b64 exec, 1
    ds_add_rtn_u32 v4, v2, v3
    s_mov_b64 exec, -1
    v_lshlrev_b32 v2, 10, v1
    s_cmp_lt_u32 s45, 23232512
    s_cselect_b32 s42, 8, 1
    v_mov_b32 v5, 1073741824
    v_cmp_gt_u32 vcc, s42, v1
    s_nop 1
    v_cndmask_b32 v2, v5, v2, vcc
    s_waitcnt lgkmcnt(0)
    v_readfirstlane_b32 s41, v4
    s_nop 3
    s_cmp_lg_u32 s41, 7
    s_cbranch_scc1 gated_mix__softmax_full_mha__glu_gated_glu__prompt_kernel_pubqk
    buffer_store_dword v3, v2, s[32:35], s45 offen sc1
gated_mix__softmax_full_mha__glu_gated_glu__prompt_kernel_pubqk:
    s_branch gated_mix__softmax_full_mha__glu_gated_glu__prompt_kernel_att
gated_mix__softmax_full_mha__glu_gated_glu__prompt_kernel_v:
    s_waitcnt lgkmcnt(0)
    s_mov_b32 s32, s20
    s_mov_b32 s33, s21
    s_mov_b32 s34, 268435456
    s_mov_b32 s35, 0x00020000
    s_barrier
    ds_read_b128 v[20:23], v8 offset:0
    ds_read_b64_tr_b16 v[36:37], v10 offset:0
    ds_read_b64_tr_b16 v[38:39], v10 offset:512
    ds_read_b64_tr_b16 v[40:41], v11 offset:0
    ds_read_b64_tr_b16 v[42:43], v11 offset:512
    ds_read_b64_tr_b16 v[44:45], v12 offset:0
    ds_read_b64_tr_b16 v[46:47], v12 offset:512
    ds_read_b128 v[24:27], v8 offset:2048
    ds_read_b128 v[28:31], v8 offset:4096
    ds_read_b128 v[32:35], v8 offset:6144
    s_waitcnt lgkmcnt(9)
    s_waitcnt lgkmcnt(7)
    v_mfma_f32_16x16x32_bf16 v[60:63], v[20:23], v[36:39], 0
    ds_read_b64_tr_b16 v[48:49], v13 offset:0
    s_waitcnt lgkmcnt(6)
    v_mfma_f32_16x16x32_bf16 v[68:71], v[20:23], v[40:43], 0
    ds_read_b64_tr_b16 v[50:51], v13 offset:512
    s_waitcnt lgkmcnt(5)
    v_mfma_f32_16x16x32_bf16 v[76:79], v[20:23], v[44:47], 0
    ds_read_b64_tr_b16 v[52:53], v14 offset:0
    s_waitcnt lgkmcnt(5)
    v_mfma_f32_16x16x32_bf16 v[64:67], v[24:27], v[36:39], 0
    ds_read_b64_tr_b16 v[54:55], v14 offset:512
    v_mfma_f32_16x16x32_bf16 v[72:75], v[24:27], v[40:43], 0
    v_mfma_f32_16x16x32_bf16 v[80:83], v[24:27], v[44:47], 0
    s_waitcnt lgkmcnt(5)
    v_mfma_f32_16x16x32_bf16 v[100:103], v[28:31], v[36:39], 0
    v_mfma_f32_16x16x32_bf16 v[108:111], v[28:31], v[40:43], 0
    v_mfma_f32_16x16x32_bf16 v[116:119], v[28:31], v[44:47], 0
    s_waitcnt lgkmcnt(4)
    v_mfma_f32_16x16x32_bf16 v[104:107], v[32:35], v[36:39], 0
    v_mfma_f32_16x16x32_bf16 v[112:115], v[32:35], v[40:43], 0
    v_mfma_f32_16x16x32_bf16 v[120:123], v[32:35], v[44:47], 0
    s_waitcnt lgkmcnt(0)
    s_barrier
    v_mfma_f32_16x16x32_bf16 v[84:87], v[20:23], v[48:51], 0
    ds_read_b64_tr_b16 v[36:37], v10 offset:24576
    v_mfma_f32_16x16x32_bf16 v[92:95], v[20:23], v[52:55], 0
    ds_read_b64_tr_b16 v[38:39], v10 offset:25088
    ds_read_b128 v[20:23], v9 offset:0
    v_mfma_f32_16x16x32_bf16 v[88:91], v[24:27], v[48:51], 0
    ds_read_b64_tr_b16 v[40:41], v11 offset:24576
    v_mfma_f32_16x16x32_bf16 v[96:99], v[24:27], v[52:55], 0
    ds_read_b64_tr_b16 v[42:43], v11 offset:25088
    ds_read_b128 v[24:27], v9 offset:2048
    v_mfma_f32_16x16x32_bf16 v[124:127], v[28:31], v[48:51], 0
    ds_read_b64_tr_b16 v[44:45], v12 offset:24576
    v_mfma_f32_16x16x32_bf16 v[132:135], v[28:31], v[52:55], 0
    ds_read_b64_tr_b16 v[46:47], v12 offset:25088
    ds_read_b128 v[28:31], v9 offset:4096
    v_mfma_f32_16x16x32_bf16 v[128:131], v[32:35], v[48:51], 0
    v_mfma_f32_16x16x32_bf16 v[136:139], v[32:35], v[52:55], 0
    ds_read_b128 v[32:35], v9 offset:6144
    s_waitcnt lgkmcnt(7)
    v_mfma_f32_16x16x32_bf16 v[60:63], v[20:23], v[36:39], v[60:63]
    ds_read_b64_tr_b16 v[48:49], v13 offset:24576
    s_waitcnt lgkmcnt(6)
    v_mfma_f32_16x16x32_bf16 v[68:71], v[20:23], v[40:43], v[68:71]
    ds_read_b64_tr_b16 v[50:51], v13 offset:25088
    s_waitcnt lgkmcnt(4)
    v_mfma_f32_16x16x32_bf16 v[76:79], v[20:23], v[44:47], v[76:79]
    ds_read_b64_tr_b16 v[52:53], v14 offset:24576
    v_mfma_f32_16x16x32_bf16 v[64:67], v[24:27], v[36:39], v[64:67]
    ds_read_b64_tr_b16 v[54:55], v14 offset:25088
    v_mfma_f32_16x16x32_bf16 v[72:75], v[24:27], v[40:43], v[72:75]
    v_mfma_f32_16x16x32_bf16 v[80:83], v[24:27], v[44:47], v[80:83]
    s_waitcnt lgkmcnt(5)
    v_mfma_f32_16x16x32_bf16 v[100:103], v[28:31], v[36:39], v[100:103]
    v_mfma_f32_16x16x32_bf16 v[108:111], v[28:31], v[40:43], v[108:111]
    v_mfma_f32_16x16x32_bf16 v[116:119], v[28:31], v[44:47], v[116:119]
    s_waitcnt lgkmcnt(4)
    v_mfma_f32_16x16x32_bf16 v[104:107], v[32:35], v[36:39], v[104:107]
    v_mfma_f32_16x16x32_bf16 v[112:115], v[32:35], v[40:43], v[112:115]
    v_mfma_f32_16x16x32_bf16 v[120:123], v[32:35], v[44:47], v[120:123]
    s_waitcnt lgkmcnt(0)
    s_barrier
    v_mfma_f32_16x16x32_bf16 v[84:87], v[20:23], v[48:51], v[84:87]
    ds_read_b64_tr_b16 v[36:37], v15 offset:0
    v_mfma_f32_16x16x32_bf16 v[92:95], v[20:23], v[52:55], v[92:95]
    ds_read_b64_tr_b16 v[38:39], v15 offset:512
    ds_read_b128 v[20:23], v8 offset:32768
    v_mfma_f32_16x16x32_bf16 v[88:91], v[24:27], v[48:51], v[88:91]
    ds_read_b64_tr_b16 v[40:41], v16 offset:0
    v_mfma_f32_16x16x32_bf16 v[96:99], v[24:27], v[52:55], v[96:99]
    ds_read_b64_tr_b16 v[42:43], v16 offset:512
    ds_read_b128 v[24:27], v8 offset:34816
    v_mfma_f32_16x16x32_bf16 v[124:127], v[28:31], v[48:51], v[124:127]
    ds_read_b64_tr_b16 v[44:45], v17 offset:0
    v_mfma_f32_16x16x32_bf16 v[132:135], v[28:31], v[52:55], v[132:135]
    ds_read_b64_tr_b16 v[46:47], v17 offset:512
    ds_read_b128 v[28:31], v8 offset:36864
    v_mfma_f32_16x16x32_bf16 v[128:131], v[32:35], v[48:51], v[128:131]
    v_mfma_f32_16x16x32_bf16 v[136:139], v[32:35], v[52:55], v[136:139]
    ds_read_b128 v[32:35], v8 offset:38912
    s_waitcnt lgkmcnt(7)
    v_mfma_f32_16x16x32_bf16 v[60:63], v[20:23], v[36:39], v[60:63]
    ds_read_b64_tr_b16 v[48:49], v18 offset:0
    s_waitcnt lgkmcnt(6)
    v_mfma_f32_16x16x32_bf16 v[68:71], v[20:23], v[40:43], v[68:71]
    ds_read_b64_tr_b16 v[50:51], v18 offset:512
    s_waitcnt lgkmcnt(4)
    v_mfma_f32_16x16x32_bf16 v[76:79], v[20:23], v[44:47], v[76:79]
    ds_read_b64_tr_b16 v[52:53], v19 offset:0
    v_mfma_f32_16x16x32_bf16 v[64:67], v[24:27], v[36:39], v[64:67]
    ds_read_b64_tr_b16 v[54:55], v19 offset:512
    v_mfma_f32_16x16x32_bf16 v[72:75], v[24:27], v[40:43], v[72:75]
    v_mfma_f32_16x16x32_bf16 v[80:83], v[24:27], v[44:47], v[80:83]
    s_waitcnt lgkmcnt(5)
    v_mfma_f32_16x16x32_bf16 v[100:103], v[28:31], v[36:39], v[100:103]
    v_mfma_f32_16x16x32_bf16 v[108:111], v[28:31], v[40:43], v[108:111]
    v_mfma_f32_16x16x32_bf16 v[116:119], v[28:31], v[44:47], v[116:119]
    s_waitcnt lgkmcnt(4)
    v_mfma_f32_16x16x32_bf16 v[104:107], v[32:35], v[36:39], v[104:107]
    v_mfma_f32_16x16x32_bf16 v[112:115], v[32:35], v[40:43], v[112:115]
    v_mfma_f32_16x16x32_bf16 v[120:123], v[32:35], v[44:47], v[120:123]
    s_waitcnt lgkmcnt(0)
    s_barrier
    v_mfma_f32_16x16x32_bf16 v[84:87], v[20:23], v[48:51], v[84:87]
    ds_read_b64_tr_b16 v[36:37], v15 offset:24576
    v_mfma_f32_16x16x32_bf16 v[92:95], v[20:23], v[52:55], v[92:95]
    ds_read_b64_tr_b16 v[38:39], v15 offset:25088
    ds_read_b128 v[20:23], v9 offset:32768
    v_mfma_f32_16x16x32_bf16 v[88:91], v[24:27], v[48:51], v[88:91]
    ds_read_b64_tr_b16 v[40:41], v16 offset:24576
    v_mfma_f32_16x16x32_bf16 v[96:99], v[24:27], v[52:55], v[96:99]
    ds_read_b64_tr_b16 v[42:43], v16 offset:25088
    ds_read_b128 v[24:27], v9 offset:34816
    v_mfma_f32_16x16x32_bf16 v[124:127], v[28:31], v[48:51], v[124:127]
    ds_read_b64_tr_b16 v[44:45], v17 offset:24576
    v_mfma_f32_16x16x32_bf16 v[132:135], v[28:31], v[52:55], v[132:135]
    ds_read_b64_tr_b16 v[46:47], v17 offset:25088
    ds_read_b128 v[28:31], v9 offset:36864
    v_mfma_f32_16x16x32_bf16 v[128:131], v[32:35], v[48:51], v[128:131]
    v_mfma_f32_16x16x32_bf16 v[136:139], v[32:35], v[52:55], v[136:139]
    ds_read_b128 v[32:35], v9 offset:38912
    s_waitcnt lgkmcnt(7)
    v_mfma_f32_16x16x32_bf16 v[60:63], v[20:23], v[36:39], v[60:63]
    ds_read_b64_tr_b16 v[48:49], v18 offset:24576
    s_waitcnt lgkmcnt(6)
    v_mfma_f32_16x16x32_bf16 v[68:71], v[20:23], v[40:43], v[68:71]
    ds_read_b64_tr_b16 v[50:51], v18 offset:25088
    s_waitcnt lgkmcnt(4)
    v_mfma_f32_16x16x32_bf16 v[76:79], v[20:23], v[44:47], v[76:79]
    ds_read_b64_tr_b16 v[52:53], v19 offset:24576
    v_mfma_f32_16x16x32_bf16 v[64:67], v[24:27], v[36:39], v[64:67]
    ds_read_b64_tr_b16 v[54:55], v19 offset:25088
    v_mfma_f32_16x16x32_bf16 v[72:75], v[24:27], v[40:43], v[72:75]
    v_mfma_f32_16x16x32_bf16 v[80:83], v[24:27], v[44:47], v[80:83]
    s_waitcnt lgkmcnt(5)
    v_mfma_f32_16x16x32_bf16 v[100:103], v[28:31], v[36:39], v[100:103]
    v_mfma_f32_16x16x32_bf16 v[108:111], v[28:31], v[40:43], v[108:111]
    v_mfma_f32_16x16x32_bf16 v[116:119], v[28:31], v[44:47], v[116:119]
    s_waitcnt lgkmcnt(4)
    v_mfma_f32_16x16x32_bf16 v[104:107], v[32:35], v[36:39], v[104:107]
    v_mfma_f32_16x16x32_bf16 v[112:115], v[32:35], v[40:43], v[112:115]
    v_mfma_f32_16x16x32_bf16 v[120:123], v[32:35], v[44:47], v[120:123]
    s_waitcnt lgkmcnt(0)
    s_barrier
    v_mfma_f32_16x16x32_bf16 v[84:87], v[20:23], v[48:51], v[84:87]
    ds_read_b64_tr_b16 v[36:37], v10 offset:0
    v_mfma_f32_16x16x32_bf16 v[92:95], v[20:23], v[52:55], v[92:95]
    ds_read_b64_tr_b16 v[38:39], v10 offset:512
    ds_read_b128 v[20:23], v8 offset:16384
    v_mfma_f32_16x16x32_bf16 v[88:91], v[24:27], v[48:51], v[88:91]
    ds_read_b64_tr_b16 v[40:41], v11 offset:0
    v_mfma_f32_16x16x32_bf16 v[96:99], v[24:27], v[52:55], v[96:99]
    ds_read_b64_tr_b16 v[42:43], v11 offset:512
    ds_read_b128 v[24:27], v8 offset:18432
    v_mfma_f32_16x16x32_bf16 v[124:127], v[28:31], v[48:51], v[124:127]
    ds_read_b64_tr_b16 v[44:45], v12 offset:0
    v_mfma_f32_16x16x32_bf16 v[132:135], v[28:31], v[52:55], v[132:135]
    ds_read_b64_tr_b16 v[46:47], v12 offset:512
    ds_read_b128 v[28:31], v8 offset:20480
    v_mfma_f32_16x16x32_bf16 v[128:131], v[32:35], v[48:51], v[128:131]
    v_mfma_f32_16x16x32_bf16 v[136:139], v[32:35], v[52:55], v[136:139]
    ds_read_b128 v[32:35], v8 offset:22528
    s_waitcnt lgkmcnt(7)
    v_mfma_f32_16x16x32_bf16 v[60:63], v[20:23], v[36:39], v[60:63]
    ds_read_b64_tr_b16 v[48:49], v13 offset:0
    s_waitcnt lgkmcnt(6)
    v_mfma_f32_16x16x32_bf16 v[68:71], v[20:23], v[40:43], v[68:71]
    ds_read_b64_tr_b16 v[50:51], v13 offset:512
    s_waitcnt lgkmcnt(4)
    v_mfma_f32_16x16x32_bf16 v[76:79], v[20:23], v[44:47], v[76:79]
    ds_read_b64_tr_b16 v[52:53], v14 offset:0
    v_mfma_f32_16x16x32_bf16 v[64:67], v[24:27], v[36:39], v[64:67]
    ds_read_b64_tr_b16 v[54:55], v14 offset:512
    v_mfma_f32_16x16x32_bf16 v[72:75], v[24:27], v[40:43], v[72:75]
    v_mfma_f32_16x16x32_bf16 v[80:83], v[24:27], v[44:47], v[80:83]
    s_waitcnt lgkmcnt(5)
    v_mfma_f32_16x16x32_bf16 v[100:103], v[28:31], v[36:39], v[100:103]
    v_mfma_f32_16x16x32_bf16 v[108:111], v[28:31], v[40:43], v[108:111]
    v_mfma_f32_16x16x32_bf16 v[116:119], v[28:31], v[44:47], v[116:119]
    s_waitcnt lgkmcnt(4)
    v_mfma_f32_16x16x32_bf16 v[104:107], v[32:35], v[36:39], v[104:107]
    v_mfma_f32_16x16x32_bf16 v[112:115], v[32:35], v[40:43], v[112:115]
    v_mfma_f32_16x16x32_bf16 v[120:123], v[32:35], v[44:47], v[120:123]
    s_waitcnt lgkmcnt(0)
    s_barrier
    v_mfma_f32_16x16x32_bf16 v[84:87], v[20:23], v[48:51], v[84:87]
    ds_read_b64_tr_b16 v[36:37], v10 offset:24576
    v_mfma_f32_16x16x32_bf16 v[92:95], v[20:23], v[52:55], v[92:95]
    ds_read_b64_tr_b16 v[38:39], v10 offset:25088
    ds_read_b128 v[20:23], v9 offset:16384
    v_mfma_f32_16x16x32_bf16 v[88:91], v[24:27], v[48:51], v[88:91]
    ds_read_b64_tr_b16 v[40:41], v11 offset:24576
    v_mfma_f32_16x16x32_bf16 v[96:99], v[24:27], v[52:55], v[96:99]
    ds_read_b64_tr_b16 v[42:43], v11 offset:25088
    ds_read_b128 v[24:27], v9 offset:18432
    v_mfma_f32_16x16x32_bf16 v[124:127], v[28:31], v[48:51], v[124:127]
    ds_read_b64_tr_b16 v[44:45], v12 offset:24576
    v_mfma_f32_16x16x32_bf16 v[132:135], v[28:31], v[52:55], v[132:135]
    ds_read_b64_tr_b16 v[46:47], v12 offset:25088
    ds_read_b128 v[28:31], v9 offset:20480
    v_mfma_f32_16x16x32_bf16 v[128:131], v[32:35], v[48:51], v[128:131]
    v_mfma_f32_16x16x32_bf16 v[136:139], v[32:35], v[52:55], v[136:139]
    ds_read_b128 v[32:35], v9 offset:22528
    s_cmp_lg_u32 s38, 0
    s_cbranch_scc1 gated_mix__softmax_full_mha__glu_gated_glu__prompt_kernel_cntv
    s_cmp_ge_u32 s2, 44
    s_cbranch_scc1 gated_mix__softmax_full_mha__glu_gated_glu__prompt_kernel_cntv
    s_mov_b32 s56, s96
    s_mov_b32 s57, s97
    s_mov_b32 s58, 256
    s_mov_b32 s59, 0x00020000
    v_mov_b32 v2, 0
    v_mov_b32 v3, 1
    s_waitcnt vmcnt(0)
    s_mov_b64 exec, 1
    buffer_atomic_add v3, v2, s[56:59], 0 offen
    s_mov_b64 exec, -1
gated_mix__softmax_full_mha__glu_gated_glu__prompt_kernel_cntv:
    s_waitcnt lgkmcnt(7)
    v_mfma_f32_16x16x32_bf16 v[60:63], v[20:23], v[36:39], v[60:63]
    ds_read_b64_tr_b16 v[48:49], v13 offset:24576
    s_waitcnt lgkmcnt(6)
    v_mfma_f32_16x16x32_bf16 v[68:71], v[20:23], v[40:43], v[68:71]
    ds_read_b64_tr_b16 v[50:51], v13 offset:25088
    s_waitcnt lgkmcnt(4)
    v_mfma_f32_16x16x32_bf16 v[76:79], v[20:23], v[44:47], v[76:79]
    ds_read_b64_tr_b16 v[52:53], v14 offset:24576
    v_mfma_f32_16x16x32_bf16 v[64:67], v[24:27], v[36:39], v[64:67]
    ds_read_b64_tr_b16 v[54:55], v14 offset:25088
    v_mfma_f32_16x16x32_bf16 v[72:75], v[24:27], v[40:43], v[72:75]
    v_mfma_f32_16x16x32_bf16 v[80:83], v[24:27], v[44:47], v[80:83]
    s_waitcnt lgkmcnt(5)
    v_mfma_f32_16x16x32_bf16 v[100:103], v[28:31], v[36:39], v[100:103]
    v_mfma_f32_16x16x32_bf16 v[108:111], v[28:31], v[40:43], v[108:111]
    v_mfma_f32_16x16x32_bf16 v[116:119], v[28:31], v[44:47], v[116:119]
    s_waitcnt lgkmcnt(4)
    v_mfma_f32_16x16x32_bf16 v[104:107], v[32:35], v[36:39], v[104:107]
    v_mfma_f32_16x16x32_bf16 v[112:115], v[32:35], v[40:43], v[112:115]
    v_mfma_f32_16x16x32_bf16 v[120:123], v[32:35], v[44:47], v[120:123]
    s_waitcnt lgkmcnt(0)
    s_barrier
    v_mfma_f32_16x16x32_bf16 v[84:87], v[20:23], v[48:51], v[84:87]
    ds_read_b64_tr_b16 v[36:37], v15 offset:0
    v_mfma_f32_16x16x32_bf16 v[92:95], v[20:23], v[52:55], v[92:95]
    ds_read_b64_tr_b16 v[38:39], v15 offset:512
    ds_read_b128 v[20:23], v8 offset:0
    v_mfma_f32_16x16x32_bf16 v[88:91], v[24:27], v[48:51], v[88:91]
    ds_read_b64_tr_b16 v[40:41], v16 offset:0
    v_mfma_f32_16x16x32_bf16 v[96:99], v[24:27], v[52:55], v[96:99]
    ds_read_b64_tr_b16 v[42:43], v16 offset:512
    ds_read_b128 v[24:27], v8 offset:2048
    v_mfma_f32_16x16x32_bf16 v[124:127], v[28:31], v[48:51], v[124:127]
    ds_read_b64_tr_b16 v[44:45], v17 offset:0
    v_mfma_f32_16x16x32_bf16 v[132:135], v[28:31], v[52:55], v[132:135]
    ds_read_b64_tr_b16 v[46:47], v17 offset:512
    ds_read_b128 v[28:31], v8 offset:4096
    v_mfma_f32_16x16x32_bf16 v[128:131], v[32:35], v[48:51], v[128:131]
    v_mfma_f32_16x16x32_bf16 v[136:139], v[32:35], v[52:55], v[136:139]
    ds_read_b128 v[32:35], v8 offset:6144
    s_waitcnt lgkmcnt(7)
    v_mfma_f32_16x16x32_bf16 v[60:63], v[20:23], v[36:39], v[60:63]
    ds_read_b64_tr_b16 v[48:49], v18 offset:0
    s_waitcnt lgkmcnt(6)
    v_mfma_f32_16x16x32_bf16 v[68:71], v[20:23], v[40:43], v[68:71]
    ds_read_b64_tr_b16 v[50:51], v18 offset:512
    s_waitcnt lgkmcnt(4)
    v_mfma_f32_16x16x32_bf16 v[76:79], v[20:23], v[44:47], v[76:79]
    ds_read_b64_tr_b16 v[52:53], v19 offset:0
    v_mfma_f32_16x16x32_bf16 v[64:67], v[24:27], v[36:39], v[64:67]
    ds_read_b64_tr_b16 v[54:55], v19 offset:512
    v_mfma_f32_16x16x32_bf16 v[72:75], v[24:27], v[40:43], v[72:75]
    v_mfma_f32_16x16x32_bf16 v[80:83], v[24:27], v[44:47], v[80:83]
    s_waitcnt lgkmcnt(5)
    v_mfma_f32_16x16x32_bf16 v[100:103], v[28:31], v[36:39], v[100:103]
    v_mfma_f32_16x16x32_bf16 v[108:111], v[28:31], v[40:43], v[108:111]
    v_mfma_f32_16x16x32_bf16 v[116:119], v[28:31], v[44:47], v[116:119]
    s_waitcnt lgkmcnt(4)
    v_mfma_f32_16x16x32_bf16 v[104:107], v[32:35], v[36:39], v[104:107]
    v_mfma_f32_16x16x32_bf16 v[112:115], v[32:35], v[40:43], v[112:115]
    v_mfma_f32_16x16x32_bf16 v[120:123], v[32:35], v[44:47], v[120:123]
    s_waitcnt lgkmcnt(0)
    s_barrier
    v_mfma_f32_16x16x32_bf16 v[84:87], v[20:23], v[48:51], v[84:87]
    ds_read_b64_tr_b16 v[36:37], v15 offset:24576
    v_mfma_f32_16x16x32_bf16 v[92:95], v[20:23], v[52:55], v[92:95]
    ds_read_b64_tr_b16 v[38:39], v15 offset:25088
    ds_read_b128 v[20:23], v9 offset:0
    v_mfma_f32_16x16x32_bf16 v[88:91], v[24:27], v[48:51], v[88:91]
    ds_read_b64_tr_b16 v[40:41], v16 offset:24576
    v_mfma_f32_16x16x32_bf16 v[96:99], v[24:27], v[52:55], v[96:99]
    ds_read_b64_tr_b16 v[42:43], v16 offset:25088
    ds_read_b128 v[24:27], v9 offset:2048
    v_mfma_f32_16x16x32_bf16 v[124:127], v[28:31], v[48:51], v[124:127]
    ds_read_b64_tr_b16 v[44:45], v17 offset:24576
    v_mfma_f32_16x16x32_bf16 v[132:135], v[28:31], v[52:55], v[132:135]
    ds_read_b64_tr_b16 v[46:47], v17 offset:25088
    ds_read_b128 v[28:31], v9 offset:4096
    v_mfma_f32_16x16x32_bf16 v[128:131], v[32:35], v[48:51], v[128:131]
    v_mfma_f32_16x16x32_bf16 v[136:139], v[32:35], v[52:55], v[136:139]
    ds_read_b128 v[32:35], v9 offset:6144
    s_waitcnt lgkmcnt(7)
    v_mfma_f32_16x16x32_bf16 v[60:63], v[20:23], v[36:39], v[60:63]
    ds_read_b64_tr_b16 v[48:49], v18 offset:24576
    s_waitcnt lgkmcnt(6)
    v_mfma_f32_16x16x32_bf16 v[68:71], v[20:23], v[40:43], v[68:71]
    ds_read_b64_tr_b16 v[50:51], v18 offset:25088
    s_waitcnt lgkmcnt(4)
    v_mfma_f32_16x16x32_bf16 v[76:79], v[20:23], v[44:47], v[76:79]
    ds_read_b64_tr_b16 v[52:53], v19 offset:24576
    v_mfma_f32_16x16x32_bf16 v[64:67], v[24:27], v[36:39], v[64:67]
    ds_read_b64_tr_b16 v[54:55], v19 offset:25088
    v_mfma_f32_16x16x32_bf16 v[72:75], v[24:27], v[40:43], v[72:75]
    v_mfma_f32_16x16x32_bf16 v[80:83], v[24:27], v[44:47], v[80:83]
    s_waitcnt lgkmcnt(5)
    v_mfma_f32_16x16x32_bf16 v[100:103], v[28:31], v[36:39], v[100:103]
    v_mfma_f32_16x16x32_bf16 v[108:111], v[28:31], v[40:43], v[108:111]
    v_mfma_f32_16x16x32_bf16 v[116:119], v[28:31], v[44:47], v[116:119]
    s_waitcnt lgkmcnt(4)
    v_mfma_f32_16x16x32_bf16 v[104:107], v[32:35], v[36:39], v[104:107]
    v_mfma_f32_16x16x32_bf16 v[112:115], v[32:35], v[40:43], v[112:115]
    v_mfma_f32_16x16x32_bf16 v[120:123], v[32:35], v[44:47], v[120:123]
    s_waitcnt lgkmcnt(0)
    s_barrier
    v_mfma_f32_16x16x32_bf16 v[84:87], v[20:23], v[48:51], v[84:87]
    ds_read_b64_tr_b16 v[36:37], v10 offset:0
    v_mfma_f32_16x16x32_bf16 v[92:95], v[20:23], v[52:55], v[92:95]
    ds_read_b64_tr_b16 v[38:39], v10 offset:512
    ds_read_b128 v[20:23], v8 offset:32768
    v_mfma_f32_16x16x32_bf16 v[88:91], v[24:27], v[48:51], v[88:91]
    ds_read_b64_tr_b16 v[40:41], v11 offset:0
    v_mfma_f32_16x16x32_bf16 v[96:99], v[24:27], v[52:55], v[96:99]
    ds_read_b64_tr_b16 v[42:43], v11 offset:512
    ds_read_b128 v[24:27], v8 offset:34816
    v_mfma_f32_16x16x32_bf16 v[124:127], v[28:31], v[48:51], v[124:127]
    ds_read_b64_tr_b16 v[44:45], v12 offset:0
    v_mfma_f32_16x16x32_bf16 v[132:135], v[28:31], v[52:55], v[132:135]
    ds_read_b64_tr_b16 v[46:47], v12 offset:512
    ds_read_b128 v[28:31], v8 offset:36864
    v_mfma_f32_16x16x32_bf16 v[128:131], v[32:35], v[48:51], v[128:131]
    v_mfma_f32_16x16x32_bf16 v[136:139], v[32:35], v[52:55], v[136:139]
    ds_read_b128 v[32:35], v8 offset:38912
    s_waitcnt lgkmcnt(7)
    v_mfma_f32_16x16x32_bf16 v[60:63], v[20:23], v[36:39], v[60:63]
    ds_read_b64_tr_b16 v[48:49], v13 offset:0
    s_waitcnt lgkmcnt(6)
    v_mfma_f32_16x16x32_bf16 v[68:71], v[20:23], v[40:43], v[68:71]
    ds_read_b64_tr_b16 v[50:51], v13 offset:512
    s_waitcnt lgkmcnt(4)
    v_mfma_f32_16x16x32_bf16 v[76:79], v[20:23], v[44:47], v[76:79]
    ds_read_b64_tr_b16 v[52:53], v14 offset:0
    v_mfma_f32_16x16x32_bf16 v[64:67], v[24:27], v[36:39], v[64:67]
    ds_read_b64_tr_b16 v[54:55], v14 offset:512
    v_mfma_f32_16x16x32_bf16 v[72:75], v[24:27], v[40:43], v[72:75]
    v_mfma_f32_16x16x32_bf16 v[80:83], v[24:27], v[44:47], v[80:83]
    s_waitcnt lgkmcnt(5)
    v_mfma_f32_16x16x32_bf16 v[100:103], v[28:31], v[36:39], v[100:103]
    v_mfma_f32_16x16x32_bf16 v[108:111], v[28:31], v[40:43], v[108:111]
    v_mfma_f32_16x16x32_bf16 v[116:119], v[28:31], v[44:47], v[116:119]
    s_waitcnt lgkmcnt(4)
    v_mfma_f32_16x16x32_bf16 v[104:107], v[32:35], v[36:39], v[104:107]
    v_mfma_f32_16x16x32_bf16 v[112:115], v[32:35], v[40:43], v[112:115]
    v_mfma_f32_16x16x32_bf16 v[120:123], v[32:35], v[44:47], v[120:123]
    s_waitcnt lgkmcnt(0)
    s_barrier
    v_mfma_f32_16x16x32_bf16 v[84:87], v[20:23], v[48:51], v[84:87]
    ds_read_b64_tr_b16 v[36:37], v10 offset:24576
    v_mfma_f32_16x16x32_bf16 v[92:95], v[20:23], v[52:55], v[92:95]
    ds_read_b64_tr_b16 v[38:39], v10 offset:25088
    ds_read_b128 v[20:23], v9 offset:32768
    v_mfma_f32_16x16x32_bf16 v[88:91], v[24:27], v[48:51], v[88:91]
    ds_read_b64_tr_b16 v[40:41], v11 offset:24576
    v_mfma_f32_16x16x32_bf16 v[96:99], v[24:27], v[52:55], v[96:99]
    ds_read_b64_tr_b16 v[42:43], v11 offset:25088
    ds_read_b128 v[24:27], v9 offset:34816
    v_mfma_f32_16x16x32_bf16 v[124:127], v[28:31], v[48:51], v[124:127]
    ds_read_b64_tr_b16 v[44:45], v12 offset:24576
    v_mfma_f32_16x16x32_bf16 v[132:135], v[28:31], v[52:55], v[132:135]
    ds_read_b64_tr_b16 v[46:47], v12 offset:25088
    ds_read_b128 v[28:31], v9 offset:36864
    v_mfma_f32_16x16x32_bf16 v[128:131], v[32:35], v[48:51], v[128:131]
    v_mfma_f32_16x16x32_bf16 v[136:139], v[32:35], v[52:55], v[136:139]
    ds_read_b128 v[32:35], v9 offset:38912
    s_waitcnt lgkmcnt(7)
    v_mfma_f32_16x16x32_bf16 v[60:63], v[20:23], v[36:39], v[60:63]
    ds_read_b64_tr_b16 v[48:49], v13 offset:24576
    s_waitcnt lgkmcnt(6)
    v_mfma_f32_16x16x32_bf16 v[68:71], v[20:23], v[40:43], v[68:71]
    ds_read_b64_tr_b16 v[50:51], v13 offset:25088
    s_waitcnt lgkmcnt(4)
    v_mfma_f32_16x16x32_bf16 v[76:79], v[20:23], v[44:47], v[76:79]
    ds_read_b64_tr_b16 v[52:53], v14 offset:24576
    v_mfma_f32_16x16x32_bf16 v[64:67], v[24:27], v[36:39], v[64:67]
    ds_read_b64_tr_b16 v[54:55], v14 offset:25088
    v_mfma_f32_16x16x32_bf16 v[72:75], v[24:27], v[40:43], v[72:75]
    v_mfma_f32_16x16x32_bf16 v[80:83], v[24:27], v[44:47], v[80:83]
    s_waitcnt lgkmcnt(5)
    v_mfma_f32_16x16x32_bf16 v[100:103], v[28:31], v[36:39], v[100:103]
    v_mfma_f32_16x16x32_bf16 v[108:111], v[28:31], v[40:43], v[108:111]
    v_mfma_f32_16x16x32_bf16 v[116:119], v[28:31], v[44:47], v[116:119]
    s_waitcnt lgkmcnt(4)
    v_mfma_f32_16x16x32_bf16 v[104:107], v[32:35], v[36:39], v[104:107]
    v_mfma_f32_16x16x32_bf16 v[112:115], v[32:35], v[40:43], v[112:115]
    v_mfma_f32_16x16x32_bf16 v[120:123], v[32:35], v[44:47], v[120:123]
    s_waitcnt lgkmcnt(0)
    s_barrier
    v_mfma_f32_16x16x32_bf16 v[84:87], v[20:23], v[48:51], v[84:87]
    ds_read_b64_tr_b16 v[36:37], v15 offset:0
    v_mfma_f32_16x16x32_bf16 v[92:95], v[20:23], v[52:55], v[92:95]
    ds_read_b64_tr_b16 v[38:39], v15 offset:512
    ds_read_b128 v[20:23], v8 offset:16384
    v_mfma_f32_16x16x32_bf16 v[88:91], v[24:27], v[48:51], v[88:91]
    ds_read_b64_tr_b16 v[40:41], v16 offset:0
    v_mfma_f32_16x16x32_bf16 v[96:99], v[24:27], v[52:55], v[96:99]
    ds_read_b64_tr_b16 v[42:43], v16 offset:512
    ds_read_b128 v[24:27], v8 offset:18432
    v_mfma_f32_16x16x32_bf16 v[124:127], v[28:31], v[48:51], v[124:127]
    ds_read_b64_tr_b16 v[44:45], v17 offset:0
    v_mfma_f32_16x16x32_bf16 v[132:135], v[28:31], v[52:55], v[132:135]
    ds_read_b64_tr_b16 v[46:47], v17 offset:512
    ds_read_b128 v[28:31], v8 offset:20480
    v_mfma_f32_16x16x32_bf16 v[128:131], v[32:35], v[48:51], v[128:131]
    v_mfma_f32_16x16x32_bf16 v[136:139], v[32:35], v[52:55], v[136:139]
    ds_read_b128 v[32:35], v8 offset:22528
    s_waitcnt lgkmcnt(7)
    v_mfma_f32_16x16x32_bf16 v[60:63], v[20:23], v[36:39], v[60:63]
    ds_read_b64_tr_b16 v[48:49], v18 offset:0
    s_waitcnt lgkmcnt(6)
    v_mfma_f32_16x16x32_bf16 v[68:71], v[20:23], v[40:43], v[68:71]
    ds_read_b64_tr_b16 v[50:51], v18 offset:512
    s_waitcnt lgkmcnt(4)
    v_mfma_f32_16x16x32_bf16 v[76:79], v[20:23], v[44:47], v[76:79]
    ds_read_b64_tr_b16 v[52:53], v19 offset:0
    v_mfma_f32_16x16x32_bf16 v[64:67], v[24:27], v[36:39], v[64:67]
    ds_read_b64_tr_b16 v[54:55], v19 offset:512
    v_mfma_f32_16x16x32_bf16 v[72:75], v[24:27], v[40:43], v[72:75]
    v_mfma_f32_16x16x32_bf16 v[80:83], v[24:27], v[44:47], v[80:83]
    s_waitcnt lgkmcnt(5)
    v_mfma_f32_16x16x32_bf16 v[100:103], v[28:31], v[36:39], v[100:103]
    v_mfma_f32_16x16x32_bf16 v[108:111], v[28:31], v[40:43], v[108:111]
    v_mfma_f32_16x16x32_bf16 v[116:119], v[28:31], v[44:47], v[116:119]
    s_waitcnt lgkmcnt(4)
    v_mfma_f32_16x16x32_bf16 v[104:107], v[32:35], v[36:39], v[104:107]
    v_mfma_f32_16x16x32_bf16 v[112:115], v[32:35], v[40:43], v[112:115]
    v_mfma_f32_16x16x32_bf16 v[120:123], v[32:35], v[44:47], v[120:123]
    s_waitcnt lgkmcnt(0)
    s_barrier
    v_mfma_f32_16x16x32_bf16 v[84:87], v[20:23], v[48:51], v[84:87]
    ds_read_b64_tr_b16 v[36:37], v15 offset:24576
    v_mfma_f32_16x16x32_bf16 v[92:95], v[20:23], v[52:55], v[92:95]
    ds_read_b64_tr_b16 v[38:39], v15 offset:25088
    ds_read_b128 v[20:23], v9 offset:16384
    v_mfma_f32_16x16x32_bf16 v[88:91], v[24:27], v[48:51], v[88:91]
    ds_read_b64_tr_b16 v[40:41], v16 offset:24576
    v_mfma_f32_16x16x32_bf16 v[96:99], v[24:27], v[52:55], v[96:99]
    ds_read_b64_tr_b16 v[42:43], v16 offset:25088
    ds_read_b128 v[24:27], v9 offset:18432
    v_mfma_f32_16x16x32_bf16 v[124:127], v[28:31], v[48:51], v[124:127]
    ds_read_b64_tr_b16 v[44:45], v17 offset:24576
    v_mfma_f32_16x16x32_bf16 v[132:135], v[28:31], v[52:55], v[132:135]
    ds_read_b64_tr_b16 v[46:47], v17 offset:25088
    ds_read_b128 v[28:31], v9 offset:20480
    v_mfma_f32_16x16x32_bf16 v[128:131], v[32:35], v[48:51], v[128:131]
    v_mfma_f32_16x16x32_bf16 v[136:139], v[32:35], v[52:55], v[136:139]
    ds_read_b128 v[32:35], v9 offset:22528
    s_waitcnt lgkmcnt(7)
    v_mfma_f32_16x16x32_bf16 v[60:63], v[20:23], v[36:39], v[60:63]
    ds_read_b64_tr_b16 v[48:49], v18 offset:24576
    s_waitcnt lgkmcnt(6)
    v_mfma_f32_16x16x32_bf16 v[68:71], v[20:23], v[40:43], v[68:71]
    ds_read_b64_tr_b16 v[50:51], v18 offset:25088
    s_waitcnt lgkmcnt(4)
    v_mfma_f32_16x16x32_bf16 v[76:79], v[20:23], v[44:47], v[76:79]
    ds_read_b64_tr_b16 v[52:53], v19 offset:24576
    v_mfma_f32_16x16x32_bf16 v[64:67], v[24:27], v[36:39], v[64:67]
    ds_read_b64_tr_b16 v[54:55], v19 offset:25088
    v_mfma_f32_16x16x32_bf16 v[72:75], v[24:27], v[40:43], v[72:75]
    v_mfma_f32_16x16x32_bf16 v[80:83], v[24:27], v[44:47], v[80:83]
    s_waitcnt lgkmcnt(5)
    v_mfma_f32_16x16x32_bf16 v[100:103], v[28:31], v[36:39], v[100:103]
    v_mfma_f32_16x16x32_bf16 v[108:111], v[28:31], v[40:43], v[108:111]
    v_mfma_f32_16x16x32_bf16 v[116:119], v[28:31], v[44:47], v[116:119]
    s_waitcnt lgkmcnt(4)
    v_mfma_f32_16x16x32_bf16 v[104:107], v[32:35], v[36:39], v[104:107]
    v_mfma_f32_16x16x32_bf16 v[112:115], v[32:35], v[40:43], v[112:115]
    v_mfma_f32_16x16x32_bf16 v[120:123], v[32:35], v[44:47], v[120:123]
    s_waitcnt lgkmcnt(0)
    s_barrier
    v_mfma_f32_16x16x32_bf16 v[84:87], v[20:23], v[48:51], v[84:87]
    ds_read_b64_tr_b16 v[36:37], v10 offset:0
    v_mfma_f32_16x16x32_bf16 v[92:95], v[20:23], v[52:55], v[92:95]
    ds_read_b64_tr_b16 v[38:39], v10 offset:512
    ds_read_b128 v[20:23], v8 offset:0
    v_mfma_f32_16x16x32_bf16 v[88:91], v[24:27], v[48:51], v[88:91]
    ds_read_b64_tr_b16 v[40:41], v11 offset:0
    v_mfma_f32_16x16x32_bf16 v[96:99], v[24:27], v[52:55], v[96:99]
    ds_read_b64_tr_b16 v[42:43], v11 offset:512
    ds_read_b128 v[24:27], v8 offset:2048
    v_mfma_f32_16x16x32_bf16 v[124:127], v[28:31], v[48:51], v[124:127]
    ds_read_b64_tr_b16 v[44:45], v12 offset:0
    v_mfma_f32_16x16x32_bf16 v[132:135], v[28:31], v[52:55], v[132:135]
    ds_read_b64_tr_b16 v[46:47], v12 offset:512
    ds_read_b128 v[28:31], v8 offset:4096
    v_mfma_f32_16x16x32_bf16 v[128:131], v[32:35], v[48:51], v[128:131]
    v_mfma_f32_16x16x32_bf16 v[136:139], v[32:35], v[52:55], v[136:139]
    ds_read_b128 v[32:35], v8 offset:6144
    s_waitcnt lgkmcnt(7)
    v_mfma_f32_16x16x32_bf16 v[60:63], v[20:23], v[36:39], v[60:63]
    ds_read_b64_tr_b16 v[48:49], v13 offset:0
    s_waitcnt lgkmcnt(6)
    v_mfma_f32_16x16x32_bf16 v[68:71], v[20:23], v[40:43], v[68:71]
    ds_read_b64_tr_b16 v[50:51], v13 offset:512
    s_waitcnt lgkmcnt(4)
    v_mfma_f32_16x16x32_bf16 v[76:79], v[20:23], v[44:47], v[76:79]
    ds_read_b64_tr_b16 v[52:53], v14 offset:0
    v_mfma_f32_16x16x32_bf16 v[64:67], v[24:27], v[36:39], v[64:67]
    ds_read_b64_tr_b16 v[54:55], v14 offset:512
    v_mfma_f32_16x16x32_bf16 v[72:75], v[24:27], v[40:43], v[72:75]
    v_mfma_f32_16x16x32_bf16 v[80:83], v[24:27], v[44:47], v[80:83]
    s_waitcnt lgkmcnt(5)
    v_mfma_f32_16x16x32_bf16 v[100:103], v[28:31], v[36:39], v[100:103]
    v_mfma_f32_16x16x32_bf16 v[108:111], v[28:31], v[40:43], v[108:111]
    v_mfma_f32_16x16x32_bf16 v[116:119], v[28:31], v[44:47], v[116:119]
    s_waitcnt lgkmcnt(4)
    v_mfma_f32_16x16x32_bf16 v[104:107], v[32:35], v[36:39], v[104:107]
    v_mfma_f32_16x16x32_bf16 v[112:115], v[32:35], v[40:43], v[112:115]
    v_mfma_f32_16x16x32_bf16 v[120:123], v[32:35], v[44:47], v[120:123]
    s_waitcnt lgkmcnt(0)
    s_barrier
    v_mfma_f32_16x16x32_bf16 v[84:87], v[20:23], v[48:51], v[84:87]
    ds_read_b64_tr_b16 v[36:37], v10 offset:24576
    v_mfma_f32_16x16x32_bf16 v[92:95], v[20:23], v[52:55], v[92:95]
    ds_read_b64_tr_b16 v[38:39], v10 offset:25088
    ds_read_b128 v[20:23], v9 offset:0
    v_mfma_f32_16x16x32_bf16 v[88:91], v[24:27], v[48:51], v[88:91]
    ds_read_b64_tr_b16 v[40:41], v11 offset:24576
    v_mfma_f32_16x16x32_bf16 v[96:99], v[24:27], v[52:55], v[96:99]
    ds_read_b64_tr_b16 v[42:43], v11 offset:25088
    ds_read_b128 v[24:27], v9 offset:2048
    v_mfma_f32_16x16x32_bf16 v[124:127], v[28:31], v[48:51], v[124:127]
    ds_read_b64_tr_b16 v[44:45], v12 offset:24576
    v_mfma_f32_16x16x32_bf16 v[132:135], v[28:31], v[52:55], v[132:135]
    ds_read_b64_tr_b16 v[46:47], v12 offset:25088
    ds_read_b128 v[28:31], v9 offset:4096
    v_mfma_f32_16x16x32_bf16 v[128:131], v[32:35], v[48:51], v[128:131]
    v_mfma_f32_16x16x32_bf16 v[136:139], v[32:35], v[52:55], v[136:139]
    ds_read_b128 v[32:35], v9 offset:6144
    s_waitcnt lgkmcnt(7)
    v_mfma_f32_16x16x32_bf16 v[60:63], v[20:23], v[36:39], v[60:63]
    ds_read_b64_tr_b16 v[48:49], v13 offset:24576
    s_waitcnt lgkmcnt(6)
    v_mfma_f32_16x16x32_bf16 v[68:71], v[20:23], v[40:43], v[68:71]
    ds_read_b64_tr_b16 v[50:51], v13 offset:25088
    s_waitcnt lgkmcnt(4)
    v_mfma_f32_16x16x32_bf16 v[76:79], v[20:23], v[44:47], v[76:79]
    ds_read_b64_tr_b16 v[52:53], v14 offset:24576
    v_mfma_f32_16x16x32_bf16 v[64:67], v[24:27], v[36:39], v[64:67]
    ds_read_b64_tr_b16 v[54:55], v14 offset:25088
    v_mfma_f32_16x16x32_bf16 v[72:75], v[24:27], v[40:43], v[72:75]
    v_mfma_f32_16x16x32_bf16 v[80:83], v[24:27], v[44:47], v[80:83]
    s_waitcnt lgkmcnt(5)
    v_mfma_f32_16x16x32_bf16 v[100:103], v[28:31], v[36:39], v[100:103]
    v_mfma_f32_16x16x32_bf16 v[108:111], v[28:31], v[40:43], v[108:111]
    v_mfma_f32_16x16x32_bf16 v[116:119], v[28:31], v[44:47], v[116:119]
    s_waitcnt lgkmcnt(4)
    v_mfma_f32_16x16x32_bf16 v[104:107], v[32:35], v[36:39], v[104:107]
    v_mfma_f32_16x16x32_bf16 v[112:115], v[32:35], v[40:43], v[112:115]
    v_mfma_f32_16x16x32_bf16 v[120:123], v[32:35], v[44:47], v[120:123]
    s_waitcnt lgkmcnt(0)
    s_barrier
    v_mfma_f32_16x16x32_bf16 v[84:87], v[20:23], v[48:51], v[84:87]
    ds_read_b64_tr_b16 v[36:37], v15 offset:0
    v_mfma_f32_16x16x32_bf16 v[92:95], v[20:23], v[52:55], v[92:95]
    ds_read_b64_tr_b16 v[38:39], v15 offset:512
    ds_read_b128 v[20:23], v8 offset:32768
    v_mfma_f32_16x16x32_bf16 v[88:91], v[24:27], v[48:51], v[88:91]
    ds_read_b64_tr_b16 v[40:41], v16 offset:0
    v_mfma_f32_16x16x32_bf16 v[96:99], v[24:27], v[52:55], v[96:99]
    ds_read_b64_tr_b16 v[42:43], v16 offset:512
    ds_read_b128 v[24:27], v8 offset:34816
    v_mfma_f32_16x16x32_bf16 v[124:127], v[28:31], v[48:51], v[124:127]
    ds_read_b64_tr_b16 v[44:45], v17 offset:0
    v_mfma_f32_16x16x32_bf16 v[132:135], v[28:31], v[52:55], v[132:135]
    ds_read_b64_tr_b16 v[46:47], v17 offset:512
    ds_read_b128 v[28:31], v8 offset:36864
    v_mfma_f32_16x16x32_bf16 v[128:131], v[32:35], v[48:51], v[128:131]
    v_mfma_f32_16x16x32_bf16 v[136:139], v[32:35], v[52:55], v[136:139]
    ds_read_b128 v[32:35], v8 offset:38912
    s_waitcnt lgkmcnt(7)
    v_mfma_f32_16x16x32_bf16 v[60:63], v[20:23], v[36:39], v[60:63]
    ds_read_b64_tr_b16 v[48:49], v18 offset:0
    s_waitcnt lgkmcnt(6)
    v_mfma_f32_16x16x32_bf16 v[68:71], v[20:23], v[40:43], v[68:71]
    ds_read_b64_tr_b16 v[50:51], v18 offset:512
    s_waitcnt lgkmcnt(4)
    v_mfma_f32_16x16x32_bf16 v[76:79], v[20:23], v[44:47], v[76:79]
    ds_read_b64_tr_b16 v[52:53], v19 offset:0
    v_mfma_f32_16x16x32_bf16 v[64:67], v[24:27], v[36:39], v[64:67]
    ds_read_b64_tr_b16 v[54:55], v19 offset:512
    v_mfma_f32_16x16x32_bf16 v[72:75], v[24:27], v[40:43], v[72:75]
    v_mfma_f32_16x16x32_bf16 v[80:83], v[24:27], v[44:47], v[80:83]
    s_waitcnt lgkmcnt(5)
    v_mfma_f32_16x16x32_bf16 v[100:103], v[28:31], v[36:39], v[100:103]
    v_mfma_f32_16x16x32_bf16 v[108:111], v[28:31], v[40:43], v[108:111]
    v_mfma_f32_16x16x32_bf16 v[116:119], v[28:31], v[44:47], v[116:119]
    s_waitcnt lgkmcnt(4)
    v_mfma_f32_16x16x32_bf16 v[104:107], v[32:35], v[36:39], v[104:107]
    v_mfma_f32_16x16x32_bf16 v[112:115], v[32:35], v[40:43], v[112:115]
    v_mfma_f32_16x16x32_bf16 v[120:123], v[32:35], v[44:47], v[120:123]
    s_waitcnt lgkmcnt(0)
    s_barrier
    v_mfma_f32_16x16x32_bf16 v[84:87], v[20:23], v[48:51], v[84:87]
    ds_read_b64_tr_b16 v[36:37], v15 offset:24576
    v_mfma_f32_16x16x32_bf16 v[92:95], v[20:23], v[52:55], v[92:95]
    ds_read_b64_tr_b16 v[38:39], v15 offset:25088
    ds_read_b128 v[20:23], v9 offset:32768
    v_mfma_f32_16x16x32_bf16 v[88:91], v[24:27], v[48:51], v[88:91]
    ds_read_b64_tr_b16 v[40:41], v16 offset:24576
    v_mfma_f32_16x16x32_bf16 v[96:99], v[24:27], v[52:55], v[96:99]
    ds_read_b64_tr_b16 v[42:43], v16 offset:25088
    ds_read_b128 v[24:27], v9 offset:34816
    v_mfma_f32_16x16x32_bf16 v[124:127], v[28:31], v[48:51], v[124:127]
    ds_read_b64_tr_b16 v[44:45], v17 offset:24576
    v_mfma_f32_16x16x32_bf16 v[132:135], v[28:31], v[52:55], v[132:135]
    ds_read_b64_tr_b16 v[46:47], v17 offset:25088
    ds_read_b128 v[28:31], v9 offset:36864
    v_mfma_f32_16x16x32_bf16 v[128:131], v[32:35], v[48:51], v[128:131]
    v_mfma_f32_16x16x32_bf16 v[136:139], v[32:35], v[52:55], v[136:139]
    ds_read_b128 v[32:35], v9 offset:38912
    s_waitcnt lgkmcnt(7)
    v_mfma_f32_16x16x32_bf16 v[60:63], v[20:23], v[36:39], v[60:63]
    ds_read_b64_tr_b16 v[48:49], v18 offset:24576
    s_waitcnt lgkmcnt(6)
    v_mfma_f32_16x16x32_bf16 v[68:71], v[20:23], v[40:43], v[68:71]
    ds_read_b64_tr_b16 v[50:51], v18 offset:25088
    s_waitcnt lgkmcnt(4)
    v_mfma_f32_16x16x32_bf16 v[76:79], v[20:23], v[44:47], v[76:79]
    ds_read_b64_tr_b16 v[52:53], v19 offset:24576
    v_mfma_f32_16x16x32_bf16 v[64:67], v[24:27], v[36:39], v[64:67]
    ds_read_b64_tr_b16 v[54:55], v19 offset:25088
    v_mfma_f32_16x16x32_bf16 v[72:75], v[24:27], v[40:43], v[72:75]
    v_mfma_f32_16x16x32_bf16 v[80:83], v[24:27], v[44:47], v[80:83]
    s_waitcnt lgkmcnt(5)
    v_mfma_f32_16x16x32_bf16 v[100:103], v[28:31], v[36:39], v[100:103]
    v_mfma_f32_16x16x32_bf16 v[108:111], v[28:31], v[40:43], v[108:111]
    v_mfma_f32_16x16x32_bf16 v[116:119], v[28:31], v[44:47], v[116:119]
    s_waitcnt lgkmcnt(4)
    v_mfma_f32_16x16x32_bf16 v[104:107], v[32:35], v[36:39], v[104:107]
    v_mfma_f32_16x16x32_bf16 v[112:115], v[32:35], v[40:43], v[112:115]
    v_mfma_f32_16x16x32_bf16 v[120:123], v[32:35], v[44:47], v[120:123]
    s_waitcnt lgkmcnt(0)
    s_barrier
    v_mfma_f32_16x16x32_bf16 v[84:87], v[20:23], v[48:51], v[84:87]
    ds_read_b64_tr_b16 v[36:37], v10 offset:0
    v_mfma_f32_16x16x32_bf16 v[92:95], v[20:23], v[52:55], v[92:95]
    ds_read_b64_tr_b16 v[38:39], v10 offset:512
    ds_read_b128 v[20:23], v8 offset:16384
    v_mfma_f32_16x16x32_bf16 v[88:91], v[24:27], v[48:51], v[88:91]
    ds_read_b64_tr_b16 v[40:41], v11 offset:0
    v_mfma_f32_16x16x32_bf16 v[96:99], v[24:27], v[52:55], v[96:99]
    ds_read_b64_tr_b16 v[42:43], v11 offset:512
    ds_read_b128 v[24:27], v8 offset:18432
    v_mfma_f32_16x16x32_bf16 v[124:127], v[28:31], v[48:51], v[124:127]
    ds_read_b64_tr_b16 v[44:45], v12 offset:0
    v_mfma_f32_16x16x32_bf16 v[132:135], v[28:31], v[52:55], v[132:135]
    ds_read_b64_tr_b16 v[46:47], v12 offset:512
    ds_read_b128 v[28:31], v8 offset:20480
    v_mfma_f32_16x16x32_bf16 v[128:131], v[32:35], v[48:51], v[128:131]
    v_mfma_f32_16x16x32_bf16 v[136:139], v[32:35], v[52:55], v[136:139]
    ds_read_b128 v[32:35], v8 offset:22528
    s_waitcnt lgkmcnt(7)
    v_mfma_f32_16x16x32_bf16 v[60:63], v[20:23], v[36:39], v[60:63]
    ds_read_b64_tr_b16 v[48:49], v13 offset:0
    s_waitcnt lgkmcnt(6)
    v_mfma_f32_16x16x32_bf16 v[68:71], v[20:23], v[40:43], v[68:71]
    ds_read_b64_tr_b16 v[50:51], v13 offset:512
    s_waitcnt lgkmcnt(4)
    v_mfma_f32_16x16x32_bf16 v[76:79], v[20:23], v[44:47], v[76:79]
    ds_read_b64_tr_b16 v[52:53], v14 offset:0
    v_mfma_f32_16x16x32_bf16 v[64:67], v[24:27], v[36:39], v[64:67]
    ds_read_b64_tr_b16 v[54:55], v14 offset:512
    v_mfma_f32_16x16x32_bf16 v[72:75], v[24:27], v[40:43], v[72:75]
    v_mfma_f32_16x16x32_bf16 v[80:83], v[24:27], v[44:47], v[80:83]
    s_waitcnt lgkmcnt(5)
    v_mfma_f32_16x16x32_bf16 v[100:103], v[28:31], v[36:39], v[100:103]
    v_mfma_f32_16x16x32_bf16 v[108:111], v[28:31], v[40:43], v[108:111]
    v_mfma_f32_16x16x32_bf16 v[116:119], v[28:31], v[44:47], v[116:119]
    s_waitcnt lgkmcnt(4)
    v_mfma_f32_16x16x32_bf16 v[104:107], v[32:35], v[36:39], v[104:107]
    v_mfma_f32_16x16x32_bf16 v[112:115], v[32:35], v[40:43], v[112:115]
    v_mfma_f32_16x16x32_bf16 v[120:123], v[32:35], v[44:47], v[120:123]
    s_waitcnt lgkmcnt(0)
    s_barrier
    s_cmp_ge_u32 s38, 4
    s_cbranch_scc1 gated_mix__softmax_full_mha__glu_gated_glu__prompt_kernel_npv
    s_setprio 1
gated_mix__softmax_full_mha__glu_gated_glu__prompt_kernel_npv:
    v_mfma_f32_16x16x32_bf16 v[84:87], v[20:23], v[48:51], v[84:87]
    ds_read_b64_tr_b16 v[36:37], v10 offset:24576
    v_mfma_f32_16x16x32_bf16 v[92:95], v[20:23], v[52:55], v[92:95]
    ds_read_b64_tr_b16 v[38:39], v10 offset:25088
    ds_read_b128 v[20:23], v9 offset:16384
    v_mfma_f32_16x16x32_bf16 v[88:91], v[24:27], v[48:51], v[88:91]
    ds_read_b64_tr_b16 v[40:41], v11 offset:24576
    v_mfma_f32_16x16x32_bf16 v[96:99], v[24:27], v[52:55], v[96:99]
    ds_read_b64_tr_b16 v[42:43], v11 offset:25088
    ds_read_b128 v[24:27], v9 offset:18432
    v_mfma_f32_16x16x32_bf16 v[124:127], v[28:31], v[48:51], v[124:127]
    ds_read_b64_tr_b16 v[44:45], v12 offset:24576
    v_mfma_f32_16x16x32_bf16 v[132:135], v[28:31], v[52:55], v[132:135]
    ds_read_b64_tr_b16 v[46:47], v12 offset:25088
    ds_read_b128 v[28:31], v9 offset:20480
    v_mfma_f32_16x16x32_bf16 v[128:131], v[32:35], v[48:51], v[128:131]
    v_mfma_f32_16x16x32_bf16 v[136:139], v[32:35], v[52:55], v[136:139]
    ds_read_b128 v[32:35], v9 offset:22528
    s_waitcnt lgkmcnt(7)
    v_mfma_f32_16x16x32_bf16 v[60:63], v[20:23], v[36:39], v[60:63]
    ds_read_b64_tr_b16 v[48:49], v13 offset:24576
    s_waitcnt lgkmcnt(6)
    v_mfma_f32_16x16x32_bf16 v[68:71], v[20:23], v[40:43], v[68:71]
    ds_read_b64_tr_b16 v[50:51], v13 offset:25088
    s_waitcnt lgkmcnt(4)
    v_mfma_f32_16x16x32_bf16 v[76:79], v[20:23], v[44:47], v[76:79]
    ds_read_b64_tr_b16 v[52:53], v14 offset:24576
    v_mfma_f32_16x16x32_bf16 v[64:67], v[24:27], v[36:39], v[64:67]
    ds_read_b64_tr_b16 v[54:55], v14 offset:25088
    v_mfma_f32_16x16x32_bf16 v[72:75], v[24:27], v[40:43], v[72:75]
    v_mfma_f32_16x16x32_bf16 v[80:83], v[24:27], v[44:47], v[80:83]
    s_waitcnt lgkmcnt(5)
    v_mfma_f32_16x16x32_bf16 v[100:103], v[28:31], v[36:39], v[100:103]
    v_mfma_f32_16x16x32_bf16 v[108:111], v[28:31], v[40:43], v[108:111]
    v_mfma_f32_16x16x32_bf16 v[116:119], v[28:31], v[44:47], v[116:119]
    s_waitcnt lgkmcnt(4)
    v_mfma_f32_16x16x32_bf16 v[104:107], v[32:35], v[36:39], v[104:107]
    v_mfma_f32_16x16x32_bf16 v[112:115], v[32:35], v[40:43], v[112:115]
    v_mfma_f32_16x16x32_bf16 v[120:123], v[32:35], v[44:47], v[120:123]
    s_waitcnt lgkmcnt(2)
    v_mfma_f32_16x16x32_bf16 v[84:87], v[20:23], v[48:51], v[84:87]
    ds_read_b64_tr_b16 v[36:37], v15 offset:0
    s_waitcnt lgkmcnt(1)
    v_mfma_f32_16x16x32_bf16 v[92:95], v[20:23], v[52:55], v[92:95]
    ds_read_b64_tr_b16 v[38:39], v15 offset:512
    ds_read_b128 v[20:23], v8 offset:0
    v_mfma_f32_16x16x32_bf16 v[88:91], v[24:27], v[48:51], v[88:91]
    ds_read_b64_tr_b16 v[40:41], v16 offset:0
    v_mfma_f32_16x16x32_bf16 v[96:99], v[24:27], v[52:55], v[96:99]
    ds_read_b64_tr_b16 v[42:43], v16 offset:512
    ds_read_b128 v[24:27], v8 offset:2048
    v_mfma_f32_16x16x32_bf16 v[124:127], v[28:31], v[48:51], v[124:127]
    ds_read_b64_tr_b16 v[44:45], v17 offset:0
    v_mfma_f32_16x16x32_bf16 v[132:135], v[28:31], v[52:55], v[132:135]
    ds_read_b64_tr_b16 v[46:47], v17 offset:512
    ds_read_b128 v[28:31], v8 offset:4096
    v_mfma_f32_16x16x32_bf16 v[128:131], v[32:35], v[48:51], v[128:131]
    v_mfma_f32_16x16x32_bf16 v[136:139], v[32:35], v[52:55], v[136:139]
    ds_read_b128 v[32:35], v8 offset:6144
    s_waitcnt lgkmcnt(7)
    v_mfma_f32_16x16x32_bf16 v[60:63], v[20:23], v[36:39], v[60:63]
    ds_read_b64_tr_b16 v[48:49], v18 offset:0
    s_waitcnt lgkmcnt(6)
    v_mfma_f32_16x16x32_bf16 v[68:71], v[20:23], v[40:43], v[68:71]
    ds_read_b64_tr_b16 v[50:51], v18 offset:512
    s_waitcnt lgkmcnt(4)
    v_mfma_f32_16x16x32_bf16 v[76:79], v[20:23], v[44:47], v[76:79]
    ds_read_b64_tr_b16 v[52:53], v19 offset:0
    v_mfma_f32_16x16x32_bf16 v[64:67], v[24:27], v[36:39], v[64:67]
    ds_read_b64_tr_b16 v[54:55], v19 offset:512
    v_mfma_f32_16x16x32_bf16 v[72:75], v[24:27], v[40:43], v[72:75]
    v_mfma_f32_16x16x32_bf16 v[80:83], v[24:27], v[44:47], v[80:83]
    s_waitcnt lgkmcnt(5)
    v_mfma_f32_16x16x32_bf16 v[100:103], v[28:31], v[36:39], v[100:103]
    v_mfma_f32_16x16x32_bf16 v[108:111], v[28:31], v[40:43], v[108:111]
    v_mfma_f32_16x16x32_bf16 v[116:119], v[28:31], v[44:47], v[116:119]
    s_waitcnt lgkmcnt(4)
    v_mfma_f32_16x16x32_bf16 v[104:107], v[32:35], v[36:39], v[104:107]
    v_mfma_f32_16x16x32_bf16 v[112:115], v[32:35], v[40:43], v[112:115]
    v_mfma_f32_16x16x32_bf16 v[120:123], v[32:35], v[44:47], v[120:123]
    s_waitcnt lgkmcnt(2)
    v_mfma_f32_16x16x32_bf16 v[84:87], v[20:23], v[48:51], v[84:87]
    ds_read_b64_tr_b16 v[36:37], v15 offset:24576
    s_waitcnt lgkmcnt(1)
    v_mfma_f32_16x16x32_bf16 v[92:95], v[20:23], v[52:55], v[92:95]
    ds_read_b64_tr_b16 v[38:39], v15 offset:25088
    ds_read_b128 v[20:23], v9 offset:0
    v_mfma_f32_16x16x32_bf16 v[88:91], v[24:27], v[48:51], v[88:91]
    ds_read_b64_tr_b16 v[40:41], v16 offset:24576
    v_mfma_f32_16x16x32_bf16 v[96:99], v[24:27], v[52:55], v[96:99]
    ds_read_b64_tr_b16 v[42:43], v16 offset:25088
    ds_read_b128 v[24:27], v9 offset:2048
    v_mfma_f32_16x16x32_bf16 v[124:127], v[28:31], v[48:51], v[124:127]
    ds_read_b64_tr_b16 v[44:45], v17 offset:24576
    v_mfma_f32_16x16x32_bf16 v[132:135], v[28:31], v[52:55], v[132:135]
    ds_read_b64_tr_b16 v[46:47], v17 offset:25088
    ds_read_b128 v[28:31], v9 offset:4096
    v_mfma_f32_16x16x32_bf16 v[128:131], v[32:35], v[48:51], v[128:131]
    v_mfma_f32_16x16x32_bf16 v[136:139], v[32:35], v[52:55], v[136:139]
    ds_read_b128 v[32:35], v9 offset:6144
    s_waitcnt lgkmcnt(7)
    v_mfma_f32_16x16x32_bf16 v[60:63], v[20:23], v[36:39], v[60:63]
    ds_read_b64_tr_b16 v[48:49], v18 offset:24576
    s_waitcnt lgkmcnt(6)
    v_mfma_f32_16x16x32_bf16 v[68:71], v[20:23], v[40:43], v[68:71]
    ds_read_b64_tr_b16 v[50:51], v18 offset:25088
    s_waitcnt lgkmcnt(4)
    v_mfma_f32_16x16x32_bf16 v[76:79], v[20:23], v[44:47], v[76:79]
    ds_read_b64_tr_b16 v[52:53], v19 offset:24576
    v_mfma_f32_16x16x32_bf16 v[64:67], v[24:27], v[36:39], v[64:67]
    ds_read_b64_tr_b16 v[54:55], v19 offset:25088
    v_mfma_f32_16x16x32_bf16 v[72:75], v[24:27], v[40:43], v[72:75]
    v_mfma_f32_16x16x32_bf16 v[80:83], v[24:27], v[44:47], v[80:83]
    s_waitcnt lgkmcnt(5)
    v_mfma_f32_16x16x32_bf16 v[100:103], v[28:31], v[36:39], v[100:103]
    v_mfma_f32_16x16x32_bf16 v[108:111], v[28:31], v[40:43], v[108:111]
    v_mfma_f32_16x16x32_bf16 v[116:119], v[28:31], v[44:47], v[116:119]
    s_waitcnt lgkmcnt(4)
    v_mfma_f32_16x16x32_bf16 v[104:107], v[32:35], v[36:39], v[104:107]
    v_mfma_f32_16x16x32_bf16 v[112:115], v[32:35], v[40:43], v[112:115]
    v_mfma_f32_16x16x32_bf16 v[120:123], v[32:35], v[44:47], v[120:123]
    s_waitcnt lgkmcnt(2)
    v_mfma_f32_16x16x32_bf16 v[84:87], v[20:23], v[48:51], v[84:87]
    s_waitcnt lgkmcnt(0)
    v_mfma_f32_16x16x32_bf16 v[92:95], v[20:23], v[52:55], v[92:95]
    v_mfma_f32_16x16x32_bf16 v[88:91], v[24:27], v[48:51], v[88:91]
    v_mfma_f32_16x16x32_bf16 v[96:99], v[24:27], v[52:55], v[96:99]
    v_mfma_f32_16x16x32_bf16 v[124:127], v[28:31], v[48:51], v[124:127]
    v_mfma_f32_16x16x32_bf16 v[132:135], v[28:31], v[52:55], v[132:135]
    v_mfma_f32_16x16x32_bf16 v[128:131], v[32:35], v[48:51], v[128:131]
    v_mfma_f32_16x16x32_bf16 v[136:139], v[32:35], v[52:55], v[136:139]
    s_waitcnt vmcnt(0)
    s_and_b32 s41, s39, 1
    s_lshl_b32 s41, s41, 2
    s_add_u32 s41, s41, s53
    s_mul_i32 s41, s41, 327680
    s_lshl_b32 s42, s40, 1
    s_add_u32 s42, s42, s52
    s_mul_i32 s42, s42, 2560
    s_add_u32 s41, s41, s42
    s_lshr_b32 s42, s39, 1
    s_mul_i32 s42, s42, 2621440
    s_add_u32 s41, s41, s42
    v_and_b32 v3, 15, v1
    v_lshrrev_b32 v4, 4, v1
    v_mul_u32_u24 v4, 320, v4
    v_lshl_add_u32 v4, v3, 4, v4
    s_mov_b32 s43, 81600
    s_add_u32 s42, s41, 0
    v_cvt_pk_bf16_f32 v20, v60, v61
    v_cvt_pk_bf16_f32 v21, v62, v63
    v_cvt_pk_bf16_f32 v22, v64, v65
    v_cvt_pk_bf16_f32 v23, v66, v67
    buffer_store_dwordx4 v[20:23], v4, s[32:35], s42 offen offset:0 sc1
    v_cvt_pk_bf16_f32 v24, v100, v101
    v_cvt_pk_bf16_f32 v25, v102, v103
    v_cvt_pk_bf16_f32 v26, v104, v105
    v_cvt_pk_bf16_f32 v27, v106, v107
    buffer_store_dwordx4 v[24:27], v4, s[32:35], s42 offen offset:1280 sc1
    s_add_u32 s42, s41, 256
    v_cmp_le_u32 vcc, 4, v3
    v_cvt_pk_bf16_f32 v28, v68, v69
    v_cvt_pk_bf16_f32 v29, v70, v71
    v_cvt_pk_bf16_f32 v30, v72, v73
    v_cvt_pk_bf16_f32 v31, v74, v75
    v_cndmask_b32 v5, 0, 1, vcc
    v_mad_u32_u24 v5, v5, s43, v4
    buffer_store_dwordx4 v[28:31], v5, s[32:35], s42 offen offset:0 sc1
    v_cvt_pk_bf16_f32 v32, v108, v109
    v_cvt_pk_bf16_f32 v33, v110, v111
    v_cvt_pk_bf16_f32 v34, v112, v113
    v_cvt_pk_bf16_f32 v35, v114, v115
    buffer_store_dwordx4 v[32:35], v5, s[32:35], s42 offen offset:1280 sc1
    s_add_u32 s42, s41, 82112
    v_cmp_le_u32 vcc, 8, v3
    v_cvt_pk_bf16_f32 v36, v76, v77
    v_cvt_pk_bf16_f32 v37, v78, v79
    v_cvt_pk_bf16_f32 v38, v80, v81
    v_cvt_pk_bf16_f32 v39, v82, v83
    v_cndmask_b32 v5, 0, 1, vcc
    v_mad_u32_u24 v5, v5, s43, v4
    buffer_store_dwordx4 v[36:39], v5, s[32:35], s42 offen offset:0 sc1
    v_cvt_pk_bf16_f32 v40, v116, v117
    v_cvt_pk_bf16_f32 v41, v118, v119
    v_cvt_pk_bf16_f32 v42, v120, v121
    v_cvt_pk_bf16_f32 v43, v122, v123
    buffer_store_dwordx4 v[40:43], v5, s[32:35], s42 offen offset:1280 sc1
    s_add_u32 s42, s41, 163968
    v_cmp_le_u32 vcc, 12, v3
    v_cvt_pk_bf16_f32 v44, v84, v85
    v_cvt_pk_bf16_f32 v45, v86, v87
    v_cvt_pk_bf16_f32 v46, v88, v89
    v_cvt_pk_bf16_f32 v47, v90, v91
    v_cndmask_b32 v5, 0, 1, vcc
    v_mad_u32_u24 v5, v5, s43, v4
    buffer_store_dwordx4 v[44:47], v5, s[32:35], s42 offen offset:0 sc1
    v_cvt_pk_bf16_f32 v48, v124, v125
    v_cvt_pk_bf16_f32 v49, v126, v127
    v_cvt_pk_bf16_f32 v50, v128, v129
    v_cvt_pk_bf16_f32 v51, v130, v131
    buffer_store_dwordx4 v[48:51], v5, s[32:35], s42 offen offset:1280 sc1
    s_add_u32 s42, s41, 245824
    v_cvt_pk_bf16_f32 v20, v92, v93
    v_cvt_pk_bf16_f32 v21, v94, v95
    v_cvt_pk_bf16_f32 v22, v96, v97
    v_cvt_pk_bf16_f32 v23, v98, v99
    buffer_store_dwordx4 v[20:23], v4, s[32:35], s42 offen offset:0 sc1
    v_cvt_pk_bf16_f32 v24, v132, v133
    v_cvt_pk_bf16_f32 v25, v134, v135
    v_cvt_pk_bf16_f32 v26, v136, v137
    v_cvt_pk_bf16_f32 v27, v138, v139
    buffer_store_dwordx4 v[24:27], v4, s[32:35], s42 offen offset:1280 sc1
    s_waitcnt vmcnt(0)
    v_mov_b32 v2, 161792
    v_mov_b32 v3, 1
    s_mov_b64 exec, 1
    ds_add_rtn_u32 v4, v2, v3
    s_mov_b64 exec, -1
    v_lshlrev_b32 v2, 10, v1
    s_cmp_lt_u32 s45, 23232512
    s_cselect_b32 s42, 8, 1
    v_mov_b32 v5, 1073741824
    v_cmp_gt_u32 vcc, s42, v1
    s_nop 1
    v_cndmask_b32 v2, v5, v2, vcc
    s_waitcnt lgkmcnt(0)
    v_readfirstlane_b32 s41, v4
    s_nop 3
    s_cmp_lg_u32 s41, 7
    s_cbranch_scc1 gated_mix__softmax_full_mha__glu_gated_glu__prompt_kernel_pubv
    buffer_store_dword v3, v2, s[32:35], s45 offen sc1
gated_mix__softmax_full_mha__glu_gated_glu__prompt_kernel_pubv:
    s_branch gated_mix__softmax_full_mha__glu_gated_glu__prompt_kernel_att
gated_mix__softmax_full_mha__glu_gated_glu__prompt_kernel_gu:
    s_and_b32 s52, s38, 1
    s_lshr_b32 s53, s38, 1
    v_and_b32 v2, 15, v1
    v_lshrrev_b32 v3, 4, v1
    v_lshrrev_b32 v4, 1, v2
    v_xor_b32 v4, v3, v4
    s_lshl_b32 s41, s52, 13
    s_add_u32 s41, s41, 98304
    v_lshl_add_u32 v2, v2, 7, s41
    v_lshl_add_u32 v8, v4, 4, v2
    v_xor_b32 v9, 64, v8
    v_bfe_u32 v4, v1, 2, 2
    v_lshl_add_u32 v2, v3, 3, v4
    v_lshlrev_b32 v2, 7, v2
    v_and_b32 v5, 3, v1
    v_lshl_add_u32 v2, v5, 3, v2
    v_lshrrev_b32 v4, 1, v4
    v_and_b32 v3, 1, v3
    v_lshl_or_b32 v3, v3, 1, v4
    s_mul_i32 s41, s53, 3
    s_add_u32 s42, s41, 0
    s_lshr_b32 s43, s42, 2
    s_lshl_b32 s43, s43, 7
    s_and_b32 s42, s42, 3
    s_or_b32 s42, s42, s43
    v_xor_b32 v5, s42, v3
    v_lshl_add_u32 v10, v5, 5, v2
    v_add_u32 v13, 49152, v10
    s_add_u32 s42, s41, 1
    s_lshr_b32 s43, s42, 2
    s_lshl_b32 s43, s43, 7
    s_and_b32 s42, s42, 3
    s_or_b32 s42, s42, s43
    v_xor_b32 v5, s42, v3
    v_lshl_add_u32 v11, v5, 5, v2
    v_add_u32 v14, 49152, v11
    s_add_u32 s42, s41, 2
    s_lshr_b32 s43, s42, 2
    s_lshl_b32 s43, s43, 7
    s_and_b32 s42, s42, 3
    s_or_b32 s42, s42, s43
    v_xor_b32 v5, s42, v3
    v_lshl_add_u32 v12, v5, 5, v2
    v_add_u32 v15, 49152, v12
    s_waitcnt lgkmcnt(0)
    s_mov_b32 s32, s20
    s_mov_b32 s33, s21
    s_mov_b32 s34, 268435456
    s_mov_b32 s35, 0x00020000
    s_barrier
    ds_read_b128 v[16:19], v8 offset:0
    ds_read_b64_tr_b16 v[32:33], v10 offset:0
    ds_read_b64_tr_b16 v[34:35], v10 offset:512
    ds_read_b64_tr_b16 v[36:37], v10 offset:12288
    ds_read_b64_tr_b16 v[38:39], v10 offset:12800
    ds_read_b64_tr_b16 v[40:41], v11 offset:0
    ds_read_b64_tr_b16 v[42:43], v11 offset:512
    ds_read_b128 v[20:23], v8 offset:2048
    ds_read_b128 v[24:27], v8 offset:4096
    ds_read_b128 v[28:31], v8 offset:6144
    s_waitcnt lgkmcnt(9)
    s_waitcnt lgkmcnt(7)
    v_mfma_f32_16x16x32_bf16 v[58:61], v[32:35], v[16:19], 0
    ds_read_b64_tr_b16 v[44:45], v11 offset:12288
    s_waitcnt lgkmcnt(6)
    v_mfma_f32_16x16x32_bf16 v[62:65], v[36:39], v[16:19], 0
    ds_read_b64_tr_b16 v[46:47], v11 offset:12800
    s_waitcnt lgkmcnt(5)
    v_mfma_f32_16x16x32_bf16 v[66:69], v[40:43], v[16:19], 0
    ds_read_b64_tr_b16 v[48:49], v12 offset:0
    s_waitcnt lgkmcnt(5)
    v_mfma_f32_16x16x32_bf16 v[82:85], v[32:35], v[20:23], 0
    ds_read_b64_tr_b16 v[50:51], v12 offset:512
    v_mfma_f32_16x16x32_bf16 v[86:89], v[36:39], v[20:23], 0
    ds_read_b64_tr_b16 v[52:53], v12 offset:12288
    v_mfma_f32_16x16x32_bf16 v[90:93], v[40:43], v[20:23], 0
    ds_read_b64_tr_b16 v[54:55], v12 offset:12800
    s_waitcnt lgkmcnt(7)
    v_mfma_f32_16x16x32_bf16 v[106:109], v[32:35], v[24:27], 0
    v_mfma_f32_16x16x32_bf16 v[110:113], v[36:39], v[24:27], 0
    v_mfma_f32_16x16x32_bf16 v[114:117], v[40:43], v[24:27], 0
    s_waitcnt lgkmcnt(6)
    v_mfma_f32_16x16x32_bf16 v[130:133], v[32:35], v[28:31], 0
    v_mfma_f32_16x16x32_bf16 v[134:137], v[36:39], v[28:31], 0
    v_mfma_f32_16x16x32_bf16 v[138:141], v[40:43], v[28:31], 0
    s_waitcnt lgkmcnt(0)
    s_barrier
    v_mfma_f32_16x16x32_bf16 v[70:73], v[44:47], v[16:19], 0
    ds_read_b64_tr_b16 v[32:33], v10 offset:24576
    v_mfma_f32_16x16x32_bf16 v[74:77], v[48:51], v[16:19], 0
    ds_read_b64_tr_b16 v[34:35], v10 offset:25088
    v_mfma_f32_16x16x32_bf16 v[78:81], v[52:55], v[16:19], 0
    ds_read_b64_tr_b16 v[36:37], v10 offset:36864
    ds_read_b128 v[16:19], v9 offset:0
    v_mfma_f32_16x16x32_bf16 v[94:97], v[44:47], v[20:23], 0
    ds_read_b64_tr_b16 v[38:39], v10 offset:37376
    v_mfma_f32_16x16x32_bf16 v[98:101], v[48:51], v[20:23], 0
    ds_read_b64_tr_b16 v[40:41], v11 offset:24576
    v_mfma_f32_16x16x32_bf16 v[102:105], v[52:55], v[20:23], 0
    ds_read_b64_tr_b16 v[42:43], v11 offset:25088
    ds_read_b128 v[20:23], v9 offset:2048
    v_mfma_f32_16x16x32_bf16 v[118:121], v[44:47], v[24:27], 0
    v_mfma_f32_16x16x32_bf16 v[122:125], v[48:51], v[24:27], 0
    v_mfma_f32_16x16x32_bf16 v[126:129], v[52:55], v[24:27], 0
    ds_read_b128 v[24:27], v9 offset:4096
    v_mfma_f32_16x16x32_bf16 v[142:145], v[44:47], v[28:31], 0
    v_mfma_f32_16x16x32_bf16 v[146:149], v[48:51], v[28:31], 0
    v_mfma_f32_16x16x32_bf16 v[150:153], v[52:55], v[28:31], 0
    ds_read_b128 v[28:31], v9 offset:6144
    s_waitcnt lgkmcnt(6)
    v_mfma_f32_16x16x32_bf16 v[58:61], v[32:35], v[16:19], v[58:61]
    ds_read_b64_tr_b16 v[44:45], v11 offset:36864
    s_waitcnt lgkmcnt(6)
    v_mfma_f32_16x16x32_bf16 v[62:65], v[36:39], v[16:19], v[62:65]
    ds_read_b64_tr_b16 v[46:47], v11 offset:37376
    s_waitcnt lgkmcnt(5)
    v_mfma_f32_16x16x32_bf16 v[66:69], v[40:43], v[16:19], v[66:69]
    ds_read_b64_tr_b16 v[48:49], v12 offset:24576
    s_waitcnt lgkmcnt(5)
    v_mfma_f32_16x16x32_bf16 v[82:85], v[32:35], v[20:23], v[82:85]
    ds_read_b64_tr_b16 v[50:51], v12 offset:25088
    v_mfma_f32_16x16x32_bf16 v[86:89], v[36:39], v[20:23], v[86:89]
    ds_read_b64_tr_b16 v[52:53], v12 offset:36864
    v_mfma_f32_16x16x32_bf16 v[90:93], v[40:43], v[20:23], v[90:93]
    ds_read_b64_tr_b16 v[54:55], v12 offset:37376
    s_waitcnt lgkmcnt(7)
    v_mfma_f32_16x16x32_bf16 v[106:109], v[32:35], v[24:27], v[106:109]
    v_mfma_f32_16x16x32_bf16 v[110:113], v[36:39], v[24:27], v[110:113]
    v_mfma_f32_16x16x32_bf16 v[114:117], v[40:43], v[24:27], v[114:117]
    s_waitcnt lgkmcnt(6)
    v_mfma_f32_16x16x32_bf16 v[130:133], v[32:35], v[28:31], v[130:133]
    v_mfma_f32_16x16x32_bf16 v[134:137], v[36:39], v[28:31], v[134:137]
    v_mfma_f32_16x16x32_bf16 v[138:141], v[40:43], v[28:31], v[138:141]
    s_waitcnt lgkmcnt(0)
    s_barrier
    v_mfma_f32_16x16x32_bf16 v[70:73], v[44:47], v[16:19], v[70:73]
    ds_read_b64_tr_b16 v[32:33], v13 offset:0
    v_mfma_f32_16x16x32_bf16 v[74:77], v[48:51], v[16:19], v[74:77]
    ds_read_b64_tr_b16 v[34:35], v13 offset:512
    v_mfma_f32_16x16x32_bf16 v[78:81], v[52:55], v[16:19], v[78:81]
    ds_read_b64_tr_b16 v[36:37], v13 offset:12288
    ds_read_b128 v[16:19], v8 offset:32768
    v_mfma_f32_16x16x32_bf16 v[94:97], v[44:47], v[20:23], v[94:97]
    ds_read_b64_tr_b16 v[38:39], v13 offset:12800
    v_mfma_f32_16x16x32_bf16 v[98:101], v[48:51], v[20:23], v[98:101]
    ds_read_b64_tr_b16 v[40:41], v14 offset:0
    v_mfma_f32_16x16x32_bf16 v[102:105], v[52:55], v[20:23], v[102:105]
    ds_read_b64_tr_b16 v[42:43], v14 offset:512
    ds_read_b128 v[20:23], v8 offset:34816
    v_mfma_f32_16x16x32_bf16 v[118:121], v[44:47], v[24:27], v[118:121]
    v_mfma_f32_16x16x32_bf16 v[122:125], v[48:51], v[24:27], v[122:125]
    v_mfma_f32_16x16x32_bf16 v[126:129], v[52:55], v[24:27], v[126:129]
    ds_read_b128 v[24:27], v8 offset:36864
    v_mfma_f32_16x16x32_bf16 v[142:145], v[44:47], v[28:31], v[142:145]
    v_mfma_f32_16x16x32_bf16 v[146:149], v[48:51], v[28:31], v[146:149]
    v_mfma_f32_16x16x32_bf16 v[150:153], v[52:55], v[28:31], v[150:153]
    ds_read_b128 v[28:31], v8 offset:38912
    s_waitcnt lgkmcnt(6)
    v_mfma_f32_16x16x32_bf16 v[58:61], v[32:35], v[16:19], v[58:61]
    ds_read_b64_tr_b16 v[44:45], v14 offset:12288
    s_waitcnt lgkmcnt(6)
    v_mfma_f32_16x16x32_bf16 v[62:65], v[36:39], v[16:19], v[62:65]
    ds_read_b64_tr_b16 v[46:47], v14 offset:12800
    s_waitcnt lgkmcnt(5)
    v_mfma_f32_16x16x32_bf16 v[66:69], v[40:43], v[16:19], v[66:69]
    ds_read_b64_tr_b16 v[48:49], v15 offset:0
    s_waitcnt lgkmcnt(5)
    v_mfma_f32_16x16x32_bf16 v[82:85], v[32:35], v[20:23], v[82:85]
    ds_read_b64_tr_b16 v[50:51], v15 offset:512
    v_mfma_f32_16x16x32_bf16 v[86:89], v[36:39], v[20:23], v[86:89]
    ds_read_b64_tr_b16 v[52:53], v15 offset:12288
    v_mfma_f32_16x16x32_bf16 v[90:93], v[40:43], v[20:23], v[90:93]
    ds_read_b64_tr_b16 v[54:55], v15 offset:12800
    s_waitcnt lgkmcnt(7)
    v_mfma_f32_16x16x32_bf16 v[106:109], v[32:35], v[24:27], v[106:109]
    v_mfma_f32_16x16x32_bf16 v[110:113], v[36:39], v[24:27], v[110:113]
    v_mfma_f32_16x16x32_bf16 v[114:117], v[40:43], v[24:27], v[114:117]
    s_waitcnt lgkmcnt(6)
    v_mfma_f32_16x16x32_bf16 v[130:133], v[32:35], v[28:31], v[130:133]
    v_mfma_f32_16x16x32_bf16 v[134:137], v[36:39], v[28:31], v[134:137]
    v_mfma_f32_16x16x32_bf16 v[138:141], v[40:43], v[28:31], v[138:141]
    s_waitcnt lgkmcnt(0)
    s_barrier
    v_mfma_f32_16x16x32_bf16 v[70:73], v[44:47], v[16:19], v[70:73]
    ds_read_b64_tr_b16 v[32:33], v13 offset:24576
    v_mfma_f32_16x16x32_bf16 v[74:77], v[48:51], v[16:19], v[74:77]
    ds_read_b64_tr_b16 v[34:35], v13 offset:25088
    v_mfma_f32_16x16x32_bf16 v[78:81], v[52:55], v[16:19], v[78:81]
    ds_read_b64_tr_b16 v[36:37], v13 offset:36864
    ds_read_b128 v[16:19], v9 offset:32768
    v_mfma_f32_16x16x32_bf16 v[94:97], v[44:47], v[20:23], v[94:97]
    ds_read_b64_tr_b16 v[38:39], v13 offset:37376
    v_mfma_f32_16x16x32_bf16 v[98:101], v[48:51], v[20:23], v[98:101]
    ds_read_b64_tr_b16 v[40:41], v14 offset:24576
    v_mfma_f32_16x16x32_bf16 v[102:105], v[52:55], v[20:23], v[102:105]
    ds_read_b64_tr_b16 v[42:43], v14 offset:25088
    ds_read_b128 v[20:23], v9 offset:34816
    v_mfma_f32_16x16x32_bf16 v[118:121], v[44:47], v[24:27], v[118:121]
    v_mfma_f32_16x16x32_bf16 v[122:125], v[48:51], v[24:27], v[122:125]
    v_mfma_f32_16x16x32_bf16 v[126:129], v[52:55], v[24:27], v[126:129]
    ds_read_b128 v[24:27], v9 offset:36864
    v_mfma_f32_16x16x32_bf16 v[142:145], v[44:47], v[28:31], v[142:145]
    v_mfma_f32_16x16x32_bf16 v[146:149], v[48:51], v[28:31], v[146:149]
    v_mfma_f32_16x16x32_bf16 v[150:153], v[52:55], v[28:31], v[150:153]
    ds_read_b128 v[28:31], v9 offset:38912
    s_waitcnt lgkmcnt(6)
    v_mfma_f32_16x16x32_bf16 v[58:61], v[32:35], v[16:19], v[58:61]
    ds_read_b64_tr_b16 v[44:45], v14 offset:36864
    s_waitcnt lgkmcnt(6)
    v_mfma_f32_16x16x32_bf16 v[62:65], v[36:39], v[16:19], v[62:65]
    ds_read_b64_tr_b16 v[46:47], v14 offset:37376
    s_waitcnt lgkmcnt(5)
    v_mfma_f32_16x16x32_bf16 v[66:69], v[40:43], v[16:19], v[66:69]
    ds_read_b64_tr_b16 v[48:49], v15 offset:24576
    s_waitcnt lgkmcnt(5)
    v_mfma_f32_16x16x32_bf16 v[82:85], v[32:35], v[20:23], v[82:85]
    ds_read_b64_tr_b16 v[50:51], v15 offset:25088
    v_mfma_f32_16x16x32_bf16 v[86:89], v[36:39], v[20:23], v[86:89]
    ds_read_b64_tr_b16 v[52:53], v15 offset:36864
    v_mfma_f32_16x16x32_bf16 v[90:93], v[40:43], v[20:23], v[90:93]
    ds_read_b64_tr_b16 v[54:55], v15 offset:37376
    s_waitcnt lgkmcnt(7)
    v_mfma_f32_16x16x32_bf16 v[106:109], v[32:35], v[24:27], v[106:109]
    v_mfma_f32_16x16x32_bf16 v[110:113], v[36:39], v[24:27], v[110:113]
    v_mfma_f32_16x16x32_bf16 v[114:117], v[40:43], v[24:27], v[114:117]
    s_waitcnt lgkmcnt(6)
    v_mfma_f32_16x16x32_bf16 v[130:133], v[32:35], v[28:31], v[130:133]
    v_mfma_f32_16x16x32_bf16 v[134:137], v[36:39], v[28:31], v[134:137]
    v_mfma_f32_16x16x32_bf16 v[138:141], v[40:43], v[28:31], v[138:141]
    s_waitcnt lgkmcnt(0)
    s_barrier
    v_mfma_f32_16x16x32_bf16 v[70:73], v[44:47], v[16:19], v[70:73]
    ds_read_b64_tr_b16 v[32:33], v10 offset:0
    v_mfma_f32_16x16x32_bf16 v[74:77], v[48:51], v[16:19], v[74:77]
    ds_read_b64_tr_b16 v[34:35], v10 offset:512
    v_mfma_f32_16x16x32_bf16 v[78:81], v[52:55], v[16:19], v[78:81]
    ds_read_b64_tr_b16 v[36:37], v10 offset:12288
    ds_read_b128 v[16:19], v8 offset:16384
    v_mfma_f32_16x16x32_bf16 v[94:97], v[44:47], v[20:23], v[94:97]
    ds_read_b64_tr_b16 v[38:39], v10 offset:12800
    v_mfma_f32_16x16x32_bf16 v[98:101], v[48:51], v[20:23], v[98:101]
    ds_read_b64_tr_b16 v[40:41], v11 offset:0
    v_mfma_f32_16x16x32_bf16 v[102:105], v[52:55], v[20:23], v[102:105]
    ds_read_b64_tr_b16 v[42:43], v11 offset:512
    ds_read_b128 v[20:23], v8 offset:18432
    v_mfma_f32_16x16x32_bf16 v[118:121], v[44:47], v[24:27], v[118:121]
    v_mfma_f32_16x16x32_bf16 v[122:125], v[48:51], v[24:27], v[122:125]
    v_mfma_f32_16x16x32_bf16 v[126:129], v[52:55], v[24:27], v[126:129]
    ds_read_b128 v[24:27], v8 offset:20480
    v_mfma_f32_16x16x32_bf16 v[142:145], v[44:47], v[28:31], v[142:145]
    v_mfma_f32_16x16x32_bf16 v[146:149], v[48:51], v[28:31], v[146:149]
    v_mfma_f32_16x16x32_bf16 v[150:153], v[52:55], v[28:31], v[150:153]
    ds_read_b128 v[28:31], v8 offset:22528
    s_waitcnt lgkmcnt(6)
    v_mfma_f32_16x16x32_bf16 v[58:61], v[32:35], v[16:19], v[58:61]
    ds_read_b64_tr_b16 v[44:45], v11 offset:12288
    s_waitcnt lgkmcnt(6)
    v_mfma_f32_16x16x32_bf16 v[62:65], v[36:39], v[16:19], v[62:65]
    ds_read_b64_tr_b16 v[46:47], v11 offset:12800
    s_waitcnt lgkmcnt(5)
    v_mfma_f32_16x16x32_bf16 v[66:69], v[40:43], v[16:19], v[66:69]
    ds_read_b64_tr_b16 v[48:49], v12 offset:0
    s_waitcnt lgkmcnt(5)
    v_mfma_f32_16x16x32_bf16 v[82:85], v[32:35], v[20:23], v[82:85]
    ds_read_b64_tr_b16 v[50:51], v12 offset:512
    v_mfma_f32_16x16x32_bf16 v[86:89], v[36:39], v[20:23], v[86:89]
    ds_read_b64_tr_b16 v[52:53], v12 offset:12288
    v_mfma_f32_16x16x32_bf16 v[90:93], v[40:43], v[20:23], v[90:93]
    ds_read_b64_tr_b16 v[54:55], v12 offset:12800
    s_waitcnt lgkmcnt(7)
    v_mfma_f32_16x16x32_bf16 v[106:109], v[32:35], v[24:27], v[106:109]
    v_mfma_f32_16x16x32_bf16 v[110:113], v[36:39], v[24:27], v[110:113]
    v_mfma_f32_16x16x32_bf16 v[114:117], v[40:43], v[24:27], v[114:117]
    s_waitcnt lgkmcnt(6)
    v_mfma_f32_16x16x32_bf16 v[130:133], v[32:35], v[28:31], v[130:133]
    v_mfma_f32_16x16x32_bf16 v[134:137], v[36:39], v[28:31], v[134:137]
    v_mfma_f32_16x16x32_bf16 v[138:141], v[40:43], v[28:31], v[138:141]
    s_waitcnt lgkmcnt(0)
    s_barrier
    v_mfma_f32_16x16x32_bf16 v[70:73], v[44:47], v[16:19], v[70:73]
    ds_read_b64_tr_b16 v[32:33], v10 offset:24576
    v_mfma_f32_16x16x32_bf16 v[74:77], v[48:51], v[16:19], v[74:77]
    ds_read_b64_tr_b16 v[34:35], v10 offset:25088
    v_mfma_f32_16x16x32_bf16 v[78:81], v[52:55], v[16:19], v[78:81]
    ds_read_b64_tr_b16 v[36:37], v10 offset:36864
    ds_read_b128 v[16:19], v9 offset:16384
    v_mfma_f32_16x16x32_bf16 v[94:97], v[44:47], v[20:23], v[94:97]
    ds_read_b64_tr_b16 v[38:39], v10 offset:37376
    v_mfma_f32_16x16x32_bf16 v[98:101], v[48:51], v[20:23], v[98:101]
    ds_read_b64_tr_b16 v[40:41], v11 offset:24576
    v_mfma_f32_16x16x32_bf16 v[102:105], v[52:55], v[20:23], v[102:105]
    ds_read_b64_tr_b16 v[42:43], v11 offset:25088
    ds_read_b128 v[20:23], v9 offset:18432
    v_mfma_f32_16x16x32_bf16 v[118:121], v[44:47], v[24:27], v[118:121]
    v_mfma_f32_16x16x32_bf16 v[122:125], v[48:51], v[24:27], v[122:125]
    v_mfma_f32_16x16x32_bf16 v[126:129], v[52:55], v[24:27], v[126:129]
    ds_read_b128 v[24:27], v9 offset:20480
    v_mfma_f32_16x16x32_bf16 v[142:145], v[44:47], v[28:31], v[142:145]
    v_mfma_f32_16x16x32_bf16 v[146:149], v[48:51], v[28:31], v[146:149]
    v_mfma_f32_16x16x32_bf16 v[150:153], v[52:55], v[28:31], v[150:153]
    ds_read_b128 v[28:31], v9 offset:22528
    s_cmp_lg_u32 s38, 0
    s_cbranch_scc1 gated_mix__softmax_full_mha__glu_gated_glu__prompt_kernel_cntgu
    s_cmp_ge_u32 s2, 44
    s_cbranch_scc1 gated_mix__softmax_full_mha__glu_gated_glu__prompt_kernel_cntgu
    s_mov_b32 s56, s96
    s_mov_b32 s57, s97
    s_mov_b32 s58, 256
    s_mov_b32 s59, 0x00020000
    v_mov_b32 v2, 0
    v_mov_b32 v3, 1
    s_waitcnt vmcnt(0)
    s_mov_b64 exec, 1
    buffer_atomic_add v3, v2, s[56:59], 0 offen
    s_mov_b64 exec, -1
gated_mix__softmax_full_mha__glu_gated_glu__prompt_kernel_cntgu:
    s_waitcnt lgkmcnt(6)
    v_mfma_f32_16x16x32_bf16 v[58:61], v[32:35], v[16:19], v[58:61]
    ds_read_b64_tr_b16 v[44:45], v11 offset:36864
    s_waitcnt lgkmcnt(6)
    v_mfma_f32_16x16x32_bf16 v[62:65], v[36:39], v[16:19], v[62:65]
    ds_read_b64_tr_b16 v[46:47], v11 offset:37376
    s_waitcnt lgkmcnt(5)
    v_mfma_f32_16x16x32_bf16 v[66:69], v[40:43], v[16:19], v[66:69]
    ds_read_b64_tr_b16 v[48:49], v12 offset:24576
    s_waitcnt lgkmcnt(5)
    v_mfma_f32_16x16x32_bf16 v[82:85], v[32:35], v[20:23], v[82:85]
    ds_read_b64_tr_b16 v[50:51], v12 offset:25088
    v_mfma_f32_16x16x32_bf16 v[86:89], v[36:39], v[20:23], v[86:89]
    ds_read_b64_tr_b16 v[52:53], v12 offset:36864
    v_mfma_f32_16x16x32_bf16 v[90:93], v[40:43], v[20:23], v[90:93]
    ds_read_b64_tr_b16 v[54:55], v12 offset:37376
    s_waitcnt lgkmcnt(7)
    v_mfma_f32_16x16x32_bf16 v[106:109], v[32:35], v[24:27], v[106:109]
    v_mfma_f32_16x16x32_bf16 v[110:113], v[36:39], v[24:27], v[110:113]
    v_mfma_f32_16x16x32_bf16 v[114:117], v[40:43], v[24:27], v[114:117]
    s_waitcnt lgkmcnt(6)
    v_mfma_f32_16x16x32_bf16 v[130:133], v[32:35], v[28:31], v[130:133]
    v_mfma_f32_16x16x32_bf16 v[134:137], v[36:39], v[28:31], v[134:137]
    v_mfma_f32_16x16x32_bf16 v[138:141], v[40:43], v[28:31], v[138:141]
    s_waitcnt lgkmcnt(0)
    s_barrier
    v_mfma_f32_16x16x32_bf16 v[70:73], v[44:47], v[16:19], v[70:73]
    ds_read_b64_tr_b16 v[32:33], v13 offset:0
    v_mfma_f32_16x16x32_bf16 v[74:77], v[48:51], v[16:19], v[74:77]
    ds_read_b64_tr_b16 v[34:35], v13 offset:512
    v_mfma_f32_16x16x32_bf16 v[78:81], v[52:55], v[16:19], v[78:81]
    ds_read_b64_tr_b16 v[36:37], v13 offset:12288
    ds_read_b128 v[16:19], v8 offset:0
    v_mfma_f32_16x16x32_bf16 v[94:97], v[44:47], v[20:23], v[94:97]
    ds_read_b64_tr_b16 v[38:39], v13 offset:12800
    v_mfma_f32_16x16x32_bf16 v[98:101], v[48:51], v[20:23], v[98:101]
    ds_read_b64_tr_b16 v[40:41], v14 offset:0
    v_mfma_f32_16x16x32_bf16 v[102:105], v[52:55], v[20:23], v[102:105]
    ds_read_b64_tr_b16 v[42:43], v14 offset:512
    ds_read_b128 v[20:23], v8 offset:2048
    v_mfma_f32_16x16x32_bf16 v[118:121], v[44:47], v[24:27], v[118:121]
    v_mfma_f32_16x16x32_bf16 v[122:125], v[48:51], v[24:27], v[122:125]
    v_mfma_f32_16x16x32_bf16 v[126:129], v[52:55], v[24:27], v[126:129]
    ds_read_b128 v[24:27], v8 offset:4096
    v_mfma_f32_16x16x32_bf16 v[142:145], v[44:47], v[28:31], v[142:145]
    v_mfma_f32_16x16x32_bf16 v[146:149], v[48:51], v[28:31], v[146:149]
    v_mfma_f32_16x16x32_bf16 v[150:153], v[52:55], v[28:31], v[150:153]
    ds_read_b128 v[28:31], v8 offset:6144
    s_waitcnt lgkmcnt(6)
    v_mfma_f32_16x16x32_bf16 v[58:61], v[32:35], v[16:19], v[58:61]
    ds_read_b64_tr_b16 v[44:45], v14 offset:12288
    s_waitcnt lgkmcnt(6)
    v_mfma_f32_16x16x32_bf16 v[62:65], v[36:39], v[16:19], v[62:65]
    ds_read_b64_tr_b16 v[46:47], v14 offset:12800
    s_waitcnt lgkmcnt(5)
    v_mfma_f32_16x16x32_bf16 v[66:69], v[40:43], v[16:19], v[66:69]
    ds_read_b64_tr_b16 v[48:49], v15 offset:0
    s_waitcnt lgkmcnt(5)
    v_mfma_f32_16x16x32_bf16 v[82:85], v[32:35], v[20:23], v[82:85]
    ds_read_b64_tr_b16 v[50:51], v15 offset:512
    v_mfma_f32_16x16x32_bf16 v[86:89], v[36:39], v[20:23], v[86:89]
    ds_read_b64_tr_b16 v[52:53], v15 offset:12288
    v_mfma_f32_16x16x32_bf16 v[90:93], v[40:43], v[20:23], v[90:93]
    ds_read_b64_tr_b16 v[54:55], v15 offset:12800
    s_waitcnt lgkmcnt(7)
    v_mfma_f32_16x16x32_bf16 v[106:109], v[32:35], v[24:27], v[106:109]
    v_mfma_f32_16x16x32_bf16 v[110:113], v[36:39], v[24:27], v[110:113]
    v_mfma_f32_16x16x32_bf16 v[114:117], v[40:43], v[24:27], v[114:117]
    s_waitcnt lgkmcnt(6)
    v_mfma_f32_16x16x32_bf16 v[130:133], v[32:35], v[28:31], v[130:133]
    v_mfma_f32_16x16x32_bf16 v[134:137], v[36:39], v[28:31], v[134:137]
    v_mfma_f32_16x16x32_bf16 v[138:141], v[40:43], v[28:31], v[138:141]
    s_waitcnt lgkmcnt(0)
    s_barrier
    v_mfma_f32_16x16x32_bf16 v[70:73], v[44:47], v[16:19], v[70:73]
    ds_read_b64_tr_b16 v[32:33], v13 offset:24576
    v_mfma_f32_16x16x32_bf16 v[74:77], v[48:51], v[16:19], v[74:77]
    ds_read_b64_tr_b16 v[34:35], v13 offset:25088
    v_mfma_f32_16x16x32_bf16 v[78:81], v[52:55], v[16:19], v[78:81]
    ds_read_b64_tr_b16 v[36:37], v13 offset:36864
    ds_read_b128 v[16:19], v9 offset:0
    v_mfma_f32_16x16x32_bf16 v[94:97], v[44:47], v[20:23], v[94:97]
    ds_read_b64_tr_b16 v[38:39], v13 offset:37376
    v_mfma_f32_16x16x32_bf16 v[98:101], v[48:51], v[20:23], v[98:101]
    ds_read_b64_tr_b16 v[40:41], v14 offset:24576
    v_mfma_f32_16x16x32_bf16 v[102:105], v[52:55], v[20:23], v[102:105]
    ds_read_b64_tr_b16 v[42:43], v14 offset:25088
    ds_read_b128 v[20:23], v9 offset:2048
    v_mfma_f32_16x16x32_bf16 v[118:121], v[44:47], v[24:27], v[118:121]
    v_mfma_f32_16x16x32_bf16 v[122:125], v[48:51], v[24:27], v[122:125]
    v_mfma_f32_16x16x32_bf16 v[126:129], v[52:55], v[24:27], v[126:129]
    ds_read_b128 v[24:27], v9 offset:4096
    v_mfma_f32_16x16x32_bf16 v[142:145], v[44:47], v[28:31], v[142:145]
    v_mfma_f32_16x16x32_bf16 v[146:149], v[48:51], v[28:31], v[146:149]
    v_mfma_f32_16x16x32_bf16 v[150:153], v[52:55], v[28:31], v[150:153]
    ds_read_b128 v[28:31], v9 offset:6144
    s_waitcnt lgkmcnt(6)
    v_mfma_f32_16x16x32_bf16 v[58:61], v[32:35], v[16:19], v[58:61]
    ds_read_b64_tr_b16 v[44:45], v14 offset:36864
    s_waitcnt lgkmcnt(6)
    v_mfma_f32_16x16x32_bf16 v[62:65], v[36:39], v[16:19], v[62:65]
    ds_read_b64_tr_b16 v[46:47], v14 offset:37376
    s_waitcnt lgkmcnt(5)
    v_mfma_f32_16x16x32_bf16 v[66:69], v[40:43], v[16:19], v[66:69]
    ds_read_b64_tr_b16 v[48:49], v15 offset:24576
    s_waitcnt lgkmcnt(5)
    v_mfma_f32_16x16x32_bf16 v[82:85], v[32:35], v[20:23], v[82:85]
    ds_read_b64_tr_b16 v[50:51], v15 offset:25088
    v_mfma_f32_16x16x32_bf16 v[86:89], v[36:39], v[20:23], v[86:89]
    ds_read_b64_tr_b16 v[52:53], v15 offset:36864
    v_mfma_f32_16x16x32_bf16 v[90:93], v[40:43], v[20:23], v[90:93]
    ds_read_b64_tr_b16 v[54:55], v15 offset:37376
    s_waitcnt lgkmcnt(7)
    v_mfma_f32_16x16x32_bf16 v[106:109], v[32:35], v[24:27], v[106:109]
    v_mfma_f32_16x16x32_bf16 v[110:113], v[36:39], v[24:27], v[110:113]
    v_mfma_f32_16x16x32_bf16 v[114:117], v[40:43], v[24:27], v[114:117]
    s_waitcnt lgkmcnt(6)
    v_mfma_f32_16x16x32_bf16 v[130:133], v[32:35], v[28:31], v[130:133]
    v_mfma_f32_16x16x32_bf16 v[134:137], v[36:39], v[28:31], v[134:137]
    v_mfma_f32_16x16x32_bf16 v[138:141], v[40:43], v[28:31], v[138:141]
    s_waitcnt lgkmcnt(0)
    s_barrier
    v_mfma_f32_16x16x32_bf16 v[70:73], v[44:47], v[16:19], v[70:73]
    ds_read_b64_tr_b16 v[32:33], v10 offset:0
    v_mfma_f32_16x16x32_bf16 v[74:77], v[48:51], v[16:19], v[74:77]
    ds_read_b64_tr_b16 v[34:35], v10 offset:512
    v_mfma_f32_16x16x32_bf16 v[78:81], v[52:55], v[16:19], v[78:81]
    ds_read_b64_tr_b16 v[36:37], v10 offset:12288
    ds_read_b128 v[16:19], v8 offset:32768
    v_mfma_f32_16x16x32_bf16 v[94:97], v[44:47], v[20:23], v[94:97]
    ds_read_b64_tr_b16 v[38:39], v10 offset:12800
    v_mfma_f32_16x16x32_bf16 v[98:101], v[48:51], v[20:23], v[98:101]
    ds_read_b64_tr_b16 v[40:41], v11 offset:0
    v_mfma_f32_16x16x32_bf16 v[102:105], v[52:55], v[20:23], v[102:105]
    ds_read_b64_tr_b16 v[42:43], v11 offset:512
    ds_read_b128 v[20:23], v8 offset:34816
    v_mfma_f32_16x16x32_bf16 v[118:121], v[44:47], v[24:27], v[118:121]
    v_mfma_f32_16x16x32_bf16 v[122:125], v[48:51], v[24:27], v[122:125]
    v_mfma_f32_16x16x32_bf16 v[126:129], v[52:55], v[24:27], v[126:129]
    ds_read_b128 v[24:27], v8 offset:36864
    v_mfma_f32_16x16x32_bf16 v[142:145], v[44:47], v[28:31], v[142:145]
    v_mfma_f32_16x16x32_bf16 v[146:149], v[48:51], v[28:31], v[146:149]
    v_mfma_f32_16x16x32_bf16 v[150:153], v[52:55], v[28:31], v[150:153]
    ds_read_b128 v[28:31], v8 offset:38912
    s_waitcnt lgkmcnt(6)
    v_mfma_f32_16x16x32_bf16 v[58:61], v[32:35], v[16:19], v[58:61]
    ds_read_b64_tr_b16 v[44:45], v11 offset:12288
    s_waitcnt lgkmcnt(6)
    v_mfma_f32_16x16x32_bf16 v[62:65], v[36:39], v[16:19], v[62:65]
    ds_read_b64_tr_b16 v[46:47], v11 offset:12800
    s_waitcnt lgkmcnt(5)
    v_mfma_f32_16x16x32_bf16 v[66:69], v[40:43], v[16:19], v[66:69]
    ds_read_b64_tr_b16 v[48:49], v12 offset:0
    s_waitcnt lgkmcnt(5)
    v_mfma_f32_16x16x32_bf16 v[82:85], v[32:35], v[20:23], v[82:85]
    ds_read_b64_tr_b16 v[50:51], v12 offset:512
    v_mfma_f32_16x16x32_bf16 v[86:89], v[36:39], v[20:23], v[86:89]
    ds_read_b64_tr_b16 v[52:53], v12 offset:12288
    v_mfma_f32_16x16x32_bf16 v[90:93], v[40:43], v[20:23], v[90:93]
    ds_read_b64_tr_b16 v[54:55], v12 offset:12800
    s_waitcnt lgkmcnt(7)
    v_mfma_f32_16x16x32_bf16 v[106:109], v[32:35], v[24:27], v[106:109]
    v_mfma_f32_16x16x32_bf16 v[110:113], v[36:39], v[24:27], v[110:113]
    v_mfma_f32_16x16x32_bf16 v[114:117], v[40:43], v[24:27], v[114:117]
    s_waitcnt lgkmcnt(6)
    v_mfma_f32_16x16x32_bf16 v[130:133], v[32:35], v[28:31], v[130:133]
    v_mfma_f32_16x16x32_bf16 v[134:137], v[36:39], v[28:31], v[134:137]
    v_mfma_f32_16x16x32_bf16 v[138:141], v[40:43], v[28:31], v[138:141]
    s_waitcnt lgkmcnt(0)
    s_barrier
    v_mfma_f32_16x16x32_bf16 v[70:73], v[44:47], v[16:19], v[70:73]
    ds_read_b64_tr_b16 v[32:33], v10 offset:24576
    v_mfma_f32_16x16x32_bf16 v[74:77], v[48:51], v[16:19], v[74:77]
    ds_read_b64_tr_b16 v[34:35], v10 offset:25088
    v_mfma_f32_16x16x32_bf16 v[78:81], v[52:55], v[16:19], v[78:81]
    ds_read_b64_tr_b16 v[36:37], v10 offset:36864
    ds_read_b128 v[16:19], v9 offset:32768
    v_mfma_f32_16x16x32_bf16 v[94:97], v[44:47], v[20:23], v[94:97]
    ds_read_b64_tr_b16 v[38:39], v10 offset:37376
    v_mfma_f32_16x16x32_bf16 v[98:101], v[48:51], v[20:23], v[98:101]
    ds_read_b64_tr_b16 v[40:41], v11 offset:24576
    v_mfma_f32_16x16x32_bf16 v[102:105], v[52:55], v[20:23], v[102:105]
    ds_read_b64_tr_b16 v[42:43], v11 offset:25088
    ds_read_b128 v[20:23], v9 offset:34816
    v_mfma_f32_16x16x32_bf16 v[118:121], v[44:47], v[24:27], v[118:121]
    v_mfma_f32_16x16x32_bf16 v[122:125], v[48:51], v[24:27], v[122:125]
    v_mfma_f32_16x16x32_bf16 v[126:129], v[52:55], v[24:27], v[126:129]
    ds_read_b128 v[24:27], v9 offset:36864
    v_mfma_f32_16x16x32_bf16 v[142:145], v[44:47], v[28:31], v[142:145]
    v_mfma_f32_16x16x32_bf16 v[146:149], v[48:51], v[28:31], v[146:149]
    v_mfma_f32_16x16x32_bf16 v[150:153], v[52:55], v[28:31], v[150:153]
    ds_read_b128 v[28:31], v9 offset:38912
    s_waitcnt lgkmcnt(6)
    v_mfma_f32_16x16x32_bf16 v[58:61], v[32:35], v[16:19], v[58:61]
    ds_read_b64_tr_b16 v[44:45], v11 offset:36864
    s_waitcnt lgkmcnt(6)
    v_mfma_f32_16x16x32_bf16 v[62:65], v[36:39], v[16:19], v[62:65]
    ds_read_b64_tr_b16 v[46:47], v11 offset:37376
    s_waitcnt lgkmcnt(5)
    v_mfma_f32_16x16x32_bf16 v[66:69], v[40:43], v[16:19], v[66:69]
    ds_read_b64_tr_b16 v[48:49], v12 offset:24576
    s_waitcnt lgkmcnt(5)
    v_mfma_f32_16x16x32_bf16 v[82:85], v[32:35], v[20:23], v[82:85]
    ds_read_b64_tr_b16 v[50:51], v12 offset:25088
    v_mfma_f32_16x16x32_bf16 v[86:89], v[36:39], v[20:23], v[86:89]
    ds_read_b64_tr_b16 v[52:53], v12 offset:36864
    v_mfma_f32_16x16x32_bf16 v[90:93], v[40:43], v[20:23], v[90:93]
    ds_read_b64_tr_b16 v[54:55], v12 offset:37376
    s_waitcnt lgkmcnt(7)
    v_mfma_f32_16x16x32_bf16 v[106:109], v[32:35], v[24:27], v[106:109]
    v_mfma_f32_16x16x32_bf16 v[110:113], v[36:39], v[24:27], v[110:113]
    v_mfma_f32_16x16x32_bf16 v[114:117], v[40:43], v[24:27], v[114:117]
    s_waitcnt lgkmcnt(6)
    v_mfma_f32_16x16x32_bf16 v[130:133], v[32:35], v[28:31], v[130:133]
    v_mfma_f32_16x16x32_bf16 v[134:137], v[36:39], v[28:31], v[134:137]
    v_mfma_f32_16x16x32_bf16 v[138:141], v[40:43], v[28:31], v[138:141]
    s_waitcnt lgkmcnt(0)
    s_barrier
    v_mfma_f32_16x16x32_bf16 v[70:73], v[44:47], v[16:19], v[70:73]
    ds_read_b64_tr_b16 v[32:33], v13 offset:0
    v_mfma_f32_16x16x32_bf16 v[74:77], v[48:51], v[16:19], v[74:77]
    ds_read_b64_tr_b16 v[34:35], v13 offset:512
    v_mfma_f32_16x16x32_bf16 v[78:81], v[52:55], v[16:19], v[78:81]
    ds_read_b64_tr_b16 v[36:37], v13 offset:12288
    ds_read_b128 v[16:19], v8 offset:16384
    v_mfma_f32_16x16x32_bf16 v[94:97], v[44:47], v[20:23], v[94:97]
    ds_read_b64_tr_b16 v[38:39], v13 offset:12800
    v_mfma_f32_16x16x32_bf16 v[98:101], v[48:51], v[20:23], v[98:101]
    ds_read_b64_tr_b16 v[40:41], v14 offset:0
    v_mfma_f32_16x16x32_bf16 v[102:105], v[52:55], v[20:23], v[102:105]
    ds_read_b64_tr_b16 v[42:43], v14 offset:512
    ds_read_b128 v[20:23], v8 offset:18432
    v_mfma_f32_16x16x32_bf16 v[118:121], v[44:47], v[24:27], v[118:121]
    v_mfma_f32_16x16x32_bf16 v[122:125], v[48:51], v[24:27], v[122:125]
    v_mfma_f32_16x16x32_bf16 v[126:129], v[52:55], v[24:27], v[126:129]
    ds_read_b128 v[24:27], v8 offset:20480
    v_mfma_f32_16x16x32_bf16 v[142:145], v[44:47], v[28:31], v[142:145]
    v_mfma_f32_16x16x32_bf16 v[146:149], v[48:51], v[28:31], v[146:149]
    v_mfma_f32_16x16x32_bf16 v[150:153], v[52:55], v[28:31], v[150:153]
    ds_read_b128 v[28:31], v8 offset:22528
    s_waitcnt lgkmcnt(6)
    v_mfma_f32_16x16x32_bf16 v[58:61], v[32:35], v[16:19], v[58:61]
    ds_read_b64_tr_b16 v[44:45], v14 offset:12288
    s_waitcnt lgkmcnt(6)
    v_mfma_f32_16x16x32_bf16 v[62:65], v[36:39], v[16:19], v[62:65]
    ds_read_b64_tr_b16 v[46:47], v14 offset:12800
    s_waitcnt lgkmcnt(5)
    v_mfma_f32_16x16x32_bf16 v[66:69], v[40:43], v[16:19], v[66:69]
    ds_read_b64_tr_b16 v[48:49], v15 offset:0
    s_waitcnt lgkmcnt(5)
    v_mfma_f32_16x16x32_bf16 v[82:85], v[32:35], v[20:23], v[82:85]
    ds_read_b64_tr_b16 v[50:51], v15 offset:512
    v_mfma_f32_16x16x32_bf16 v[86:89], v[36:39], v[20:23], v[86:89]
    ds_read_b64_tr_b16 v[52:53], v15 offset:12288
    v_mfma_f32_16x16x32_bf16 v[90:93], v[40:43], v[20:23], v[90:93]
    ds_read_b64_tr_b16 v[54:55], v15 offset:12800
    s_waitcnt lgkmcnt(7)
    v_mfma_f32_16x16x32_bf16 v[106:109], v[32:35], v[24:27], v[106:109]
    v_mfma_f32_16x16x32_bf16 v[110:113], v[36:39], v[24:27], v[110:113]
    v_mfma_f32_16x16x32_bf16 v[114:117], v[40:43], v[24:27], v[114:117]
    s_waitcnt lgkmcnt(6)
    v_mfma_f32_16x16x32_bf16 v[130:133], v[32:35], v[28:31], v[130:133]
    v_mfma_f32_16x16x32_bf16 v[134:137], v[36:39], v[28:31], v[134:137]
    v_mfma_f32_16x16x32_bf16 v[138:141], v[40:43], v[28:31], v[138:141]
    s_waitcnt lgkmcnt(0)
    s_barrier
    v_mfma_f32_16x16x32_bf16 v[70:73], v[44:47], v[16:19], v[70:73]
    ds_read_b64_tr_b16 v[32:33], v13 offset:24576
    v_mfma_f32_16x16x32_bf16 v[74:77], v[48:51], v[16:19], v[74:77]
    ds_read_b64_tr_b16 v[34:35], v13 offset:25088
    v_mfma_f32_16x16x32_bf16 v[78:81], v[52:55], v[16:19], v[78:81]
    ds_read_b64_tr_b16 v[36:37], v13 offset:36864
    ds_read_b128 v[16:19], v9 offset:16384
    v_mfma_f32_16x16x32_bf16 v[94:97], v[44:47], v[20:23], v[94:97]
    ds_read_b64_tr_b16 v[38:39], v13 offset:37376
    v_mfma_f32_16x16x32_bf16 v[98:101], v[48:51], v[20:23], v[98:101]
    ds_read_b64_tr_b16 v[40:41], v14 offset:24576
    v_mfma_f32_16x16x32_bf16 v[102:105], v[52:55], v[20:23], v[102:105]
    ds_read_b64_tr_b16 v[42:43], v14 offset:25088
    ds_read_b128 v[20:23], v9 offset:18432
    v_mfma_f32_16x16x32_bf16 v[118:121], v[44:47], v[24:27], v[118:121]
    v_mfma_f32_16x16x32_bf16 v[122:125], v[48:51], v[24:27], v[122:125]
    v_mfma_f32_16x16x32_bf16 v[126:129], v[52:55], v[24:27], v[126:129]
    ds_read_b128 v[24:27], v9 offset:20480
    v_mfma_f32_16x16x32_bf16 v[142:145], v[44:47], v[28:31], v[142:145]
    v_mfma_f32_16x16x32_bf16 v[146:149], v[48:51], v[28:31], v[146:149]
    v_mfma_f32_16x16x32_bf16 v[150:153], v[52:55], v[28:31], v[150:153]
    ds_read_b128 v[28:31], v9 offset:22528
    s_waitcnt lgkmcnt(6)
    v_mfma_f32_16x16x32_bf16 v[58:61], v[32:35], v[16:19], v[58:61]
    ds_read_b64_tr_b16 v[44:45], v14 offset:36864
    s_waitcnt lgkmcnt(6)
    v_mfma_f32_16x16x32_bf16 v[62:65], v[36:39], v[16:19], v[62:65]
    ds_read_b64_tr_b16 v[46:47], v14 offset:37376
    s_waitcnt lgkmcnt(5)
    v_mfma_f32_16x16x32_bf16 v[66:69], v[40:43], v[16:19], v[66:69]
    ds_read_b64_tr_b16 v[48:49], v15 offset:24576
    s_waitcnt lgkmcnt(5)
    v_mfma_f32_16x16x32_bf16 v[82:85], v[32:35], v[20:23], v[82:85]
    ds_read_b64_tr_b16 v[50:51], v15 offset:25088
    v_mfma_f32_16x16x32_bf16 v[86:89], v[36:39], v[20:23], v[86:89]
    ds_read_b64_tr_b16 v[52:53], v15 offset:36864
    v_mfma_f32_16x16x32_bf16 v[90:93], v[40:43], v[20:23], v[90:93]
    ds_read_b64_tr_b16 v[54:55], v15 offset:37376
    s_waitcnt lgkmcnt(7)
    v_mfma_f32_16x16x32_bf16 v[106:109], v[32:35], v[24:27], v[106:109]
    v_mfma_f32_16x16x32_bf16 v[110:113], v[36:39], v[24:27], v[110:113]
    v_mfma_f32_16x16x32_bf16 v[114:117], v[40:43], v[24:27], v[114:117]
    s_waitcnt lgkmcnt(6)
    v_mfma_f32_16x16x32_bf16 v[130:133], v[32:35], v[28:31], v[130:133]
    v_mfma_f32_16x16x32_bf16 v[134:137], v[36:39], v[28:31], v[134:137]
    v_mfma_f32_16x16x32_bf16 v[138:141], v[40:43], v[28:31], v[138:141]
    s_waitcnt lgkmcnt(0)
    s_barrier
    v_mfma_f32_16x16x32_bf16 v[70:73], v[44:47], v[16:19], v[70:73]
    ds_read_b64_tr_b16 v[32:33], v10 offset:0
    v_mfma_f32_16x16x32_bf16 v[74:77], v[48:51], v[16:19], v[74:77]
    ds_read_b64_tr_b16 v[34:35], v10 offset:512
    v_mfma_f32_16x16x32_bf16 v[78:81], v[52:55], v[16:19], v[78:81]
    ds_read_b64_tr_b16 v[36:37], v10 offset:12288
    ds_read_b128 v[16:19], v8 offset:0
    v_mfma_f32_16x16x32_bf16 v[94:97], v[44:47], v[20:23], v[94:97]
    ds_read_b64_tr_b16 v[38:39], v10 offset:12800
    v_mfma_f32_16x16x32_bf16 v[98:101], v[48:51], v[20:23], v[98:101]
    ds_read_b64_tr_b16 v[40:41], v11 offset:0
    v_mfma_f32_16x16x32_bf16 v[102:105], v[52:55], v[20:23], v[102:105]
    ds_read_b64_tr_b16 v[42:43], v11 offset:512
    ds_read_b128 v[20:23], v8 offset:2048
    v_mfma_f32_16x16x32_bf16 v[118:121], v[44:47], v[24:27], v[118:121]
    v_mfma_f32_16x16x32_bf16 v[122:125], v[48:51], v[24:27], v[122:125]
    v_mfma_f32_16x16x32_bf16 v[126:129], v[52:55], v[24:27], v[126:129]
    ds_read_b128 v[24:27], v8 offset:4096
    v_mfma_f32_16x16x32_bf16 v[142:145], v[44:47], v[28:31], v[142:145]
    v_mfma_f32_16x16x32_bf16 v[146:149], v[48:51], v[28:31], v[146:149]
    v_mfma_f32_16x16x32_bf16 v[150:153], v[52:55], v[28:31], v[150:153]
    ds_read_b128 v[28:31], v8 offset:6144
    s_waitcnt lgkmcnt(6)
    v_mfma_f32_16x16x32_bf16 v[58:61], v[32:35], v[16:19], v[58:61]
    ds_read_b64_tr_b16 v[44:45], v11 offset:12288
    s_waitcnt lgkmcnt(6)
    v_mfma_f32_16x16x32_bf16 v[62:65], v[36:39], v[16:19], v[62:65]
    ds_read_b64_tr_b16 v[46:47], v11 offset:12800
    s_waitcnt lgkmcnt(5)
    v_mfma_f32_16x16x32_bf16 v[66:69], v[40:43], v[16:19], v[66:69]
    ds_read_b64_tr_b16 v[48:49], v12 offset:0
    s_waitcnt lgkmcnt(5)
    v_mfma_f32_16x16x32_bf16 v[82:85], v[32:35], v[20:23], v[82:85]
    ds_read_b64_tr_b16 v[50:51], v12 offset:512
    v_mfma_f32_16x16x32_bf16 v[86:89], v[36:39], v[20:23], v[86:89]
    ds_read_b64_tr_b16 v[52:53], v12 offset:12288
    v_mfma_f32_16x16x32_bf16 v[90:93], v[40:43], v[20:23], v[90:93]
    ds_read_b64_tr_b16 v[54:55], v12 offset:12800
    s_waitcnt lgkmcnt(7)
    v_mfma_f32_16x16x32_bf16 v[106:109], v[32:35], v[24:27], v[106:109]
    v_mfma_f32_16x16x32_bf16 v[110:113], v[36:39], v[24:27], v[110:113]
    v_mfma_f32_16x16x32_bf16 v[114:117], v[40:43], v[24:27], v[114:117]
    s_waitcnt lgkmcnt(6)
    v_mfma_f32_16x16x32_bf16 v[130:133], v[32:35], v[28:31], v[130:133]
    v_mfma_f32_16x16x32_bf16 v[134:137], v[36:39], v[28:31], v[134:137]
    v_mfma_f32_16x16x32_bf16 v[138:141], v[40:43], v[28:31], v[138:141]
    s_waitcnt lgkmcnt(0)
    s_barrier
    v_mfma_f32_16x16x32_bf16 v[70:73], v[44:47], v[16:19], v[70:73]
    ds_read_b64_tr_b16 v[32:33], v10 offset:24576
    v_mfma_f32_16x16x32_bf16 v[74:77], v[48:51], v[16:19], v[74:77]
    ds_read_b64_tr_b16 v[34:35], v10 offset:25088
    v_mfma_f32_16x16x32_bf16 v[78:81], v[52:55], v[16:19], v[78:81]
    ds_read_b64_tr_b16 v[36:37], v10 offset:36864
    ds_read_b128 v[16:19], v9 offset:0
    v_mfma_f32_16x16x32_bf16 v[94:97], v[44:47], v[20:23], v[94:97]
    ds_read_b64_tr_b16 v[38:39], v10 offset:37376
    v_mfma_f32_16x16x32_bf16 v[98:101], v[48:51], v[20:23], v[98:101]
    ds_read_b64_tr_b16 v[40:41], v11 offset:24576
    v_mfma_f32_16x16x32_bf16 v[102:105], v[52:55], v[20:23], v[102:105]
    ds_read_b64_tr_b16 v[42:43], v11 offset:25088
    ds_read_b128 v[20:23], v9 offset:2048
    v_mfma_f32_16x16x32_bf16 v[118:121], v[44:47], v[24:27], v[118:121]
    v_mfma_f32_16x16x32_bf16 v[122:125], v[48:51], v[24:27], v[122:125]
    v_mfma_f32_16x16x32_bf16 v[126:129], v[52:55], v[24:27], v[126:129]
    ds_read_b128 v[24:27], v9 offset:4096
    v_mfma_f32_16x16x32_bf16 v[142:145], v[44:47], v[28:31], v[142:145]
    v_mfma_f32_16x16x32_bf16 v[146:149], v[48:51], v[28:31], v[146:149]
    v_mfma_f32_16x16x32_bf16 v[150:153], v[52:55], v[28:31], v[150:153]
    ds_read_b128 v[28:31], v9 offset:6144
    s_waitcnt lgkmcnt(6)
    v_mfma_f32_16x16x32_bf16 v[58:61], v[32:35], v[16:19], v[58:61]
    ds_read_b64_tr_b16 v[44:45], v11 offset:36864
    s_waitcnt lgkmcnt(6)
    v_mfma_f32_16x16x32_bf16 v[62:65], v[36:39], v[16:19], v[62:65]
    ds_read_b64_tr_b16 v[46:47], v11 offset:37376
    s_waitcnt lgkmcnt(5)
    v_mfma_f32_16x16x32_bf16 v[66:69], v[40:43], v[16:19], v[66:69]
    ds_read_b64_tr_b16 v[48:49], v12 offset:24576
    s_waitcnt lgkmcnt(5)
    v_mfma_f32_16x16x32_bf16 v[82:85], v[32:35], v[20:23], v[82:85]
    ds_read_b64_tr_b16 v[50:51], v12 offset:25088
    v_mfma_f32_16x16x32_bf16 v[86:89], v[36:39], v[20:23], v[86:89]
    ds_read_b64_tr_b16 v[52:53], v12 offset:36864
    v_mfma_f32_16x16x32_bf16 v[90:93], v[40:43], v[20:23], v[90:93]
    ds_read_b64_tr_b16 v[54:55], v12 offset:37376
    s_waitcnt lgkmcnt(7)
    v_mfma_f32_16x16x32_bf16 v[106:109], v[32:35], v[24:27], v[106:109]
    v_mfma_f32_16x16x32_bf16 v[110:113], v[36:39], v[24:27], v[110:113]
    v_mfma_f32_16x16x32_bf16 v[114:117], v[40:43], v[24:27], v[114:117]
    s_waitcnt lgkmcnt(6)
    v_mfma_f32_16x16x32_bf16 v[130:133], v[32:35], v[28:31], v[130:133]
    v_mfma_f32_16x16x32_bf16 v[134:137], v[36:39], v[28:31], v[134:137]
    v_mfma_f32_16x16x32_bf16 v[138:141], v[40:43], v[28:31], v[138:141]
    s_waitcnt lgkmcnt(0)
    s_barrier
    v_mfma_f32_16x16x32_bf16 v[70:73], v[44:47], v[16:19], v[70:73]
    ds_read_b64_tr_b16 v[32:33], v13 offset:0
    v_mfma_f32_16x16x32_bf16 v[74:77], v[48:51], v[16:19], v[74:77]
    ds_read_b64_tr_b16 v[34:35], v13 offset:512
    v_mfma_f32_16x16x32_bf16 v[78:81], v[52:55], v[16:19], v[78:81]
    ds_read_b64_tr_b16 v[36:37], v13 offset:12288
    ds_read_b128 v[16:19], v8 offset:32768
    v_mfma_f32_16x16x32_bf16 v[94:97], v[44:47], v[20:23], v[94:97]
    ds_read_b64_tr_b16 v[38:39], v13 offset:12800
    v_mfma_f32_16x16x32_bf16 v[98:101], v[48:51], v[20:23], v[98:101]
    ds_read_b64_tr_b16 v[40:41], v14 offset:0
    v_mfma_f32_16x16x32_bf16 v[102:105], v[52:55], v[20:23], v[102:105]
    ds_read_b64_tr_b16 v[42:43], v14 offset:512
    ds_read_b128 v[20:23], v8 offset:34816
    v_mfma_f32_16x16x32_bf16 v[118:121], v[44:47], v[24:27], v[118:121]
    v_mfma_f32_16x16x32_bf16 v[122:125], v[48:51], v[24:27], v[122:125]
    v_mfma_f32_16x16x32_bf16 v[126:129], v[52:55], v[24:27], v[126:129]
    ds_read_b128 v[24:27], v8 offset:36864
    v_mfma_f32_16x16x32_bf16 v[142:145], v[44:47], v[28:31], v[142:145]
    v_mfma_f32_16x16x32_bf16 v[146:149], v[48:51], v[28:31], v[146:149]
    v_mfma_f32_16x16x32_bf16 v[150:153], v[52:55], v[28:31], v[150:153]
    ds_read_b128 v[28:31], v8 offset:38912
    s_waitcnt lgkmcnt(6)
    v_mfma_f32_16x16x32_bf16 v[58:61], v[32:35], v[16:19], v[58:61]
    ds_read_b64_tr_b16 v[44:45], v14 offset:12288
    s_waitcnt lgkmcnt(6)
    v_mfma_f32_16x16x32_bf16 v[62:65], v[36:39], v[16:19], v[62:65]
    ds_read_b64_tr_b16 v[46:47], v14 offset:12800
    s_waitcnt lgkmcnt(5)
    v_mfma_f32_16x16x32_bf16 v[66:69], v[40:43], v[16:19], v[66:69]
    ds_read_b64_tr_b16 v[48:49], v15 offset:0
    s_waitcnt lgkmcnt(5)
    v_mfma_f32_16x16x32_bf16 v[82:85], v[32:35], v[20:23], v[82:85]
    ds_read_b64_tr_b16 v[50:51], v15 offset:512
    v_mfma_f32_16x16x32_bf16 v[86:89], v[36:39], v[20:23], v[86:89]
    ds_read_b64_tr_b16 v[52:53], v15 offset:12288
    v_mfma_f32_16x16x32_bf16 v[90:93], v[40:43], v[20:23], v[90:93]
    ds_read_b64_tr_b16 v[54:55], v15 offset:12800
    s_waitcnt lgkmcnt(7)
    v_mfma_f32_16x16x32_bf16 v[106:109], v[32:35], v[24:27], v[106:109]
    v_mfma_f32_16x16x32_bf16 v[110:113], v[36:39], v[24:27], v[110:113]
    v_mfma_f32_16x16x32_bf16 v[114:117], v[40:43], v[24:27], v[114:117]
    s_waitcnt lgkmcnt(6)
    v_mfma_f32_16x16x32_bf16 v[130:133], v[32:35], v[28:31], v[130:133]
    v_mfma_f32_16x16x32_bf16 v[134:137], v[36:39], v[28:31], v[134:137]
    v_mfma_f32_16x16x32_bf16 v[138:141], v[40:43], v[28:31], v[138:141]
    s_waitcnt lgkmcnt(0)
    s_barrier
    v_mfma_f32_16x16x32_bf16 v[70:73], v[44:47], v[16:19], v[70:73]
    ds_read_b64_tr_b16 v[32:33], v13 offset:24576
    v_mfma_f32_16x16x32_bf16 v[74:77], v[48:51], v[16:19], v[74:77]
    ds_read_b64_tr_b16 v[34:35], v13 offset:25088
    v_mfma_f32_16x16x32_bf16 v[78:81], v[52:55], v[16:19], v[78:81]
    ds_read_b64_tr_b16 v[36:37], v13 offset:36864
    ds_read_b128 v[16:19], v9 offset:32768
    v_mfma_f32_16x16x32_bf16 v[94:97], v[44:47], v[20:23], v[94:97]
    ds_read_b64_tr_b16 v[38:39], v13 offset:37376
    v_mfma_f32_16x16x32_bf16 v[98:101], v[48:51], v[20:23], v[98:101]
    ds_read_b64_tr_b16 v[40:41], v14 offset:24576
    v_mfma_f32_16x16x32_bf16 v[102:105], v[52:55], v[20:23], v[102:105]
    ds_read_b64_tr_b16 v[42:43], v14 offset:25088
    ds_read_b128 v[20:23], v9 offset:34816
    v_mfma_f32_16x16x32_bf16 v[118:121], v[44:47], v[24:27], v[118:121]
    v_mfma_f32_16x16x32_bf16 v[122:125], v[48:51], v[24:27], v[122:125]
    v_mfma_f32_16x16x32_bf16 v[126:129], v[52:55], v[24:27], v[126:129]
    ds_read_b128 v[24:27], v9 offset:36864
    v_mfma_f32_16x16x32_bf16 v[142:145], v[44:47], v[28:31], v[142:145]
    v_mfma_f32_16x16x32_bf16 v[146:149], v[48:51], v[28:31], v[146:149]
    v_mfma_f32_16x16x32_bf16 v[150:153], v[52:55], v[28:31], v[150:153]
    ds_read_b128 v[28:31], v9 offset:38912
    s_waitcnt lgkmcnt(6)
    v_mfma_f32_16x16x32_bf16 v[58:61], v[32:35], v[16:19], v[58:61]
    ds_read_b64_tr_b16 v[44:45], v14 offset:36864
    s_waitcnt lgkmcnt(6)
    v_mfma_f32_16x16x32_bf16 v[62:65], v[36:39], v[16:19], v[62:65]
    ds_read_b64_tr_b16 v[46:47], v14 offset:37376
    s_waitcnt lgkmcnt(5)
    v_mfma_f32_16x16x32_bf16 v[66:69], v[40:43], v[16:19], v[66:69]
    ds_read_b64_tr_b16 v[48:49], v15 offset:24576
    s_waitcnt lgkmcnt(5)
    v_mfma_f32_16x16x32_bf16 v[82:85], v[32:35], v[20:23], v[82:85]
    ds_read_b64_tr_b16 v[50:51], v15 offset:25088
    v_mfma_f32_16x16x32_bf16 v[86:89], v[36:39], v[20:23], v[86:89]
    ds_read_b64_tr_b16 v[52:53], v15 offset:36864
    v_mfma_f32_16x16x32_bf16 v[90:93], v[40:43], v[20:23], v[90:93]
    ds_read_b64_tr_b16 v[54:55], v15 offset:37376
    s_waitcnt lgkmcnt(7)
    v_mfma_f32_16x16x32_bf16 v[106:109], v[32:35], v[24:27], v[106:109]
    v_mfma_f32_16x16x32_bf16 v[110:113], v[36:39], v[24:27], v[110:113]
    v_mfma_f32_16x16x32_bf16 v[114:117], v[40:43], v[24:27], v[114:117]
    s_waitcnt lgkmcnt(6)
    v_mfma_f32_16x16x32_bf16 v[130:133], v[32:35], v[28:31], v[130:133]
    v_mfma_f32_16x16x32_bf16 v[134:137], v[36:39], v[28:31], v[134:137]
    v_mfma_f32_16x16x32_bf16 v[138:141], v[40:43], v[28:31], v[138:141]
    s_waitcnt lgkmcnt(0)
    s_barrier
    v_mfma_f32_16x16x32_bf16 v[70:73], v[44:47], v[16:19], v[70:73]
    ds_read_b64_tr_b16 v[32:33], v10 offset:0
    v_mfma_f32_16x16x32_bf16 v[74:77], v[48:51], v[16:19], v[74:77]
    ds_read_b64_tr_b16 v[34:35], v10 offset:512
    v_mfma_f32_16x16x32_bf16 v[78:81], v[52:55], v[16:19], v[78:81]
    ds_read_b64_tr_b16 v[36:37], v10 offset:12288
    ds_read_b128 v[16:19], v8 offset:16384
    v_mfma_f32_16x16x32_bf16 v[94:97], v[44:47], v[20:23], v[94:97]
    ds_read_b64_tr_b16 v[38:39], v10 offset:12800
    v_mfma_f32_16x16x32_bf16 v[98:101], v[48:51], v[20:23], v[98:101]
    ds_read_b64_tr_b16 v[40:41], v11 offset:0
    v_mfma_f32_16x16x32_bf16 v[102:105], v[52:55], v[20:23], v[102:105]
    ds_read_b64_tr_b16 v[42:43], v11 offset:512
    ds_read_b128 v[20:23], v8 offset:18432
    v_mfma_f32_16x16x32_bf16 v[118:121], v[44:47], v[24:27], v[118:121]
    v_mfma_f32_16x16x32_bf16 v[122:125], v[48:51], v[24:27], v[122:125]
    v_mfma_f32_16x16x32_bf16 v[126:129], v[52:55], v[24:27], v[126:129]
    ds_read_b128 v[24:27], v8 offset:20480
    v_mfma_f32_16x16x32_bf16 v[142:145], v[44:47], v[28:31], v[142:145]
    v_mfma_f32_16x16x32_bf16 v[146:149], v[48:51], v[28:31], v[146:149]
    v_mfma_f32_16x16x32_bf16 v[150:153], v[52:55], v[28:31], v[150:153]
    ds_read_b128 v[28:31], v8 offset:22528
    s_waitcnt lgkmcnt(6)
    v_mfma_f32_16x16x32_bf16 v[58:61], v[32:35], v[16:19], v[58:61]
    ds_read_b64_tr_b16 v[44:45], v11 offset:12288
    s_waitcnt lgkmcnt(6)
    v_mfma_f32_16x16x32_bf16 v[62:65], v[36:39], v[16:19], v[62:65]
    ds_read_b64_tr_b16 v[46:47], v11 offset:12800
    s_waitcnt lgkmcnt(5)
    v_mfma_f32_16x16x32_bf16 v[66:69], v[40:43], v[16:19], v[66:69]
    ds_read_b64_tr_b16 v[48:49], v12 offset:0
    s_waitcnt lgkmcnt(5)
    v_mfma_f32_16x16x32_bf16 v[82:85], v[32:35], v[20:23], v[82:85]
    ds_read_b64_tr_b16 v[50:51], v12 offset:512
    v_mfma_f32_16x16x32_bf16 v[86:89], v[36:39], v[20:23], v[86:89]
    ds_read_b64_tr_b16 v[52:53], v12 offset:12288
    v_mfma_f32_16x16x32_bf16 v[90:93], v[40:43], v[20:23], v[90:93]
    ds_read_b64_tr_b16 v[54:55], v12 offset:12800
    s_waitcnt lgkmcnt(7)
    v_mfma_f32_16x16x32_bf16 v[106:109], v[32:35], v[24:27], v[106:109]
    v_mfma_f32_16x16x32_bf16 v[110:113], v[36:39], v[24:27], v[110:113]
    v_mfma_f32_16x16x32_bf16 v[114:117], v[40:43], v[24:27], v[114:117]
    s_waitcnt lgkmcnt(6)
    v_mfma_f32_16x16x32_bf16 v[130:133], v[32:35], v[28:31], v[130:133]
    v_mfma_f32_16x16x32_bf16 v[134:137], v[36:39], v[28:31], v[134:137]
    v_mfma_f32_16x16x32_bf16 v[138:141], v[40:43], v[28:31], v[138:141]
    s_waitcnt lgkmcnt(0)
    s_barrier
    s_cmp_ge_u32 s38, 4
    s_cbranch_scc1 gated_mix__softmax_full_mha__glu_gated_glu__prompt_kernel_npgu
    s_setprio 1
gated_mix__softmax_full_mha__glu_gated_glu__prompt_kernel_npgu:
    v_mfma_f32_16x16x32_bf16 v[70:73], v[44:47], v[16:19], v[70:73]
    ds_read_b64_tr_b16 v[32:33], v10 offset:24576
    v_mfma_f32_16x16x32_bf16 v[74:77], v[48:51], v[16:19], v[74:77]
    ds_read_b64_tr_b16 v[34:35], v10 offset:25088
    v_mfma_f32_16x16x32_bf16 v[78:81], v[52:55], v[16:19], v[78:81]
    ds_read_b64_tr_b16 v[36:37], v10 offset:36864
    ds_read_b128 v[16:19], v9 offset:16384
    v_mfma_f32_16x16x32_bf16 v[94:97], v[44:47], v[20:23], v[94:97]
    ds_read_b64_tr_b16 v[38:39], v10 offset:37376
    v_mfma_f32_16x16x32_bf16 v[98:101], v[48:51], v[20:23], v[98:101]
    ds_read_b64_tr_b16 v[40:41], v11 offset:24576
    v_mfma_f32_16x16x32_bf16 v[102:105], v[52:55], v[20:23], v[102:105]
    ds_read_b64_tr_b16 v[42:43], v11 offset:25088
    ds_read_b128 v[20:23], v9 offset:18432
    v_mfma_f32_16x16x32_bf16 v[118:121], v[44:47], v[24:27], v[118:121]
    v_mfma_f32_16x16x32_bf16 v[122:125], v[48:51], v[24:27], v[122:125]
    v_mfma_f32_16x16x32_bf16 v[126:129], v[52:55], v[24:27], v[126:129]
    ds_read_b128 v[24:27], v9 offset:20480
    v_mfma_f32_16x16x32_bf16 v[142:145], v[44:47], v[28:31], v[142:145]
    v_mfma_f32_16x16x32_bf16 v[146:149], v[48:51], v[28:31], v[146:149]
    v_mfma_f32_16x16x32_bf16 v[150:153], v[52:55], v[28:31], v[150:153]
    ds_read_b128 v[28:31], v9 offset:22528
    s_waitcnt lgkmcnt(6)
    v_mfma_f32_16x16x32_bf16 v[58:61], v[32:35], v[16:19], v[58:61]
    ds_read_b64_tr_b16 v[44:45], v11 offset:36864
    s_waitcnt lgkmcnt(6)
    v_mfma_f32_16x16x32_bf16 v[62:65], v[36:39], v[16:19], v[62:65]
    ds_read_b64_tr_b16 v[46:47], v11 offset:37376
    s_waitcnt lgkmcnt(5)
    v_mfma_f32_16x16x32_bf16 v[66:69], v[40:43], v[16:19], v[66:69]
    ds_read_b64_tr_b16 v[48:49], v12 offset:24576
    s_waitcnt lgkmcnt(5)
    v_mfma_f32_16x16x32_bf16 v[82:85], v[32:35], v[20:23], v[82:85]
    ds_read_b64_tr_b16 v[50:51], v12 offset:25088
    v_mfma_f32_16x16x32_bf16 v[86:89], v[36:39], v[20:23], v[86:89]
    ds_read_b64_tr_b16 v[52:53], v12 offset:36864
    v_mfma_f32_16x16x32_bf16 v[90:93], v[40:43], v[20:23], v[90:93]
    ds_read_b64_tr_b16 v[54:55], v12 offset:37376
    s_waitcnt lgkmcnt(7)
    v_mfma_f32_16x16x32_bf16 v[106:109], v[32:35], v[24:27], v[106:109]
    v_mfma_f32_16x16x32_bf16 v[110:113], v[36:39], v[24:27], v[110:113]
    v_mfma_f32_16x16x32_bf16 v[114:117], v[40:43], v[24:27], v[114:117]
    s_waitcnt lgkmcnt(6)
    v_mfma_f32_16x16x32_bf16 v[130:133], v[32:35], v[28:31], v[130:133]
    v_mfma_f32_16x16x32_bf16 v[134:137], v[36:39], v[28:31], v[134:137]
    v_mfma_f32_16x16x32_bf16 v[138:141], v[40:43], v[28:31], v[138:141]
    s_waitcnt lgkmcnt(4)
    v_mfma_f32_16x16x32_bf16 v[70:73], v[44:47], v[16:19], v[70:73]
    ds_read_b64_tr_b16 v[32:33], v13 offset:0
    s_waitcnt lgkmcnt(3)
    v_mfma_f32_16x16x32_bf16 v[74:77], v[48:51], v[16:19], v[74:77]
    ds_read_b64_tr_b16 v[34:35], v13 offset:512
    s_waitcnt lgkmcnt(2)
    v_mfma_f32_16x16x32_bf16 v[78:81], v[52:55], v[16:19], v[78:81]
    ds_read_b64_tr_b16 v[36:37], v13 offset:12288
    ds_read_b128 v[16:19], v8 offset:0
    v_mfma_f32_16x16x32_bf16 v[94:97], v[44:47], v[20:23], v[94:97]
    ds_read_b64_tr_b16 v[38:39], v13 offset:12800
    v_mfma_f32_16x16x32_bf16 v[98:101], v[48:51], v[20:23], v[98:101]
    ds_read_b64_tr_b16 v[40:41], v14 offset:0
    v_mfma_f32_16x16x32_bf16 v[102:105], v[52:55], v[20:23], v[102:105]
    ds_read_b64_tr_b16 v[42:43], v14 offset:512
    ds_read_b128 v[20:23], v8 offset:2048
    v_mfma_f32_16x16x32_bf16 v[118:121], v[44:47], v[24:27], v[118:121]
    v_mfma_f32_16x16x32_bf16 v[122:125], v[48:51], v[24:27], v[122:125]
    v_mfma_f32_16x16x32_bf16 v[126:129], v[52:55], v[24:27], v[126:129]
    ds_read_b128 v[24:27], v8 offset:4096
    v_mfma_f32_16x16x32_bf16 v[142:145], v[44:47], v[28:31], v[142:145]
    v_mfma_f32_16x16x32_bf16 v[146:149], v[48:51], v[28:31], v[146:149]
    v_mfma_f32_16x16x32_bf16 v[150:153], v[52:55], v[28:31], v[150:153]
    ds_read_b128 v[28:31], v8 offset:6144
    s_waitcnt lgkmcnt(6)
    v_mfma_f32_16x16x32_bf16 v[58:61], v[32:35], v[16:19], v[58:61]
    ds_read_b64_tr_b16 v[44:45], v14 offset:12288
    s_waitcnt lgkmcnt(6)
    v_mfma_f32_16x16x32_bf16 v[62:65], v[36:39], v[16:19], v[62:65]
    ds_read_b64_tr_b16 v[46:47], v14 offset:12800
    s_waitcnt lgkmcnt(5)
    v_mfma_f32_16x16x32_bf16 v[66:69], v[40:43], v[16:19], v[66:69]
    ds_read_b64_tr_b16 v[48:49], v15 offset:0
    s_waitcnt lgkmcnt(5)
    v_mfma_f32_16x16x32_bf16 v[82:85], v[32:35], v[20:23], v[82:85]
    ds_read_b64_tr_b16 v[50:51], v15 offset:512
    v_mfma_f32_16x16x32_bf16 v[86:89], v[36:39], v[20:23], v[86:89]
    ds_read_b64_tr_b16 v[52:53], v15 offset:12288
    v_mfma_f32_16x16x32_bf16 v[90:93], v[40:43], v[20:23], v[90:93]
    ds_read_b64_tr_b16 v[54:55], v15 offset:12800
    s_waitcnt lgkmcnt(7)
    v_mfma_f32_16x16x32_bf16 v[106:109], v[32:35], v[24:27], v[106:109]
    v_mfma_f32_16x16x32_bf16 v[110:113], v[36:39], v[24:27], v[110:113]
    v_mfma_f32_16x16x32_bf16 v[114:117], v[40:43], v[24:27], v[114:117]
    s_waitcnt lgkmcnt(6)
    v_mfma_f32_16x16x32_bf16 v[130:133], v[32:35], v[28:31], v[130:133]
    v_mfma_f32_16x16x32_bf16 v[134:137], v[36:39], v[28:31], v[134:137]
    v_mfma_f32_16x16x32_bf16 v[138:141], v[40:43], v[28:31], v[138:141]
    s_waitcnt lgkmcnt(4)
    v_mfma_f32_16x16x32_bf16 v[70:73], v[44:47], v[16:19], v[70:73]
    ds_read_b64_tr_b16 v[32:33], v13 offset:24576
    s_waitcnt lgkmcnt(3)
    v_mfma_f32_16x16x32_bf16 v[74:77], v[48:51], v[16:19], v[74:77]
    ds_read_b64_tr_b16 v[34:35], v13 offset:25088
    s_waitcnt lgkmcnt(2)
    v_mfma_f32_16x16x32_bf16 v[78:81], v[52:55], v[16:19], v[78:81]
    ds_read_b64_tr_b16 v[36:37], v13 offset:36864
    ds_read_b128 v[16:19], v9 offset:0
    v_mfma_f32_16x16x32_bf16 v[94:97], v[44:47], v[20:23], v[94:97]
    ds_read_b64_tr_b16 v[38:39], v13 offset:37376
    v_mfma_f32_16x16x32_bf16 v[98:101], v[48:51], v[20:23], v[98:101]
    ds_read_b64_tr_b16 v[40:41], v14 offset:24576
    v_mfma_f32_16x16x32_bf16 v[102:105], v[52:55], v[20:23], v[102:105]
    ds_read_b64_tr_b16 v[42:43], v14 offset:25088
    ds_read_b128 v[20:23], v9 offset:2048
    v_mfma_f32_16x16x32_bf16 v[118:121], v[44:47], v[24:27], v[118:121]
    v_mfma_f32_16x16x32_bf16 v[122:125], v[48:51], v[24:27], v[122:125]
    v_mfma_f32_16x16x32_bf16 v[126:129], v[52:55], v[24:27], v[126:129]
    ds_read_b128 v[24:27], v9 offset:4096
    v_mfma_f32_16x16x32_bf16 v[142:145], v[44:47], v[28:31], v[142:145]
    v_mfma_f32_16x16x32_bf16 v[146:149], v[48:51], v[28:31], v[146:149]
    v_mfma_f32_16x16x32_bf16 v[150:153], v[52:55], v[28:31], v[150:153]
    ds_read_b128 v[28:31], v9 offset:6144
    s_waitcnt lgkmcnt(6)
    v_mfma_f32_16x16x32_bf16 v[58:61], v[32:35], v[16:19], v[58:61]
    ds_read_b64_tr_b16 v[44:45], v14 offset:36864
    s_waitcnt lgkmcnt(6)
    v_mfma_f32_16x16x32_bf16 v[62:65], v[36:39], v[16:19], v[62:65]
    ds_read_b64_tr_b16 v[46:47], v14 offset:37376
    s_waitcnt lgkmcnt(5)
    v_mfma_f32_16x16x32_bf16 v[66:69], v[40:43], v[16:19], v[66:69]
    ds_read_b64_tr_b16 v[48:49], v15 offset:24576
    s_waitcnt lgkmcnt(5)
    v_mfma_f32_16x16x32_bf16 v[82:85], v[32:35], v[20:23], v[82:85]
    ds_read_b64_tr_b16 v[50:51], v15 offset:25088
    v_mfma_f32_16x16x32_bf16 v[86:89], v[36:39], v[20:23], v[86:89]
    ds_read_b64_tr_b16 v[52:53], v15 offset:36864
    v_mfma_f32_16x16x32_bf16 v[90:93], v[40:43], v[20:23], v[90:93]
    ds_read_b64_tr_b16 v[54:55], v15 offset:37376
    s_waitcnt lgkmcnt(7)
    v_mfma_f32_16x16x32_bf16 v[106:109], v[32:35], v[24:27], v[106:109]
    v_mfma_f32_16x16x32_bf16 v[110:113], v[36:39], v[24:27], v[110:113]
    v_mfma_f32_16x16x32_bf16 v[114:117], v[40:43], v[24:27], v[114:117]
    s_waitcnt lgkmcnt(6)
    v_mfma_f32_16x16x32_bf16 v[130:133], v[32:35], v[28:31], v[130:133]
    v_mfma_f32_16x16x32_bf16 v[134:137], v[36:39], v[28:31], v[134:137]
    v_mfma_f32_16x16x32_bf16 v[138:141], v[40:43], v[28:31], v[138:141]
    s_waitcnt lgkmcnt(4)
    v_mfma_f32_16x16x32_bf16 v[70:73], v[44:47], v[16:19], v[70:73]
    s_waitcnt lgkmcnt(2)
    v_mfma_f32_16x16x32_bf16 v[74:77], v[48:51], v[16:19], v[74:77]
    s_waitcnt lgkmcnt(0)
    v_mfma_f32_16x16x32_bf16 v[78:81], v[52:55], v[16:19], v[78:81]
    v_mfma_f32_16x16x32_bf16 v[94:97], v[44:47], v[20:23], v[94:97]
    v_mfma_f32_16x16x32_bf16 v[98:101], v[48:51], v[20:23], v[98:101]
    v_mfma_f32_16x16x32_bf16 v[102:105], v[52:55], v[20:23], v[102:105]
    v_mfma_f32_16x16x32_bf16 v[118:121], v[44:47], v[24:27], v[118:121]
    v_mfma_f32_16x16x32_bf16 v[122:125], v[48:51], v[24:27], v[122:125]
    v_mfma_f32_16x16x32_bf16 v[126:129], v[52:55], v[24:27], v[126:129]
    v_mfma_f32_16x16x32_bf16 v[142:145], v[44:47], v[28:31], v[142:145]
    v_mfma_f32_16x16x32_bf16 v[146:149], v[48:51], v[28:31], v[146:149]
    v_mfma_f32_16x16x32_bf16 v[150:153], v[52:55], v[28:31], v[150:153]
    s_waitcnt vmcnt(0)
    s_cmp_ge_u32 s38, 4
    s_cbranch_scc1 gated_mix__softmax_full_mha__glu_gated_glu__prompt_kernel_nog1
    s_mov_b32 s24, s4
    s_mov_b32 s25, s5
    s_mov_b32 s26, 2621440
    s_mov_b32 s27, 0x00020000
    s_mov_b32 s56, s18
    s_mov_b32 s57, s19
    s_mov_b32 s58, 1280
    s_mov_b32 s59, 0x00020000
    s_mul_i32 s41, s39, 15
    s_lshl_b32 s42, s38, 2
    s_add_u32 s41, s41, s42
    s_sub_u32 s41, s41, 90
    v_lshrrev_b32 v3, 4, v1
    v_add_u32 v3, s41, v3
    v_min_u32 v3, 127, v3
    s_lshl_b32 s41, s40, 7
    v_add_u32 v3, s41, v3
    v_and_b32 v2, 15, v1
    v_lshlrev_b32 v2, 4, v2
    v_mul_u32_u24 v4, 1280, v3
    v_add_u32 v4, v4, v2
    buffer_load_dwordx4 v[10:13], v2, s[56:59], 0 offen offset:0
    buffer_load_dwordx4 v[30:33], v4, s[24:27], 0 offen offset:0
    buffer_load_dwordx4 v[14:17], v2, s[56:59], 0 offen offset:256
    buffer_load_dwordx4 v[34:37], v4, s[24:27], 0 offen offset:256
    buffer_load_dwordx4 v[18:21], v2, s[56:59], 0 offen offset:512
    buffer_load_dwordx4 v[38:41], v4, s[24:27], 0 offen offset:512
    buffer_load_dwordx4 v[22:25], v2, s[56:59], 0 offen offset:768
    buffer_load_dwordx4 v[42:45], v4, s[24:27], 0 offen offset:768
    buffer_load_dwordx4 v[26:29], v2, s[56:59], 0 offen offset:1024
    buffer_load_dwordx4 v[46:49], v4, s[24:27], 0 offen offset:1024
gated_mix__softmax_full_mha__glu_gated_glu__prompt_kernel_nog1:
    s_lshl_b32 s41, s40, 1
    s_add_u32 s41, s41, s52
    s_mul_i32 s41, s41, 216
    s_sub_u32 s42, s39, 6
    s_mul_i32 s42, s42, 12
    s_add_u32 s41, s41, s42
    s_mul_i32 s42, s53, 3
    s_add_u32 s41, s41, s42
    s_lshl_b32 s41, s41, 10
    s_add_u32 s41, s41, 7864320
    s_add_u32 s42, s41, 110592
    s_mov_b32 s48, 0xbfb8aa3b
    s_mov_b32 s60, s41
    s_mov_b32 s61, s42
    v_mul_f32 v122, s48, v122
    v_mul_f32 v123, s48, v123
    v_mul_f32 v124, s48, v124
    v_mul_f32 v125, s48, v125
    v_mul_f32 v146, s48, v146
    v_mul_f32 v147, s48, v147
    v_mul_f32 v148, s48, v148
    v_mul_f32 v149, s48, v149
    v_exp_f32 v122, v122
    v_exp_f32 v123, v123
    v_exp_f32 v124, v124
    v_exp_f32 v125, v125
    v_exp_f32 v146, v146
    v_exp_f32 v147, v147
    v_exp_f32 v148, v148
    v_exp_f32 v149, v149
    v_add_f32 v122, 1.0, v122
    v_add_f32 v123, 1.0, v123
    v_add_f32 v124, 1.0, v124
    v_add_f32 v125, 1.0, v125
    v_add_f32 v146, 1.0, v146
    v_add_f32 v147, 1.0, v147
    v_add_f32 v148, 1.0, v148
    v_add_f32 v149, 1.0, v149
    v_rcp_f32 v122, v122
    v_rcp_f32 v123, v123
    v_rcp_f32 v124, v124
    v_rcp_f32 v125, v125
    v_rcp_f32 v146, v146
    v_rcp_f32 v147, v147
    v_rcp_f32 v148, v148
    v_rcp_f32 v149, v149
    v_mul_f32 v122, v122, v126
    v_mul_f32 v123, v123, v127
    v_mul_f32 v124, v124, v128
    v_mul_f32 v125, v125, v129
    v_mul_f32 v146, v146, v150
    v_mul_f32 v147, v147, v151
    v_mul_f32 v148, v148, v152
    v_mul_f32 v149, v149, v153
    v_cvt_pk_bf16_f32 v156, v122, v123
    v_cvt_pk_bf16_f32 v157, v124, v125
    v_cvt_pk_bf16_f32 v158, v146, v147
    v_cvt_pk_bf16_f32 v159, v148, v149
    s_nop 1
    v_permlane16_swap_b32 v156, v158
    v_permlane16_swap_b32 v157, v159
    v_mul_f32 v114, s48, v114
    v_mul_f32 v115, s48, v115
    v_mul_f32 v116, s48, v116
    v_mul_f32 v117, s48, v117
    v_mul_f32 v138, s48, v138
    v_mul_f32 v139, s48, v139
    v_mul_f32 v140, s48, v140
    v_mul_f32 v141, s48, v141
    v_exp_f32 v114, v114
    v_exp_f32 v115, v115
    v_exp_f32 v116, v116
    v_exp_f32 v117, v117
    v_exp_f32 v138, v138
    v_exp_f32 v139, v139
    v_exp_f32 v140, v140
    v_exp_f32 v141, v141
    v_add_f32 v114, 1.0, v114
    v_add_f32 v115, 1.0, v115
    v_add_f32 v116, 1.0, v116
    v_add_f32 v117, 1.0, v117
    v_add_f32 v138, 1.0, v138
    v_add_f32 v139, 1.0, v139
    v_add_f32 v140, 1.0, v140
    v_add_f32 v141, 1.0, v141
    v_rcp_f32 v114, v114
    v_rcp_f32 v115, v115
    v_rcp_f32 v116, v116
    v_rcp_f32 v117, v117
    v_rcp_f32 v138, v138
    v_rcp_f32 v139, v139
    v_rcp_f32 v140, v140
    v_rcp_f32 v141, v141
    v_mul_f32 v114, v114, v118
    v_mul_f32 v115, v115, v119
    v_mul_f32 v116, v116, v120
    v_mul_f32 v117, v117, v121
    v_mul_f32 v138, v138, v142
    v_mul_f32 v139, v139, v143
    v_mul_f32 v140, v140, v144
    v_mul_f32 v141, v141, v145
    v_cvt_pk_bf16_f32 v160, v114, v115
    v_cvt_pk_bf16_f32 v161, v116, v117
    v_cvt_pk_bf16_f32 v162, v138, v139
    v_cvt_pk_bf16_f32 v163, v140, v141
    s_nop 1
    v_permlane16_swap_b32 v160, v162
    v_permlane16_swap_b32 v161, v163
    v_mul_f32 v106, s48, v106
    v_mul_f32 v107, s48, v107
    v_mul_f32 v108, s48, v108
    v_mul_f32 v109, s48, v109
    v_mul_f32 v130, s48, v130
    v_mul_f32 v131, s48, v131
    v_mul_f32 v132, s48, v132
    v_mul_f32 v133, s48, v133
    v_exp_f32 v106, v106
    v_exp_f32 v107, v107
    v_exp_f32 v108, v108
    v_exp_f32 v109, v109
    v_exp_f32 v130, v130
    v_exp_f32 v131, v131
    v_exp_f32 v132, v132
    v_exp_f32 v133, v133
    v_add_f32 v106, 1.0, v106
    v_add_f32 v107, 1.0, v107
    v_add_f32 v108, 1.0, v108
    v_add_f32 v109, 1.0, v109
    v_add_f32 v130, 1.0, v130
    v_add_f32 v131, 1.0, v131
    v_add_f32 v132, 1.0, v132
    v_add_f32 v133, 1.0, v133
    v_rcp_f32 v106, v106
    v_rcp_f32 v107, v107
    v_rcp_f32 v108, v108
    v_rcp_f32 v109, v109
    v_rcp_f32 v130, v130
    v_rcp_f32 v131, v131
    v_rcp_f32 v132, v132
    v_rcp_f32 v133, v133
    v_mul_f32 v106, v106, v110
    v_mul_f32 v107, v107, v111
    v_mul_f32 v108, v108, v112
    v_mul_f32 v109, v109, v113
    v_mul_f32 v130, v130, v134
    v_mul_f32 v131, v131, v135
    v_mul_f32 v132, v132, v136
    v_mul_f32 v133, v133, v137
    v_cvt_pk_bf16_f32 v164, v106, v107
    v_cvt_pk_bf16_f32 v165, v108, v109
    v_cvt_pk_bf16_f32 v166, v130, v131
    v_cvt_pk_bf16_f32 v167, v132, v133
    s_nop 1
    v_permlane16_swap_b32 v164, v166
    v_permlane16_swap_b32 v165, v167
    v_mul_f32 v74, s48, v74
    v_mul_f32 v75, s48, v75
    v_mul_f32 v76, s48, v76
    v_mul_f32 v77, s48, v77
    v_mul_f32 v98, s48, v98
    v_mul_f32 v99, s48, v99
    v_mul_f32 v100, s48, v100
    v_mul_f32 v101, s48, v101
    v_exp_f32 v74, v74
    v_exp_f32 v75, v75
    v_exp_f32 v76, v76
    v_exp_f32 v77, v77
    v_exp_f32 v98, v98
    v_exp_f32 v99, v99
    v_exp_f32 v100, v100
    v_exp_f32 v101, v101
    v_add_f32 v74, 1.0, v74
    v_add_f32 v75, 1.0, v75
    v_add_f32 v76, 1.0, v76
    v_add_f32 v77, 1.0, v77
    v_add_f32 v98, 1.0, v98
    v_add_f32 v99, 1.0, v99
    v_add_f32 v100, 1.0, v100
    v_add_f32 v101, 1.0, v101
    v_rcp_f32 v74, v74
    v_rcp_f32 v75, v75
    v_rcp_f32 v76, v76
    v_rcp_f32 v77, v77
    v_rcp_f32 v98, v98
    v_rcp_f32 v99, v99
    v_rcp_f32 v100, v100
    v_rcp_f32 v101, v101
    v_mul_f32 v74, v74, v78
    v_mul_f32 v75, v75, v79
    v_mul_f32 v76, v76, v80
    v_mul_f32 v77, v77, v81
    v_mul_f32 v98, v98, v102
    v_mul_f32 v99, v99, v103
    v_mul_f32 v100, v100, v104
    v_mul_f32 v101, v101, v105
    v_cvt_pk_bf16_f32 v140, v74, v75
    v_cvt_pk_bf16_f32 v141, v76, v77
    v_cvt_pk_bf16_f32 v142, v98, v99
    v_cvt_pk_bf16_f32 v143, v100, v101
    s_nop 1
    v_permlane16_swap_b32 v140, v142
    v_permlane16_swap_b32 v141, v143
    v_mul_f32 v66, s48, v66
    v_mul_f32 v67, s48, v67
    v_mul_f32 v68, s48, v68
    v_mul_f32 v69, s48, v69
    v_mul_f32 v90, s48, v90
    v_mul_f32 v91, s48, v91
    v_mul_f32 v92, s48, v92
    v_mul_f32 v93, s48, v93
    v_exp_f32 v66, v66
    v_exp_f32 v67, v67
    v_exp_f32 v68, v68
    v_exp_f32 v69, v69
    v_exp_f32 v90, v90
    v_exp_f32 v91, v91
    v_exp_f32 v92, v92
    v_exp_f32 v93, v93
    v_add_f32 v66, 1.0, v66
    v_add_f32 v67, 1.0, v67
    v_add_f32 v68, 1.0, v68
    v_add_f32 v69, 1.0, v69
    v_add_f32 v90, 1.0, v90
    v_add_f32 v91, 1.0, v91
    v_add_f32 v92, 1.0, v92
    v_add_f32 v93, 1.0, v93
    v_rcp_f32 v66, v66
    v_rcp_f32 v67, v67
    v_rcp_f32 v68, v68
    v_rcp_f32 v69, v69
    v_rcp_f32 v90, v90
    v_rcp_f32 v91, v91
    v_rcp_f32 v92, v92
    v_rcp_f32 v93, v93
    v_mul_f32 v66, v66, v70
    v_mul_f32 v67, v67, v71
    v_mul_f32 v68, v68, v72
    v_mul_f32 v69, v69, v73
    v_mul_f32 v90, v90, v94
    v_mul_f32 v91, v91, v95
    v_mul_f32 v92, v92, v96
    v_mul_f32 v93, v93, v97
    v_cvt_pk_bf16_f32 v144, v66, v67
    v_cvt_pk_bf16_f32 v145, v68, v69
    v_cvt_pk_bf16_f32 v146, v90, v91
    v_cvt_pk_bf16_f32 v147, v92, v93
    s_nop 1
    v_permlane16_swap_b32 v144, v146
    v_permlane16_swap_b32 v145, v147
    v_mul_f32 v58, s48, v58
    v_mul_f32 v59, s48, v59
    v_mul_f32 v60, s48, v60
    v_mul_f32 v61, s48, v61
    v_mul_f32 v82, s48, v82
    v_mul_f32 v83, s48, v83
    v_mul_f32 v84, s48, v84
    v_mul_f32 v85, s48, v85
    v_exp_f32 v58, v58
    v_exp_f32 v59, v59
    v_exp_f32 v60, v60
    v_exp_f32 v61, v61
    v_exp_f32 v82, v82
    v_exp_f32 v83, v83
    v_exp_f32 v84, v84
    v_exp_f32 v85, v85
    v_add_f32 v58, 1.0, v58
    v_add_f32 v59, 1.0, v59
    v_add_f32 v60, 1.0, v60
    v_add_f32 v61, 1.0, v61
    v_add_f32 v82, 1.0, v82
    v_add_f32 v83, 1.0, v83
    v_add_f32 v84, 1.0, v84
    v_add_f32 v85, 1.0, v85
    v_rcp_f32 v58, v58
    v_rcp_f32 v59, v59
    v_rcp_f32 v60, v60
    v_rcp_f32 v61, v61
    v_rcp_f32 v82, v82
    v_rcp_f32 v83, v83
    v_rcp_f32 v84, v84
    v_rcp_f32 v85, v85
    v_mul_f32 v58, v58, v62
    v_mul_f32 v59, v59, v63
    v_mul_f32 v60, v60, v64
    v_mul_f32 v61, v61, v65
    v_mul_f32 v82, v82, v86
    v_mul_f32 v83, v83, v87
    v_mul_f32 v84, v84, v88
    v_mul_f32 v85, v85, v89
    v_cvt_pk_bf16_f32 v148, v58, v59
    v_cvt_pk_bf16_f32 v149, v60, v61
    v_cvt_pk_bf16_f32 v150, v82, v83
    v_cvt_pk_bf16_f32 v151, v84, v85
    s_nop 1
    v_permlane16_swap_b32 v148, v150
    v_permlane16_swap_b32 v149, v151
    v_mov_b32 v50, 0
    v_mov_b32 v51, 0
    s_cmp_ge_u32 s38, 4
    s_waitcnt vmcnt(0)
    s_cbranch_scc1 gated_mix__softmax_full_mha__glu_gated_glu__prompt_kernel_nog2
    v_dot2_f32_bf16 v50, v30, v10, v50
    v_dot2_f32_bf16 v51, v31, v11, v51
    v_dot2_f32_bf16 v50, v32, v12, v50
    v_dot2_f32_bf16 v51, v33, v13, v51
    v_dot2_f32_bf16 v50, v34, v14, v50
    v_dot2_f32_bf16 v51, v35, v15, v51
    v_dot2_f32_bf16 v50, v36, v16, v50
    v_dot2_f32_bf16 v51, v37, v17, v51
    v_dot2_f32_bf16 v50, v38, v18, v50
    v_dot2_f32_bf16 v51, v39, v19, v51
    v_dot2_f32_bf16 v50, v40, v20, v50
    v_dot2_f32_bf16 v51, v41, v21, v51
    v_dot2_f32_bf16 v50, v42, v22, v50
    v_dot2_f32_bf16 v51, v43, v23, v51
    v_dot2_f32_bf16 v50, v44, v24, v50
    v_dot2_f32_bf16 v51, v45, v25, v51
    v_dot2_f32_bf16 v50, v46, v26, v50
    v_dot2_f32_bf16 v51, v47, v27, v51
    v_dot2_f32_bf16 v50, v48, v28, v50
    v_dot2_f32_bf16 v51, v49, v29, v51
    v_lshlrev_b32 v3, 2, v3
    s_nop 1
    v_add_f32 v50, v50, v51
    s_nop 1
    v_add_f32_dpp v50, v50, v50 row_ror:8 row_mask:0xf bank_mask:0xf
    s_nop 1
    v_add_f32_dpp v50, v50, v50 row_ror:4 row_mask:0xf bank_mask:0xf
    s_nop 1
    v_add_f32_dpp v50, v50, v50 row_ror:2 row_mask:0xf bank_mask:0xf
    s_nop 1
    v_add_f32_dpp v50, v50, v50 row_ror:1 row_mask:0xf bank_mask:0xf
    v_mul_f32 v50, s48, v50
    v_exp_f32 v50, v50
    s_mov_b32 s41, 17973248
    v_add_f32 v50, 1.0, v50
    v_rcp_f32 v50, v50
    s_nop 0
    buffer_store_dword v50, v3, s[32:35], s41 offen sc1
gated_mix__softmax_full_mha__glu_gated_glu__prompt_kernel_nog2:
    s_branch gated_mix__softmax_full_mha__glu_gated_glu__prompt_kernel_att
gated_mix__softmax_full_mha__glu_gated_glu__prompt_kernel_misc:
    s_barrier
    s_lshl_b32 s53, s36, 1
    s_add_u32 s53, s53, s37
    s_sub_u32 s53, s53, 30
    s_mul_i32 s52, s53, 12
    s_add_u32 s52, s52, s38
    s_mov_b32 s42, 5120
    v_add_u32 v4, 0, v1
    v_mul_u32_u24 v5, 1639, v4
    v_lshrrev_b32 v5, 16, v5
    v_mul_u32_u24 v6, 40, v5
    v_sub_u32 v6, v4, v6
    v_and_b32 v7, 2, v5
    v_lshlrev_b32 v7, 1, v7
    v_xor_b32 v6, v6, v7
    v_lshlrev_b32 v6, 4, v6
    v_mul_u32_u24 v7, 1280, v5
    v_add_u32 v15, v7, v6
    v_lshrrev_b32 v7, 2, v5
    v_mul_u32_u24 v7, 20480, v7
    v_add_u32 v25, v15, v7
    v_bfe_u32 v7, v5, 2, 1
    v_bfe_u32 v4, v5, 3, 1
    v_sub_u32 v7, v7, v4
    v_mad_i32_i24 v35, v7, s42, v15
    v_add_u32 v4, 64, v1
    v_mul_u32_u24 v5, 1639, v4
    v_lshrrev_b32 v5, 16, v5
    v_mul_u32_u24 v6, 40, v5
    v_sub_u32 v6, v4, v6
    v_and_b32 v7, 2, v5
    v_lshlrev_b32 v7, 1, v7
    v_xor_b32 v6, v6, v7
    v_lshlrev_b32 v6, 4, v6
    v_mul_u32_u24 v7, 1280, v5
    v_add_u32 v16, v7, v6
    v_lshrrev_b32 v7, 2, v5
    v_mul_u32_u24 v7, 20480, v7
    v_add_u32 v26, v16, v7
    v_bfe_u32 v7, v5, 2, 1
    v_bfe_u32 v4, v5, 3, 1
    v_sub_u32 v7, v7, v4
    v_mad_i32_i24 v36, v7, s42, v16
    v_add_u32 v4, 128, v1
    v_mul_u32_u24 v5, 1639, v4
    v_lshrrev_b32 v5, 16, v5
    v_mul_u32_u24 v6, 40, v5
    v_sub_u32 v6, v4, v6
    v_and_b32 v7, 2, v5
    v_lshlrev_b32 v7, 1, v7
    v_xor_b32 v6, v6, v7
    v_lshlrev_b32 v6, 4, v6
    v_mul_u32_u24 v7, 1280, v5
    v_add_u32 v17, v7, v6
    v_lshrrev_b32 v7, 2, v5
    v_mul_u32_u24 v7, 20480, v7
    v_add_u32 v27, v17, v7
    v_bfe_u32 v7, v5, 2, 1
    v_bfe_u32 v4, v5, 3, 1
    v_sub_u32 v7, v7, v4
    v_mad_i32_i24 v37, v7, s42, v17
    v_add_u32 v4, 192, v1
    v_mul_u32_u24 v5, 1639, v4
    v_lshrrev_b32 v5, 16, v5
    v_mul_u32_u24 v6, 40, v5
    v_sub_u32 v6, v4, v6
    v_and_b32 v7, 2, v5
    v_lshlrev_b32 v7, 1, v7
    v_xor_b32 v6, v6, v7
    v_lshlrev_b32 v6, 4, v6
    v_mul_u32_u24 v7, 1280, v5
    v_add_u32 v18, v7, v6
    v_lshrrev_b32 v7, 2, v5
    v_mul_u32_u24 v7, 20480, v7
    v_add_u32 v28, v18, v7
    v_bfe_u32 v7, v5, 2, 1
    v_bfe_u32 v4, v5, 3, 1
    v_sub_u32 v7, v7, v4
    v_mad_i32_i24 v38, v7, s42, v18
    v_add_u32 v4, 256, v1
    v_mul_u32_u24 v5, 1639, v4
    v_lshrrev_b32 v5, 16, v5
    v_mul_u32_u24 v6, 40, v5
    v_sub_u32 v6, v4, v6
    v_and_b32 v7, 2, v5
    v_lshlrev_b32 v7, 1, v7
    v_xor_b32 v6, v6, v7
    v_lshlrev_b32 v6, 4, v6
    v_mul_u32_u24 v7, 1280, v5
    v_add_u32 v19, v7, v6
    v_lshrrev_b32 v7, 2, v5
    v_mul_u32_u24 v7, 20480, v7
    v_add_u32 v29, v19, v7
    v_bfe_u32 v7, v5, 2, 1
    v_bfe_u32 v4, v5, 3, 1
    v_sub_u32 v7, v7, v4
    v_mad_i32_i24 v39, v7, s42, v19
    v_add_u32 v4, 320, v1
    v_mul_u32_u24 v5, 1639, v4
    v_lshrrev_b32 v5, 16, v5
    v_mul_u32_u24 v6, 40, v5
    v_sub_u32 v6, v4, v6
    v_and_b32 v7, 2, v5
    v_lshlrev_b32 v7, 1, v7
    v_xor_b32 v6, v6, v7
    v_lshlrev_b32 v6, 4, v6
    v_mul_u32_u24 v7, 1280, v5
    v_add_u32 v20, v7, v6
    v_lshrrev_b32 v7, 2, v5
    v_mul_u32_u24 v7, 20480, v7
    v_add_u32 v30, v20, v7
    v_bfe_u32 v7, v5, 2, 1
    v_bfe_u32 v4, v5, 3, 1
    v_sub_u32 v7, v7, v4
    v_mad_i32_i24 v40, v7, s42, v20
    v_add_u32 v4, 384, v1
    v_mul_u32_u24 v5, 1639, v4
    v_lshrrev_b32 v5, 16, v5
    v_mul_u32_u24 v6, 40, v5
    v_sub_u32 v6, v4, v6
    v_and_b32 v7, 2, v5
    v_lshlrev_b32 v7, 1, v7
    v_xor_b32 v6, v6, v7
    v_lshlrev_b32 v6, 4, v6
    v_mul_u32_u24 v7, 1280, v5
    v_add_u32 v21, v7, v6
    v_lshrrev_b32 v7, 2, v5
    v_mul_u32_u24 v7, 20480, v7
    v_add_u32 v31, v21, v7
    v_bfe_u32 v7, v5, 2, 1
    v_bfe_u32 v4, v5, 3, 1
    v_sub_u32 v7, v7, v4
    v_mad_i32_i24 v41, v7, s42, v21
    v_add_u32 v4, 448, v1
    v_mul_u32_u24 v5, 1639, v4
    v_lshrrev_b32 v5, 16, v5
    v_mul_u32_u24 v6, 40, v5
    v_sub_u32 v6, v4, v6
    v_and_b32 v7, 2, v5
    v_lshlrev_b32 v7, 1, v7
    v_xor_b32 v6, v6, v7
    v_lshlrev_b32 v6, 4, v6
    v_mul_u32_u24 v7, 1280, v5
    v_add_u32 v22, v7, v6
    v_lshrrev_b32 v7, 2, v5
    v_mul_u32_u24 v7, 20480, v7
    v_add_u32 v32, v22, v7
    v_bfe_u32 v7, v5, 2, 1
    v_bfe_u32 v4, v5, 3, 1
    v_sub_u32 v7, v7, v4
    v_mad_i32_i24 v42, v7, s42, v22
    v_add_u32 v4, 512, v1
    v_mul_u32_u24 v5, 1639, v4
    v_lshrrev_b32 v5, 16, v5
    v_mul_u32_u24 v6, 40, v5
    v_sub_u32 v6, v4, v6
    v_and_b32 v7, 2, v5
    v_lshlrev_b32 v7, 1, v7
    v_xor_b32 v6, v6, v7
    v_lshlrev_b32 v6, 4, v6
    v_mul_u32_u24 v7, 1280, v5
    v_add_u32 v23, v7, v6
    v_lshrrev_b32 v7, 2, v5
    v_mul_u32_u24 v7, 20480, v7
    v_add_u32 v33, v23, v7
    v_bfe_u32 v7, v5, 2, 1
    v_bfe_u32 v4, v5, 3, 1
    v_sub_u32 v7, v7, v4
    v_mad_i32_i24 v43, v7, s42, v23
    v_add_u32 v4, 576, v1
    v_mul_u32_u24 v5, 1639, v4
    v_lshrrev_b32 v5, 16, v5
    v_mul_u32_u24 v6, 40, v5
    v_sub_u32 v6, v4, v6
    v_and_b32 v7, 2, v5
    v_lshlrev_b32 v7, 1, v7
    v_xor_b32 v6, v6, v7
    v_lshlrev_b32 v6, 4, v6
    v_mul_u32_u24 v7, 1280, v5
    v_add_u32 v24, v7, v6
    v_lshrrev_b32 v7, 2, v5
    v_mul_u32_u24 v7, 20480, v7
    v_add_u32 v34, v24, v7
    v_bfe_u32 v7, v5, 2, 1
    v_bfe_u32 v4, v5, 3, 1
    v_sub_u32 v7, v7, v4
    v_mad_i32_i24 v44, v7, s42, v24
    v_lshrrev_b32 v4, 5, v1
    v_bfe_u32 v5, v1, 2, 2
    v_lshl_add_u32 v4, v4, 2, v5
    v_mul_u32_u24 v4, 640, v4
    v_bfe_u32 v6, v1, 4, 1
    v_and_b32 v7, 3, v1
    v_lshl_add_u32 v6, v6, 2, v7
    v_lshl_add_u32 v4, v6, 3, v4
    s_mul_i32 s46, s38, 10240
    v_add_u32 v4, s46, v4
    v_lshrrev_b32 v5, 1, v5
    v_lshl_add_u32 v12, v5, 6, v4
    v_xor_b32 v5, 1, v5
    v_lshl_add_u32 v13, v5, 6, v4
    v_lshlrev_b32 v14, 4, v1
    s_waitcnt lgkmcnt(0)
    s_mov_b32 s32, s20
    s_mov_b32 s33, s21
    s_mov_b32 s34, 268435456
    s_mov_b32 s35, 0x00020000
    s_lshr_b32 s60, s52, 1
    s_and_b32 s61, s52, 1
    s_cmp_ge_u32 s60, 108
    s_cbranch_scc1 gated_mix__softmax_full_mha__glu_gated_glu__prompt_kernel_u0wo
    s_mov_b32 s28, s16
    s_mov_b32 s29, s17
    s_mov_b32 s30, 2211840
    s_mov_b32 s31, 0x00020000
    s_mul_i32 s62, s60, 20480
    s_mul_i32 s64, s61, 1105920
    s_lshl_b32 s41, s60, 10
    s_add_u32 s64, s64, s41
    s_add_u32 s64, s64, 14942208
    s_mov_b32 s65, 110592
    s_mul_i32 s41, s61, 640
    s_add_u32 s62, s62, s41
    s_add_u32 m0, s46, 0
    s_nop 0
    buffer_load_dwordx4 v35, s[28:31], s62 offen lds
    s_add_u32 m0, s46, 1024
    s_nop 0
    buffer_load_dwordx4 v36, s[28:31], s62 offen lds
    s_add_u32 m0, s46, 2048
    s_nop 0
    buffer_load_dwordx4 v37, s[28:31], s62 offen lds
    s_add_u32 m0, s46, 3072
    s_nop 0
    buffer_load_dwordx4 v38, s[28:31], s62 offen lds
    s_add_u32 m0, s46, 4096
    s_nop 0
    buffer_load_dwordx4 v39, s[28:31], s62 offen lds
    s_add_u32 m0, s46, 5120
    s_nop 0
    buffer_load_dwordx4 v40, s[28:31], s62 offen lds
    s_add_u32 m0, s46, 6144
    s_nop 0
    buffer_load_dwordx4 v41, s[28:31], s62 offen lds
    s_add_u32 m0, s46, 7168
    s_nop 0
    buffer_load_dwordx4 v42, s[28:31], s62 offen lds
    s_add_u32 m0, s46, 8192
    s_nop 0
    buffer_load_dwordx4 v43, s[28:31], s62 offen lds
    s_add_u32 m0, s46, 9216
    s_nop 0
    buffer_load_dwordx4 v44, s[28:31], s62 offen lds
    s_branch gated_mix__softmax_full_mha__glu_gated_glu__prompt_kernel_u0go
gated_mix__softmax_full_mha__glu_gated_glu__prompt_kernel_u0wo:
    s_mov_b32 s28, s8
    s_mov_b32 s29, s9
    s_mov_b32 s30, 819200
    s_mov_b32 s31, 0x00020000
    s_sub_u32 s60, s60, 108
    s_mul_i32 s64, s61, 409600
    s_lshl_b32 s41, s60, 10
    s_add_u32 s64, s64, s41
    s_add_u32 s64, s64, 17154048
    s_mov_b32 s65, 40960
    s_mul_i32 s62, s60, 25600
    s_cmp_lt_u32 s60, 32
    s_cbranch_scc1 gated_mix__softmax_full_mha__glu_gated_glu__prompt_kernel_u0plain
    s_sub_u32 s60, s60, 32
    s_mul_i32 s62, s60, 102400
    s_add_u32 s62, s62, 20480
    s_mul_i32 s41, s61, 640
    s_add_u32 s62, s62, s41
    s_add_u32 m0, s46, 0
    s_nop 0
    buffer_load_dwordx4 v25, s[28:31], s62 offen lds
    s_add_u32 m0, s46, 1024
    s_nop 0
    buffer_load_dwordx4 v26, s[28:31], s62 offen lds
    s_add_u32 m0, s46, 2048
    s_nop 0
    buffer_load_dwordx4 v27, s[28:31], s62 offen lds
    s_add_u32 m0, s46, 3072
    s_nop 0
    buffer_load_dwordx4 v28, s[28:31], s62 offen lds
    s_add_u32 m0, s46, 4096
    s_nop 0
    buffer_load_dwordx4 v29, s[28:31], s62 offen lds
    s_add_u32 m0, s46, 5120
    s_nop 0
    buffer_load_dwordx4 v30, s[28:31], s62 offen lds
    s_add_u32 m0, s46, 6144
    s_nop 0
    buffer_load_dwordx4 v31, s[28:31], s62 offen lds
    s_add_u32 m0, s46, 7168
    s_nop 0
    buffer_load_dwordx4 v32, s[28:31], s62 offen lds
    s_add_u32 m0, s46, 8192
    s_nop 0
    buffer_load_dwordx4 v33, s[28:31], s62 offen lds
    s_add_u32 m0, s46, 9216
    s_nop 0
    buffer_load_dwordx4 v34, s[28:31], s62 offen lds
    s_branch gated_mix__softmax_full_mha__glu_gated_glu__prompt_kernel_u0go
gated_mix__softmax_full_mha__glu_gated_glu__prompt_kernel_u0plain:
    s_mul_i32 s41, s61, 640
    s_add_u32 s62, s62, s41
    s_add_u32 m0, s46, 0
    s_nop 0
    buffer_load_dwordx4 v15, s[28:31], s62 offen lds
    s_add_u32 m0, s46, 1024
    s_nop 0
    buffer_load_dwordx4 v16, s[28:31], s62 offen lds
    s_add_u32 m0, s46, 2048
    s_nop 0
    buffer_load_dwordx4 v17, s[28:31], s62 offen lds
    s_add_u32 m0, s46, 3072
    s_nop 0
    buffer_load_dwordx4 v18, s[28:31], s62 offen lds
    s_add_u32 m0, s46, 4096
    s_nop 0
    buffer_load_dwordx4 v19, s[28:31], s62 offen lds
    s_add_u32 m0, s46, 5120
    s_nop 0
    buffer_load_dwordx4 v20, s[28:31], s62 offen lds
    s_add_u32 m0, s46, 6144
    s_nop 0
    buffer_load_dwordx4 v21, s[28:31], s62 offen lds
    s_add_u32 m0, s46, 7168
    s_nop 0
    buffer_load_dwordx4 v22, s[28:31], s62 offen lds
    s_add_u32 m0, s46, 8192
    s_nop 0
    buffer_load_dwordx4 v23, s[28:31], s62 offen lds
    s_add_u32 m0, s46, 9216
    s_nop 0
    buffer_load_dwordx4 v24, s[28:31], s62 offen lds
gated_mix__softmax_full_mha__glu_gated_glu__prompt_kernel_u0go:
    s_waitcnt vmcnt(0)
    ds_read_b64_tr_b16 v[66:67], v12 offset:0
    ds_read_b64_tr_b16 v[68:69], v12 offset:5120
    ds_read_b64_tr_b16 v[70:71], v13 offset:0
    ds_read_b64_tr_b16 v[72:73], v13 offset:5120
    ds_read_b64_tr_b16 v[74:75], v12 offset:128
    ds_read_b64_tr_b16 v[76:77], v12 offset:5248
    ds_read_b64_tr_b16 v[78:79], v13 offset:128
    ds_read_b64_tr_b16 v[80:81], v13 offset:5248
    ds_read_b64_tr_b16 v[82:83], v12 offset:256
    ds_read_b64_tr_b16 v[84:85], v12 offset:5376
    ds_read_b64_tr_b16 v[86:87], v13 offset:256
    ds_read_b64_tr_b16 v[88:89], v13 offset:5376
    ds_read_b64_tr_b16 v[90:91], v12 offset:384
    ds_read_b64_tr_b16 v[92:93], v12 offset:5504
    s_waitcnt lgkmcnt(6)
    ds_read_b64_tr_b16 v[94:95], v13 offset:384
    ds_read_b64_tr_b16 v[96:97], v13 offset:5504
    ds_read_b64_tr_b16 v[98:99], v12 offset:512
    ds_read_b64_tr_b16 v[100:101], v12 offset:5632
    ds_read_b64_tr_b16 v[102:103], v13 offset:512
    ds_read_b64_tr_b16 v[104:105], v13 offset:5632
    s_waitcnt lgkmcnt(0)
    s_add_u32 s52, s38, 4
    s_cmp_ge_u32 s52, 12
    s_cselect_b32 s41, 12, 0
    s_sub_u32 s52, s52, s41
    s_lshl_b32 s52, s52, 4
    s_add_u32 s52, s52, s53
    s_add_u32 s52, s52, 192
    s_cmp_lt_u32 s52, 296
    s_cbranch_scc1 gated_mix__softmax_full_mha__glu_gated_glu__prompt_kernel_two
    buffer_store_dwordx4 v[66:69], v14, s[32:35], s64 offen sc1
    s_add_u32 s64, s64, s65
    buffer_store_dwordx4 v[70:73], v14, s[32:35], s64 offen sc1
    s_add_u32 s64, s64, s65
    buffer_store_dwordx4 v[74:77], v14, s[32:35], s64 offen sc1
    s_add_u32 s64, s64, s65
    buffer_store_dwordx4 v[78:81], v14, s[32:35], s64 offen sc1
    s_add_u32 s64, s64, s65
    buffer_store_dwordx4 v[82:85], v14, s[32:35], s64 offen sc1
    s_add_u32 s64, s64, s65
    buffer_store_dwordx4 v[86:89], v14, s[32:35], s64 offen sc1
    s_add_u32 s64, s64, s65
    buffer_store_dwordx4 v[90:93], v14, s[32:35], s64 offen sc1
    s_add_u32 s64, s64, s65
    buffer_store_dwordx4 v[94:97], v14, s[32:35], s64 offen sc1
    s_add_u32 s64, s64, s65
    buffer_store_dwordx4 v[98:101], v14, s[32:35], s64 offen sc1
    s_add_u32 s64, s64, s65
    buffer_store_dwordx4 v[102:105], v14, s[32:35], s64 offen sc1
    s_add_u32 s64, s64, s65
    s_branch gated_mix__softmax_full_mha__glu_gated_glu__prompt_kernel_misc_done
gated_mix__softmax_full_mha__glu_gated_glu__prompt_kernel_two:
    s_lshr_b32 s60, s52, 1
    s_and_b32 s61, s52, 1
    s_cmp_ge_u32 s60, 108
    s_cbranch_scc1 gated_mix__softmax_full_mha__glu_gated_glu__prompt_kernel_u1wo
    s_mov_b32 s28, s16
    s_mov_b32 s29, s17
    s_mov_b32 s30, 2211840
    s_mov_b32 s31, 0x00020000
    s_mul_i32 s62, s60, 20480
    s_mul_i32 s98, s61, 1105920
    s_lshl_b32 s41, s60, 10
    s_add_u32 s98, s98, s41
    s_add_u32 s98, s98, 14942208
    s_mov_b32 s99, 110592
    s_mul_i32 s41, s61, 640
    s_add_u32 s62, s62, s41
    s_add_u32 m0, s46, 0
    s_nop 0
    buffer_load_dwordx4 v35, s[28:31], s62 offen lds
    s_add_u32 m0, s46, 1024
    s_nop 0
    buffer_load_dwordx4 v36, s[28:31], s62 offen lds
    s_add_u32 m0, s46, 2048
    s_nop 0
    buffer_load_dwordx4 v37, s[28:31], s62 offen lds
    s_add_u32 m0, s46, 3072
    s_nop 0
    buffer_load_dwordx4 v38, s[28:31], s62 offen lds
    s_add_u32 m0, s46, 4096
    s_nop 0
    buffer_load_dwordx4 v39, s[28:31], s62 offen lds
    s_add_u32 m0, s46, 5120
    s_nop 0
    buffer_load_dwordx4 v40, s[28:31], s62 offen lds
    s_add_u32 m0, s46, 6144
    s_nop 0
    buffer_load_dwordx4 v41, s[28:31], s62 offen lds
    s_add_u32 m0, s46, 7168
    s_nop 0
    buffer_load_dwordx4 v42, s[28:31], s62 offen lds
    s_add_u32 m0, s46, 8192
    s_nop 0
    buffer_load_dwordx4 v43, s[28:31], s62 offen lds
    s_add_u32 m0, s46, 9216
    s_nop 0
    buffer_load_dwordx4 v44, s[28:31], s62 offen lds
    s_branch gated_mix__softmax_full_mha__glu_gated_glu__prompt_kernel_u1go
gated_mix__softmax_full_mha__glu_gated_glu__prompt_kernel_u1wo:
    s_mov_b32 s28, s8
    s_mov_b32 s29, s9
    s_mov_b32 s30, 819200
    s_mov_b32 s31, 0x00020000
    s_sub_u32 s60, s60, 108
    s_mul_i32 s98, s61, 409600
    s_lshl_b32 s41, s60, 10
    s_add_u32 s98, s98, s41
    s_add_u32 s98, s98, 17154048
    s_mov_b32 s99, 40960
    s_mul_i32 s62, s60, 25600
    s_cmp_lt_u32 s60, 32
    s_cbranch_scc1 gated_mix__softmax_full_mha__glu_gated_glu__prompt_kernel_u1plain
    s_sub_u32 s60, s60, 32
    s_mul_i32 s62, s60, 102400
    s_add_u32 s62, s62, 20480
    s_mul_i32 s41, s61, 640
    s_add_u32 s62, s62, s41
    s_add_u32 m0, s46, 0
    s_nop 0
    buffer_load_dwordx4 v25, s[28:31], s62 offen lds
    s_add_u32 m0, s46, 1024
    s_nop 0
    buffer_load_dwordx4 v26, s[28:31], s62 offen lds
    s_add_u32 m0, s46, 2048
    s_nop 0
    buffer_load_dwordx4 v27, s[28:31], s62 offen lds
    s_add_u32 m0, s46, 3072
    s_nop 0
    buffer_load_dwordx4 v28, s[28:31], s62 offen lds
    s_add_u32 m0, s46, 4096
    s_nop 0
    buffer_load_dwordx4 v29, s[28:31], s62 offen lds
    s_add_u32 m0, s46, 5120
    s_nop 0
    buffer_load_dwordx4 v30, s[28:31], s62 offen lds
    s_add_u32 m0, s46, 6144
    s_nop 0
    buffer_load_dwordx4 v31, s[28:31], s62 offen lds
    s_add_u32 m0, s46, 7168
    s_nop 0
    buffer_load_dwordx4 v32, s[28:31], s62 offen lds
    s_add_u32 m0, s46, 8192
    s_nop 0
    buffer_load_dwordx4 v33, s[28:31], s62 offen lds
    s_add_u32 m0, s46, 9216
    s_nop 0
    buffer_load_dwordx4 v34, s[28:31], s62 offen lds
    s_branch gated_mix__softmax_full_mha__glu_gated_glu__prompt_kernel_u1go
gated_mix__softmax_full_mha__glu_gated_glu__prompt_kernel_u1plain:
    s_mul_i32 s41, s61, 640
    s_add_u32 s62, s62, s41
    s_add_u32 m0, s46, 0
    s_nop 0
    buffer_load_dwordx4 v15, s[28:31], s62 offen lds
    s_add_u32 m0, s46, 1024
    s_nop 0
    buffer_load_dwordx4 v16, s[28:31], s62 offen lds
    s_add_u32 m0, s46, 2048
    s_nop 0
    buffer_load_dwordx4 v17, s[28:31], s62 offen lds
    s_add_u32 m0, s46, 3072
    s_nop 0
    buffer_load_dwordx4 v18, s[28:31], s62 offen lds
    s_add_u32 m0, s46, 4096
    s_nop 0
    buffer_load_dwordx4 v19, s[28:31], s62 offen lds
    s_add_u32 m0, s46, 5120
    s_nop 0
    buffer_load_dwordx4 v20, s[28:31], s62 offen lds
    s_add_u32 m0, s46, 6144
    s_nop 0
    buffer_load_dwordx4 v21, s[28:31], s62 offen lds
    s_add_u32 m0, s46, 7168
    s_nop 0
    buffer_load_dwordx4 v22, s[28:31], s62 offen lds
    s_add_u32 m0, s46, 8192
    s_nop 0
    buffer_load_dwordx4 v23, s[28:31], s62 offen lds
    s_add_u32 m0, s46, 9216
    s_nop 0
    buffer_load_dwordx4 v24, s[28:31], s62 offen lds
gated_mix__softmax_full_mha__glu_gated_glu__prompt_kernel_u1go:
    buffer_store_dwordx4 v[66:69], v14, s[32:35], s64 offen sc1
    s_add_u32 s64, s64, s65
    buffer_store_dwordx4 v[70:73], v14, s[32:35], s64 offen sc1
    s_add_u32 s64, s64, s65
    buffer_store_dwordx4 v[74:77], v14, s[32:35], s64 offen sc1
    s_add_u32 s64, s64, s65
    buffer_store_dwordx4 v[78:81], v14, s[32:35], s64 offen sc1
    s_add_u32 s64, s64, s65
    buffer_store_dwordx4 v[82:85], v14, s[32:35], s64 offen sc1
    s_add_u32 s64, s64, s65
    buffer_store_dwordx4 v[86:89], v14, s[32:35], s64 offen sc1
    s_add_u32 s64, s64, s65
    buffer_store_dwordx4 v[90:93], v14, s[32:35], s64 offen sc1
    s_add_u32 s64, s64, s65
    buffer_store_dwordx4 v[94:97], v14, s[32:35], s64 offen sc1
    s_add_u32 s64, s64, s65
    buffer_store_dwordx4 v[98:101], v14, s[32:35], s64 offen sc1
    s_add_u32 s64, s64, s65
    buffer_store_dwordx4 v[102:105], v14, s[32:35], s64 offen sc1
    s_add_u32 s64, s64, s65
    s_waitcnt vmcnt(10)
    ds_read_b64_tr_b16 v[106:107], v12 offset:0
    ds_read_b64_tr_b16 v[108:109], v12 offset:5120
    ds_read_b64_tr_b16 v[110:111], v13 offset:0
    ds_read_b64_tr_b16 v[112:113], v13 offset:5120
    ds_read_b64_tr_b16 v[114:115], v12 offset:128
    ds_read_b64_tr_b16 v[116:117], v12 offset:5248
    ds_read_b64_tr_b16 v[118:119], v13 offset:128
    ds_read_b64_tr_b16 v[120:121], v13 offset:5248
    ds_read_b64_tr_b16 v[122:123], v12 offset:256
    ds_read_b64_tr_b16 v[124:125], v12 offset:5376
    ds_read_b64_tr_b16 v[126:127], v13 offset:256
    ds_read_b64_tr_b16 v[128:129], v13 offset:5376
    ds_read_b64_tr_b16 v[130:131], v12 offset:384
    ds_read_b64_tr_b16 v[132:133], v12 offset:5504
    s_waitcnt lgkmcnt(6)
    ds_read_b64_tr_b16 v[134:135], v13 offset:384
    ds_read_b64_tr_b16 v[136:137], v13 offset:5504
    ds_read_b64_tr_b16 v[138:139], v12 offset:512
    ds_read_b64_tr_b16 v[140:141], v12 offset:5632
    ds_read_b64_tr_b16 v[142:143], v13 offset:512
    ds_read_b64_tr_b16 v[144:145], v13 offset:5632
    s_waitcnt lgkmcnt(0)
    buffer_store_dwordx4 v[106:109], v14, s[32:35], s98 offen sc1
    s_add_u32 s98, s98, s99
    buffer_store_dwordx4 v[110:113], v14, s[32:35], s98 offen sc1
    s_add_u32 s98, s98, s99
    buffer_store_dwordx4 v[114:117], v14, s[32:35], s98 offen sc1
    s_add_u32 s98, s98, s99
    buffer_store_dwordx4 v[118:121], v14, s[32:35], s98 offen sc1
    s_add_u32 s98, s98, s99
    buffer_store_dwordx4 v[122:125], v14, s[32:35], s98 offen sc1
    s_add_u32 s98, s98, s99
    buffer_store_dwordx4 v[126:129], v14, s[32:35], s98 offen sc1
    s_add_u32 s98, s98, s99
    buffer_store_dwordx4 v[130:133], v14, s[32:35], s98 offen sc1
    s_add_u32 s98, s98, s99
    buffer_store_dwordx4 v[134:137], v14, s[32:35], s98 offen sc1
    s_add_u32 s98, s98, s99
    buffer_store_dwordx4 v[138:141], v14, s[32:35], s98 offen sc1
    s_add_u32 s98, s98, s99
    buffer_store_dwordx4 v[142:145], v14, s[32:35], s98 offen sc1
    s_add_u32 s98, s98, s99
gated_mix__softmax_full_mha__glu_gated_glu__prompt_kernel_misc_done:
    s_cmp_lg_u32 s38, 0
    s_cbranch_scc1 gated_mix__softmax_full_mha__glu_gated_glu__prompt_kernel_clrm_skip
    s_mov_b32 s56, s96
    s_mov_b32 s57, s97
    s_mov_b32 s58, 256
    s_mov_b32 s59, 0x00020000
    v_mov_b32 v2, 0
    s_mov_b32 s48, 0x40000
gated_mix__softmax_full_mha__glu_gated_glu__prompt_kernel_clrm:
    buffer_load_dword v3, v2, s[56:59], 0 offen sc1
    s_waitcnt vmcnt(0)
    v_cmp_gt_u32 vcc, 44, v3
    s_cbranch_vccz gated_mix__softmax_full_mha__glu_gated_glu__prompt_kernel_clrm_ok
    s_sleep 6
    s_sub_u32 s48, s48, 1
    s_cbranch_scc0 gated_mix__softmax_full_mha__glu_gated_glu__prompt_kernel_clrm
gated_mix__softmax_full_mha__glu_gated_glu__prompt_kernel_clrm_ok:
gated_mix__softmax_full_mha__glu_gated_glu__prompt_kernel_clrm_skip:
    s_barrier
    s_waitcnt vmcnt(0)
    v_mov_b32 v2, 161792
    v_mov_b32 v3, 1
    s_mov_b64 exec, 1
    ds_add_rtn_u32 v4, v2, v3
    s_mov_b64 exec, -1
    v_lshlrev_b32 v2, 10, v1
    s_cmp_lt_u32 s45, 23232512
    s_cselect_b32 s42, 8, 1
    v_mov_b32 v5, 1073741824
    v_cmp_gt_u32 vcc, s42, v1
    s_nop 1
    v_cndmask_b32 v2, v5, v2, vcc
    s_waitcnt lgkmcnt(0)
    v_readfirstlane_b32 s41, v4
    s_nop 3
    s_cmp_lg_u32 s41, 11
    s_cbranch_scc1 gated_mix__softmax_full_mha__glu_gated_glu__prompt_kernel_pubm
    buffer_store_dword v3, v2, s[32:35], s45 offen sc1
gated_mix__softmax_full_mha__glu_gated_glu__prompt_kernel_pubm:
    s_barrier
    s_cmp_ge_u32 s38, 8
    s_cbranch_scc1 gated_mix__softmax_full_mha__glu_gated_glu__prompt_kernel_aux
gated_mix__softmax_full_mha__glu_gated_glu__prompt_kernel_att:
    s_setprio 0
    s_lshr_b32 s41, s37, 3
    s_lshl_b32 s4, s36, 2
    s_add_u32 s4, s4, s41
    s_and_b32 s5, s37, 7
    s_mul_i32 s6, s4, 81920
    s_add_u32 s7, s6, 5242880
    s_and_b32 s8, s38, 3
    s_lshr_b32 s9, s38, 2
    s_add_u32 s6, s6, 2621440
    s_mov_b32 s16, 0xfffff
    s_mov_b32 s17, 0xfffff
    v_lshlrev_b32 v8, 4, v1
    v_and_b32 v2, 31, v1
    v_lshrrev_b32 v3, 5, v1
    v_lshlrev_b32 v4, 2, v3
    v_and_b32 v5, 7, v1
    v_lshl_add_u32 v9, v5, 4, v4
    v_bfe_u32 v5, v1, 4, 1
    v_lshl_add_u32 v9, v5, 7, v9
    v_lshl_add_u32 v7, v5, 3, v4
    v_bfe_u32 v5, v1, 3, 1
    v_lshl_add_u32 v9, v5, 3, v9
    v_and_b32 v5, 15, v1
    v_lshl_add_u32 v7, v5, 4, v7
    v_cmp_gt_u32 vcc, 32, v1
    v_mov_b32 v6, 0x3f80
    v_mov_b32 v5, 0x3f803f80
    v_cndmask_b32 v41, v6, v5, vcc
    v_and_b32 v6, 31, v1
    v_cmp_eq_u32 vcc, 20, v6
    v_mov_b32 v43, v41
    s_nop 0
    v_cndmask_b32 v6, 0, v5, vcc
    v_mov_b32 v44, v6
    v_mov_b32 v45, v6
    v_mov_b32 v46, v6
    v_mov_b32 v47, v6
    v_mov_b32 v48, v6
    v_mov_b32 v49, v6
    v_mov_b32 v50, v6
    v_mov_b32 v51, v6
    v_mov_b32 v52, v6
    v_mov_b32 v53, v6
    v_mov_b32 v54, v6
    v_mov_b32 v55, v6
    v_mov_b32 v56, v6
    v_mov_b32 v57, v6
    v_mov_b32 v58, v6
    v_mov_b32 v59, v6
    v_mov_b32 v29, 0
    v_mov_b32 v31, 0
    s_mul_i32 s42, s9, 10240
    v_add_u32 v11, s42, v8
    v_add_u32 v13, s42, v9
    v_add_u32 v13, 1024, v13
    v_add_u32 v12, 61440, v11
    v_add_u32 v14, 61440, v13
    v_mul_u32_u24 v5, 20, v3
    v_add_lshl_u32 v10, v2, v5, 4
    v_add_u32 v5, s42, v10
    v_add_u32 v15, 131072, v5
    v_add_u32 v16, 40960, v5
    v_add_u32 v17, 81920, v5
    s_mul_i32 s42, s8, 2560
    s_add_u32 s42, s42, 151552
    v_add_u32 v6, s42, v8
    v_add_u32 v7, s42, v7
    s_barrier
    ds_read_b128 v[20:23], v6 offset:0
    ds_read_b32 v28, v7 offset:1024
    ds_read_b128 v[24:27], v6 offset:1280
    ds_read_b32 v30, v7 offset:2304
    ds_read_b128 v[36:39], v8 offset:0
    ds_read_b32 v42, v9 offset:1024
    ds_read_b128 v[32:35], v11 offset:0
    ds_read_b32 v40, v13 offset:0
    s_waitcnt lgkmcnt(2)
    v_mfma_f32_32x32x16_bf16 v[76:91], v[36:39], v[20:23], 0
    v_mfma_f32_32x32x8_bf16 v[76:91], v[42:43], v[28:29], v[76:91]
    v_mfma_f32_32x32x16_bf16 v[92:107], v[36:39], v[24:27], 0
    v_mfma_f32_32x32x8_bf16 v[92:107], v[42:43], v[30:31], v[92:107]
    s_nop 9
    v_cmp_gt_u32 vcc, 32, v1
    v_max3_f32 v3, v76, v77, v78
    v_max3_f32 v3, v3, v79, v80
    v_max3_f32 v3, v3, v81, v82
    v_max3_f32 v4, v92, v93, v94
    v_max3_f32 v3, v3, v83, v84
    v_max3_f32 v4, v4, v95, v96
    v_max3_f32 v3, v3, v85, v86
    v_max3_f32 v4, v4, v97, v98
    v_max3_f32 v3, v3, v87, v88
    v_max3_f32 v4, v4, v99, v100
    v_max3_f32 v3, v3, v89, v90
    v_max3_f32 v4, v4, v101, v102
    v_max_f32 v3, v3, v91
    v_max3_f32 v4, v4, v103, v104
    v_mov_b32 v5, v3
    v_max3_f32 v4, v4, v105, v106
    s_nop 1
    v_max_f32 v4, v4, v107
    v_permlane32_swap_b32 v3, v5
    v_mov_b32 v60, v4
    v_max_f32 v3, v3, v5
    s_nop 1
    v_sub_f32 v3, 0, v3
    v_permlane32_swap_b32 v4, v60
    v_and_b32 v5, 0xffff0000, v3
    v_max_f32 v4, v4, v60
    v_sub_f32 v3, v3, v5
    v_sub_f32 v4, 0, v4
    v_and_b32 v6, 0xffff0000, v3
    v_and_b32 v60, 0xffff0000, v4
    v_sub_f32 v3, v3, v6
    v_sub_f32 v4, v4, v60
    v_lshrrev_b32 v5, 16, v5
    v_and_b32 v61, 0xffff0000, v4
    v_or_b32 v5, v5, v6
    v_sub_f32 v4, v4, v61
    v_lshrrev_b32 v3, 16, v3
    v_lshrrev_b32 v60, 16, v60
    v_cndmask_b32 v29, v3, v5, vcc
    v_or_b32 v60, v60, v61
    s_waitcnt lgkmcnt(0)
    v_mfma_f32_32x32x16_bf16 v[76:91], v[32:35], v[20:23], 0
    v_lshrrev_b32 v4, 16, v4
    v_cndmask_b32 v31, v4, v60, vcc
    v_mfma_f32_32x32x8_bf16 v[76:91], v[40:41], v[28:29], v[76:91]
    s_nop 8
    s_setprio 3
    v_mfma_f32_32x32x16_bf16 v[92:107], v[32:35], v[24:27], 0
    ds_read_b128 v[36:39], v11 offset:1280
    ds_read_b32 v42, v13 offset:1280
    v_exp_f32 v76, v76
    v_exp_f32 v77, v77
    v_exp_f32 v78, v78
    v_exp_f32 v79, v79
    v_cvt_pk_bf16_f32 v60, v76, v77
    v_mfma_f32_32x32x8_bf16 v[92:107], v[40:41], v[30:31], v[92:107]
    v_exp_f32 v80, v80
    v_exp_f32 v81, v81
    v_cvt_pk_bf16_f32 v61, v78, v79
    v_exp_f32 v82, v82
    v_exp_f32 v83, v83
    v_cvt_pk_bf16_f32 v62, v80, v81
    s_mov_b64 exec, s[16:17]
    ds_read_b128 v[44:47], v15 offset:0
    ds_read_b128 v[48:51], v15 offset:640
    s_mov_b64 exec, -1
    v_exp_f32 v84, v84
    v_exp_f32 v85, v85
    v_cvt_pk_bf16_f32 v63, v82, v83
    v_exp_f32 v86, v86
    v_exp_f32 v87, v87
    v_cvt_pk_bf16_f32 v64, v84, v85
    v_exp_f32 v88, v88
    v_exp_f32 v89, v89
    v_cvt_pk_bf16_f32 v65, v86, v87
    v_exp_f32 v90, v90
    v_exp_f32 v91, v91
    v_cvt_pk_bf16_f32 v66, v88, v89
    v_cvt_pk_bf16_f32 v67, v90, v91
    s_setprio 2
    s_waitcnt lgkmcnt(0)
    v_mfma_f32_32x32x16_bf16 v[76:91], v[36:39], v[20:23], 0
    v_exp_f32 v92, v92
    v_exp_f32 v93, v93
    v_exp_f32 v94, v94
    v_exp_f32 v95, v95
    v_cvt_pk_bf16_f32 v68, v92, v93
    v_mfma_f32_32x32x8_bf16 v[76:91], v[42:43], v[28:29], v[76:91]
    v_exp_f32 v96, v96
    v_exp_f32 v97, v97
    v_cvt_pk_bf16_f32 v69, v94, v95
    v_exp_f32 v98, v98
    v_exp_f32 v99, v99
    v_cvt_pk_bf16_f32 v70, v96, v97
    v_mfma_f32_32x32x16_bf16 v[108:123], v[44:47], v[60:63], 0
    v_exp_f32 v100, v100
    v_exp_f32 v101, v101
    v_cvt_pk_bf16_f32 v71, v98, v99
    v_exp_f32 v102, v102
    v_exp_f32 v103, v103
    v_cvt_pk_bf16_f32 v72, v100, v101
    v_mfma_f32_32x32x16_bf16 v[108:123], v[48:51], v[64:67], v[108:123]
    v_exp_f32 v104, v104
    v_exp_f32 v105, v105
    v_cvt_pk_bf16_f32 v73, v102, v103
    v_exp_f32 v106, v106
    v_exp_f32 v107, v107
    v_cvt_pk_bf16_f32 v74, v104, v105
    v_cvt_pk_bf16_f32 v75, v106, v107
    s_cmp_lt_u32 s45, 23232512
    s_cbranch_scc1 gated_mix__softmax_full_mha__glu_gated_glu__prompt_kernel_noh0
    buffer_store_dwordx4 v[156:159], v8, s[32:35], s61 offen offset:2048 sc1
gated_mix__softmax_full_mha__glu_gated_glu__prompt_kernel_noh0:
    s_setprio 1
    v_mfma_f32_32x32x16_bf16 v[92:107], v[36:39], v[24:27], 0
    ds_read_b128 v[32:35], v11 offset:2560
    ds_read_b32 v40, v13 offset:2560
    v_exp_f32 v76, v76
    v_exp_f32 v77, v77
    v_exp_f32 v78, v78
    v_exp_f32 v79, v79
    v_cvt_pk_bf16_f32 v60, v76, v77
    v_mfma_f32_32x32x8_bf16 v[92:107], v[42:43], v[30:31], v[92:107]
    v_exp_f32 v80, v80
    v_exp_f32 v81, v81
    v_cvt_pk_bf16_f32 v61, v78, v79
    v_exp_f32 v82, v82
    v_exp_f32 v83, v83
    v_cvt_pk_bf16_f32 v62, v80, v81
    v_mfma_f32_32x32x16_bf16 v[124:139], v[44:47], v[68:71], 0
    s_mov_b64 exec, s[16:17]
    ds_read_b128 v[52:55], v15 offset:1280
    ds_read_b128 v[56:59], v15 offset:1920
    s_mov_b64 exec, -1
    v_exp_f32 v84, v84
    v_exp_f32 v85, v85
    v_cvt_pk_bf16_f32 v63, v82, v83
    v_exp_f32 v86, v86
    v_exp_f32 v87, v87
    v_cvt_pk_bf16_f32 v64, v84, v85
    v_mfma_f32_32x32x16_bf16 v[124:139], v[48:51], v[72:75], v[124:139]
    v_exp_f32 v88, v88
    v_exp_f32 v89, v89
    v_cvt_pk_bf16_f32 v65, v86, v87
    v_exp_f32 v90, v90
    v_exp_f32 v91, v91
    v_cvt_pk_bf16_f32 v66, v88, v89
    v_cvt_pk_bf16_f32 v67, v90, v91
    s_setprio 0
    s_cmp_lt_u32 s45, 23232512
    s_cbranch_scc1 gated_mix__softmax_full_mha__glu_gated_glu__prompt_kernel_noh1
    buffer_store_dwordx4 v[160:163], v8, s[32:35], s61 offen offset:1024 sc1
gated_mix__softmax_full_mha__glu_gated_glu__prompt_kernel_noh1:
    s_waitcnt lgkmcnt(0)
    v_mfma_f32_32x32x16_bf16 v[76:91], v[32:35], v[20:23], 0
    v_exp_f32 v92, v92
    v_exp_f32 v93, v93
    v_exp_f32 v94, v94
    v_exp_f32 v95, v95
    v_cvt_pk_bf16_f32 v68, v92, v93
    v_mfma_f32_32x32x8_bf16 v[76:91], v[40:41], v[28:29], v[76:91]
    v_exp_f32 v96, v96
    v_exp_f32 v97, v97
    v_cvt_pk_bf16_f32 v69, v94, v95
    v_exp_f32 v98, v98
    v_exp_f32 v99, v99
    v_cvt_pk_bf16_f32 v70, v96, v97
    v_mfma_f32_32x32x16_bf16 v[108:123], v[52:55], v[60:63], v[108:123]
    v_exp_f32 v100, v100
    v_exp_f32 v101, v101
    v_cvt_pk_bf16_f32 v71, v98, v99
    v_exp_f32 v102, v102
    v_exp_f32 v103, v103
    v_cvt_pk_bf16_f32 v72, v100, v101
    v_mfma_f32_32x32x16_bf16 v[108:123], v[56:59], v[64:67], v[108:123]
    v_exp_f32 v104, v104
    v_exp_f32 v105, v105
    v_cvt_pk_bf16_f32 v73, v102, v103
    v_exp_f32 v106, v106
    v_exp_f32 v107, v107
    v_cvt_pk_bf16_f32 v74, v104, v105
    v_cvt_pk_bf16_f32 v75, v106, v107
    s_barrier
    s_cmp_lt_u32 s45, 23232512
    s_cbranch_scc1 gated_mix__softmax_full_mha__glu_gated_glu__prompt_kernel_noh2
    buffer_store_dwordx4 v[164:167], v8, s[32:35], s61 offen offset:0 sc1
gated_mix__softmax_full_mha__glu_gated_glu__prompt_kernel_noh2:
    s_setprio 3
    v_mfma_f32_32x32x16_bf16 v[92:107], v[32:35], v[24:27], 0
    ds_read_b128 v[36:39], v11 offset:3840
    ds_read_b32 v42, v13 offset:3840
    v_exp_f32 v76, v76
    v_exp_f32 v77, v77
    v_exp_f32 v78, v78
    v_exp_f32 v79, v79
    v_cvt_pk_bf16_f32 v60, v76, v77
    v_mfma_f32_32x32x8_bf16 v[92:107], v[40:41], v[30:31], v[92:107]
    v_exp_f32 v80, v80
    v_exp_f32 v81, v81
    v_cvt_pk_bf16_f32 v61, v78, v79
    v_exp_f32 v82, v82
    v_exp_f32 v83, v83
    v_cvt_pk_bf16_f32 v62, v80, v81
    v_mfma_f32_32x32x16_bf16 v[124:139], v[52:55], v[68:71], v[124:139]
    s_mov_b64 exec, s[16:17]
    ds_read_b128 v[44:47], v15 offset:2560
    ds_read_b128 v[48:51], v15 offset:3200
    s_mov_b64 exec, -1
    v_exp_f32 v84, v84
    v_exp_f32 v85, v85
    v_cvt_pk_bf16_f32 v63, v82, v83
    v_exp_f32 v86, v86
    v_exp_f32 v87, v87
    v_cvt_pk_bf16_f32 v64, v84, v85
    v_mfma_f32_32x32x16_bf16 v[124:139], v[56:59], v[72:75], v[124:139]
    v_exp_f32 v88, v88
    v_exp_f32 v89, v89
    v_cvt_pk_bf16_f32 v65, v86, v87
    v_exp_f32 v90, v90
    v_exp_f32 v91, v91
    v_cvt_pk_bf16_f32 v66, v88, v89
    v_cvt_pk_bf16_f32 v67, v90, v91
    s_setprio 2
    s_cmp_lt_u32 s45, 23232512
    s_cbranch_scc1 gated_mix__softmax_full_mha__glu_gated_glu__prompt_kernel_noh3
    buffer_store_dwordx4 v[140:143], v8, s[32:35], s60 offen offset:2048 sc1
gated_mix__softmax_full_mha__glu_gated_glu__prompt_kernel_noh3:
    s_waitcnt lgkmcnt(0)
    v_mfma_f32_32x32x16_bf16 v[76:91], v[36:39], v[20:23], 0
    v_exp_f32 v92, v92
    v_exp_f32 v93, v93
    v_exp_f32 v94, v94
    v_exp_f32 v95, v95
    v_cvt_pk_bf16_f32 v68, v92, v93
    v_mfma_f32_32x32x8_bf16 v[76:91], v[42:43], v[28:29], v[76:91]
    v_exp_f32 v96, v96
    v_exp_f32 v97, v97
    v_cvt_pk_bf16_f32 v69, v94, v95
    v_exp_f32 v98, v98
    v_exp_f32 v99, v99
    v_cvt_pk_bf16_f32 v70, v96, v97
    v_mfma_f32_32x32x16_bf16 v[108:123], v[44:47], v[60:63], v[108:123]
    v_exp_f32 v100, v100
    v_exp_f32 v101, v101
    v_cvt_pk_bf16_f32 v71, v98, v99
    v_exp_f32 v102, v102
    v_exp_f32 v103, v103
    v_cvt_pk_bf16_f32 v72, v100, v101
    v_mfma_f32_32x32x16_bf16 v[108:123], v[48:51], v[64:67], v[108:123]
    v_exp_f32 v104, v104
    v_exp_f32 v105, v105
    v_cvt_pk_bf16_f32 v73, v102, v103
    v_exp_f32 v106, v106
    v_exp_f32 v107, v107
    v_cvt_pk_bf16_f32 v74, v104, v105
    v_cvt_pk_bf16_f32 v75, v106, v107
    s_cmp_lt_u32 s45, 23232512
    s_cbranch_scc1 gated_mix__softmax_full_mha__glu_gated_glu__prompt_kernel_noh4
    buffer_store_dwordx4 v[144:147], v8, s[32:35], s60 offen offset:1024 sc1
gated_mix__softmax_full_mha__glu_gated_glu__prompt_kernel_noh4:
    s_setprio 1
    v_mfma_f32_32x32x16_bf16 v[92:107], v[36:39], v[24:27], 0
    ds_read_b128 v[32:35], v11 offset:5120
    ds_read_b32 v40, v13 offset:5120
    v_exp_f32 v76, v76
    v_exp_f32 v77, v77
    v_exp_f32 v78, v78
    v_exp_f32 v79, v79
    v_cvt_pk_bf16_f32 v60, v76, v77
    v_mfma_f32_32x32x8_bf16 v[92:107], v[42:43], v[30:31], v[92:107]
    v_exp_f32 v80, v80
    v_exp_f32 v81, v81
    v_cvt_pk_bf16_f32 v61, v78, v79
    v_exp_f32 v82, v82
    v_exp_f32 v83, v83
    v_cvt_pk_bf16_f32 v62, v80, v81
    v_mfma_f32_32x32x16_bf16 v[124:139], v[44:47], v[68:71], v[124:139]
    s_mov_b64 exec, s[16:17]
    ds_read_b128 v[52:55], v15 offset:3840
    ds_read_b128 v[56:59], v15 offset:4480
    s_mov_b64 exec, -1
    v_exp_f32 v84, v84
    v_exp_f32 v85, v85
    v_cvt_pk_bf16_f32 v63, v82, v83
    v_exp_f32 v86, v86
    v_exp_f32 v87, v87
    v_cvt_pk_bf16_f32 v64, v84, v85
    v_mfma_f32_32x32x16_bf16 v[124:139], v[48:51], v[72:75], v[124:139]
    v_exp_f32 v88, v88
    v_exp_f32 v89, v89
    v_cvt_pk_bf16_f32 v65, v86, v87
    v_exp_f32 v90, v90
    v_exp_f32 v91, v91
    v_cvt_pk_bf16_f32 v66, v88, v89
    v_cvt_pk_bf16_f32 v67, v90, v91
    s_setprio 0
    s_cmp_lt_u32 s45, 23232512
    s_cbranch_scc1 gated_mix__softmax_full_mha__glu_gated_glu__prompt_kernel_noh5
    buffer_store_dwordx4 v[148:151], v8, s[32:35], s60 offen offset:0 sc1
gated_mix__softmax_full_mha__glu_gated_glu__prompt_kernel_noh5:
    s_waitcnt lgkmcnt(0)
    v_mfma_f32_32x32x16_bf16 v[76:91], v[32:35], v[20:23], 0
    v_exp_f32 v92, v92
    v_exp_f32 v93, v93
    v_exp_f32 v94, v94
    v_exp_f32 v95, v95
    v_cvt_pk_bf16_f32 v68, v92, v93
    v_mfma_f32_32x32x8_bf16 v[76:91], v[40:41], v[28:29], v[76:91]
    v_exp_f32 v96, v96
    v_exp_f32 v97, v97
    v_cvt_pk_bf16_f32 v69, v94, v95
    v_exp_f32 v98, v98
    v_exp_f32 v99, v99
    v_cvt_pk_bf16_f32 v70, v96, v97
    v_mfma_f32_32x32x16_bf16 v[108:123], v[52:55], v[60:63], v[108:123]
    v_exp_f32 v100, v100
    v_exp_f32 v101, v101
    v_cvt_pk_bf16_f32 v71, v98, v99
    v_exp_f32 v102, v102
    v_exp_f32 v103, v103
    v_cvt_pk_bf16_f32 v72, v100, v101
    v_mfma_f32_32x32x16_bf16 v[108:123], v[56:59], v[64:67], v[108:123]
    v_exp_f32 v104, v104
    v_exp_f32 v105, v105
    v_cvt_pk_bf16_f32 v73, v102, v103
    v_exp_f32 v106, v106
    v_exp_f32 v107, v107
    v_cvt_pk_bf16_f32 v74, v104, v105
    v_cvt_pk_bf16_f32 v75, v106, v107
    s_setprio 3
    v_mfma_f32_32x32x16_bf16 v[92:107], v[32:35], v[24:27], 0
    ds_read_b128 v[36:39], v11 offset:6400
    ds_read_b32 v42, v13 offset:6400
    v_exp_f32 v76, v76
    v_exp_f32 v77, v77
    v_exp_f32 v78, v78
    v_exp_f32 v79, v79
    v_cvt_pk_bf16_f32 v60, v76, v77
    v_mfma_f32_32x32x8_bf16 v[92:107], v[40:41], v[30:31], v[92:107]
    v_exp_f32 v80, v80
    v_exp_f32 v81, v81
    v_cvt_pk_bf16_f32 v61, v78, v79
    v_exp_f32 v82, v82
    v_exp_f32 v83, v83
    v_cvt_pk_bf16_f32 v62, v80, v81
    v_mfma_f32_32x32x16_bf16 v[124:139], v[52:55], v[68:71], v[124:139]
    s_mov_b64 exec, s[16:17]
    ds_read_b128 v[44:47], v15 offset:5120
    ds_read_b128 v[48:51], v15 offset:5760
    s_mov_b64 exec, -1
    v_exp_f32 v84, v84
    v_exp_f32 v85, v85
    v_cvt_pk_bf16_f32 v63, v82, v83
    v_exp_f32 v86, v86
    v_exp_f32 v87, v87
    v_cvt_pk_bf16_f32 v64, v84, v85
    v_mfma_f32_32x32x16_bf16 v[124:139], v[56:59], v[72:75], v[124:139]
    v_exp_f32 v88, v88
    v_exp_f32 v89, v89
    v_cvt_pk_bf16_f32 v65, v86, v87
    v_exp_f32 v90, v90
    v_exp_f32 v91, v91
    v_cvt_pk_bf16_f32 v66, v88, v89
    v_cvt_pk_bf16_f32 v67, v90, v91
    s_setprio 2
    s_waitcnt lgkmcnt(0)
    v_mfma_f32_32x32x16_bf16 v[76:91], v[36:39], v[20:23], 0
    v_exp_f32 v92, v92
    v_exp_f32 v93, v93
    v_exp_f32 v94, v94
    v_exp_f32 v95, v95
    v_cvt_pk_bf16_f32 v68, v92, v93
    v_mfma_f32_32x32x8_bf16 v[76:91], v[42:43], v[28:29], v[76:91]
    v_exp_f32 v96, v96
    v_exp_f32 v97, v97
    v_cvt_pk_bf16_f32 v69, v94, v95
    v_exp_f32 v98, v98
    v_exp_f32 v99, v99
    v_cvt_pk_bf16_f32 v70, v96, v97
    v_mfma_f32_32x32x16_bf16 v[108:123], v[44:47], v[60:63], v[108:123]
    v_exp_f32 v100, v100
    v_exp_f32 v101, v101
    v_cvt_pk_bf16_f32 v71, v98, v99
    v_exp_f32 v102, v102
    v_exp_f32 v103, v103
    v_cvt_pk_bf16_f32 v72, v100, v101
    v_mfma_f32_32x32x16_bf16 v[108:123], v[48:51], v[64:67], v[108:123]
    v_exp_f32 v104, v104
    v_exp_f32 v105, v105
    v_cvt_pk_bf16_f32 v73, v102, v103
    v_exp_f32 v106, v106
    v_exp_f32 v107, v107
    v_cvt_pk_bf16_f32 v74, v104, v105
    v_cvt_pk_bf16_f32 v75, v106, v107
    s_waitcnt vmcnt(0)
    s_barrier
    s_setprio 1
    v_mfma_f32_32x32x16_bf16 v[92:107], v[36:39], v[24:27], 0
    ds_read_b128 v[32:35], v11 offset:7680
    ds_read_b32 v40, v13 offset:7680
    v_exp_f32 v76, v76
    v_exp_f32 v77, v77
    v_exp_f32 v78, v78
    v_exp_f32 v79, v79
    v_cvt_pk_bf16_f32 v60, v76, v77
    v_mfma_f32_32x32x8_bf16 v[92:107], v[42:43], v[30:31], v[92:107]
    v_exp_f32 v80, v80
    v_exp_f32 v81, v81
    v_cvt_pk_bf16_f32 v61, v78, v79
    v_exp_f32 v82, v82
    v_exp_f32 v83, v83
    v_cvt_pk_bf16_f32 v62, v80, v81
    v_mfma_f32_32x32x16_bf16 v[124:139], v[44:47], v[68:71], v[124:139]
    s_mov_b64 exec, s[16:17]
    ds_read_b128 v[52:55], v15 offset:6400
    ds_read_b128 v[56:59], v15 offset:7040
    s_mov_b64 exec, -1
    v_exp_f32 v84, v84
    v_exp_f32 v85, v85
    v_cvt_pk_bf16_f32 v63, v82, v83
    v_exp_f32 v86, v86
    v_exp_f32 v87, v87
    v_cvt_pk_bf16_f32 v64, v84, v85
    v_mfma_f32_32x32x16_bf16 v[124:139], v[48:51], v[72:75], v[124:139]
    v_exp_f32 v88, v88
    v_exp_f32 v89, v89
    v_cvt_pk_bf16_f32 v65, v86, v87
    v_exp_f32 v90, v90
    v_exp_f32 v91, v91
    v_cvt_pk_bf16_f32 v66, v88, v89
    v_cvt_pk_bf16_f32 v67, v90, v91
    s_setprio 0
    s_waitcnt lgkmcnt(0)
    v_mfma_f32_32x32x16_bf16 v[76:91], v[32:35], v[20:23], 0
    v_exp_f32 v92, v92
    v_exp_f32 v93, v93
    v_exp_f32 v94, v94
    v_exp_f32 v95, v95
    v_cvt_pk_bf16_f32 v68, v92, v93
    v_mfma_f32_32x32x8_bf16 v[76:91], v[40:41], v[28:29], v[76:91]
    v_exp_f32 v96, v96
    v_exp_f32 v97, v97
    v_cvt_pk_bf16_f32 v69, v94, v95
    v_exp_f32 v98, v98
    v_exp_f32 v99, v99
    v_cvt_pk_bf16_f32 v70, v96, v97
    v_mfma_f32_32x32x16_bf16 v[108:123], v[52:55], v[60:63], v[108:123]
    v_exp_f32 v100, v100
    v_exp_f32 v101, v101
    v_cvt_pk_bf16_f32 v71, v98, v99
    v_exp_f32 v102, v102
    v_exp_f32 v103, v103
    v_cvt_pk_bf16_f32 v72, v100, v101
    v_mfma_f32_32x32x16_bf16 v[108:123], v[56:59], v[64:67], v[108:123]
    v_exp_f32 v104, v104
    v_exp_f32 v105, v105
    v_cvt_pk_bf16_f32 v73, v102, v103
    v_exp_f32 v106, v106
    v_exp_f32 v107, v107
    v_cvt_pk_bf16_f32 v74, v104, v105
    v_cvt_pk_bf16_f32 v75, v106, v107
    s_setprio 3
    v_mfma_f32_32x32x16_bf16 v[92:107], v[32:35], v[24:27], 0
    ds_read_b128 v[36:39], v11 offset:8960
    ds_read_b32 v42, v13 offset:8960
    v_exp_f32 v76, v76
    v_exp_f32 v77, v77
    v_exp_f32 v78, v78
    v_exp_f32 v79, v79
    v_cvt_pk_bf16_f32 v60, v76, v77
    v_mfma_f32_32x32x8_bf16 v[92:107], v[40:41], v[30:31], v[92:107]
    v_exp_f32 v80, v80
    v_exp_f32 v81, v81
    v_cvt_pk_bf16_f32 v61, v78, v79
    v_exp_f32 v82, v82
    v_exp_f32 v83, v83
    v_cvt_pk_bf16_f32 v62, v80, v81
    v_mfma_f32_32x32x16_bf16 v[124:139], v[52:55], v[68:71], v[124:139]
    s_mov_b64 exec, s[16:17]
    ds_read_b128 v[44:47], v15 offset:7680
    ds_read_b128 v[48:51], v15 offset:8320
    s_mov_b64 exec, -1
    v_exp_f32 v84, v84
    v_exp_f32 v85, v85
    v_cvt_pk_bf16_f32 v63, v82, v83
    v_exp_f32 v86, v86
    v_exp_f32 v87, v87
    v_cvt_pk_bf16_f32 v64, v84, v85
    v_mfma_f32_32x32x16_bf16 v[124:139], v[56:59], v[72:75], v[124:139]
    v_exp_f32 v88, v88
    v_exp_f32 v89, v89
    v_cvt_pk_bf16_f32 v65, v86, v87
    v_exp_f32 v90, v90
    v_exp_f32 v91, v91
    v_cvt_pk_bf16_f32 v66, v88, v89
    v_cvt_pk_bf16_f32 v67, v90, v91
    s_setprio 2
    s_waitcnt lgkmcnt(0)
    v_mfma_f32_32x32x16_bf16 v[76:91], v[36:39], v[20:23], 0
    v_exp_f32 v92, v92
    v_exp_f32 v93, v93
    v_exp_f32 v94, v94
    v_exp_f32 v95, v95
    v_cvt_pk_bf16_f32 v68, v92, v93
    v_mfma_f32_32x32x8_bf16 v[76:91], v[42:43], v[28:29], v[76:91]
    v_exp_f32 v96, v96
    v_exp_f32 v97, v97
    v_cvt_pk_bf16_f32 v69, v94, v95
    v_exp_f32 v98, v98
    v_exp_f32 v99, v99
    v_cvt_pk_bf16_f32 v70, v96, v97
    v_mfma_f32_32x32x16_bf16 v[108:123], v[44:47], v[60:63], v[108:123]
    v_exp_f32 v100, v100
    v_exp_f32 v101, v101
    v_cvt_pk_bf16_f32 v71, v98, v99
    v_exp_f32 v102, v102
    v_exp_f32 v103, v103
    v_cvt_pk_bf16_f32 v72, v100, v101
    v_mfma_f32_32x32x16_bf16 v[108:123], v[48:51], v[64:67], v[108:123]
    v_exp_f32 v104, v104
    v_exp_f32 v105, v105
    v_cvt_pk_bf16_f32 v73, v102, v103
    v_exp_f32 v106, v106
    v_exp_f32 v107, v107
    v_cvt_pk_bf16_f32 v74, v104, v105
    v_cvt_pk_bf16_f32 v75, v106, v107
    s_setprio 1
    v_mfma_f32_32x32x16_bf16 v[92:107], v[36:39], v[24:27], 0
    ds_read_b128 v[32:35], v11 offset:20480
    ds_read_b32 v40, v13 offset:20480
    v_exp_f32 v76, v76
    v_exp_f32 v77, v77
    v_exp_f32 v78, v78
    v_exp_f32 v79, v79
    v_cvt_pk_bf16_f32 v60, v76, v77
    v_mfma_f32_32x32x8_bf16 v[92:107], v[42:43], v[30:31], v[92:107]
    v_exp_f32 v80, v80
    v_exp_f32 v81, v81
    v_cvt_pk_bf16_f32 v61, v78, v79
    v_exp_f32 v82, v82
    v_exp_f32 v83, v83
    v_cvt_pk_bf16_f32 v62, v80, v81
    v_mfma_f32_32x32x16_bf16 v[124:139], v[44:47], v[68:71], v[124:139]
    s_mov_b64 exec, s[16:17]
    ds_read_b128 v[52:55], v15 offset:8960
    ds_read_b128 v[56:59], v15 offset:9600
    s_mov_b64 exec, -1
    v_exp_f32 v84, v84
    v_exp_f32 v85, v85
    v_cvt_pk_bf16_f32 v63, v82, v83
    v_exp_f32 v86, v86
    v_exp_f32 v87, v87
    v_cvt_pk_bf16_f32 v64, v84, v85
    v_mfma_f32_32x32x16_bf16 v[124:139], v[48:51], v[72:75], v[124:139]
    v_exp_f32 v88, v88
    v_exp_f32 v89, v89
    v_cvt_pk_bf16_f32 v65, v86, v87
    v_exp_f32 v90, v90
    v_exp_f32 v91, v91
    v_cvt_pk_bf16_f32 v66, v88, v89
    v_cvt_pk_bf16_f32 v67, v90, v91
    s_setprio 0
    s_waitcnt lgkmcnt(0)
    v_mfma_f32_32x32x16_bf16 v[76:91], v[32:35], v[20:23], 0
    v_exp_f32 v92, v92
    v_exp_f32 v93, v93
    v_exp_f32 v94, v94
    v_exp_f32 v95, v95
    v_cvt_pk_bf16_f32 v68, v92, v93
    v_mfma_f32_32x32x8_bf16 v[76:91], v[40:41], v[28:29], v[76:91]
    v_exp_f32 v96, v96
    v_exp_f32 v97, v97
    v_cvt_pk_bf16_f32 v69, v94, v95
    v_exp_f32 v98, v98
    v_exp_f32 v99, v99
    v_cvt_pk_bf16_f32 v70, v96, v97
    v_mfma_f32_32x32x16_bf16 v[108:123], v[52:55], v[60:63], v[108:123]
    v_exp_f32 v100, v100
    v_exp_f32 v101, v101
    v_cvt_pk_bf16_f32 v71, v98, v99
    v_exp_f32 v102, v102
    v_exp_f32 v103, v103
    v_cvt_pk_bf16_f32 v72, v100, v101
    v_mfma_f32_32x32x16_bf16 v[108:123], v[56:59], v[64:67], v[108:123]
    v_exp_f32 v104, v104
    v_exp_f32 v105, v105
    v_cvt_pk_bf16_f32 v73, v102, v103
    v_exp_f32 v106, v106
    v_exp_f32 v107, v107
    v_cvt_pk_bf16_f32 v74, v104, v105
    v_cvt_pk_bf16_f32 v75, v106, v107
    s_setprio 3
    v_mfma_f32_32x32x16_bf16 v[92:107], v[32:35], v[24:27], 0
    ds_read_b128 v[36:39], v11 offset:21760
    ds_read_b32 v42, v13 offset:21760
    v_exp_f32 v76, v76
    v_exp_f32 v77, v77
    v_exp_f32 v78, v78
    v_exp_f32 v79, v79
    v_cvt_pk_bf16_f32 v60, v76, v77
    v_mfma_f32_32x32x8_bf16 v[92:107], v[40:41], v[30:31], v[92:107]
    v_exp_f32 v80, v80
    v_exp_f32 v81, v81
    v_cvt_pk_bf16_f32 v61, v78, v79
    v_exp_f32 v82, v82
    v_exp_f32 v83, v83
    v_cvt_pk_bf16_f32 v62, v80, v81
    v_mfma_f32_32x32x16_bf16 v[124:139], v[52:55], v[68:71], v[124:139]
    s_mov_b64 exec, s[16:17]
    ds_read_b128 v[44:47], v16 offset:0
    ds_read_b128 v[48:51], v16 offset:640
    s_mov_b64 exec, -1
    v_exp_f32 v84, v84
    v_exp_f32 v85, v85
    v_cvt_pk_bf16_f32 v63, v82, v83
    v_exp_f32 v86, v86
    v_exp_f32 v87, v87
    v_cvt_pk_bf16_f32 v64, v84, v85
    v_mfma_f32_32x32x16_bf16 v[124:139], v[56:59], v[72:75], v[124:139]
    v_exp_f32 v88, v88
    v_exp_f32 v89, v89
    v_cvt_pk_bf16_f32 v65, v86, v87
    v_exp_f32 v90, v90
    v_exp_f32 v91, v91
    v_cvt_pk_bf16_f32 v66, v88, v89
    v_cvt_pk_bf16_f32 v67, v90, v91
    s_setprio 2
    s_waitcnt lgkmcnt(0)
    v_mfma_f32_32x32x16_bf16 v[76:91], v[36:39], v[20:23], 0
    v_exp_f32 v92, v92
    v_exp_f32 v93, v93
    v_exp_f32 v94, v94
    v_exp_f32 v95, v95
    v_cvt_pk_bf16_f32 v68, v92, v93
    v_mfma_f32_32x32x8_bf16 v[76:91], v[42:43], v[28:29], v[76:91]
    v_exp_f32 v96, v96
    v_exp_f32 v97, v97
    v_cvt_pk_bf16_f32 v69, v94, v95
    v_exp_f32 v98, v98
    v_exp_f32 v99, v99
    v_cvt_pk_bf16_f32 v70, v96, v97
    v_mfma_f32_32x32x16_bf16 v[108:123], v[44:47], v[60:63], v[108:123]
    v_exp_f32 v100, v100
    v_exp_f32 v101, v101
    v_cvt_pk_bf16_f32 v71, v98, v99
    v_exp_f32 v102, v102
    v_exp_f32 v103, v103
    v_cvt_pk_bf16_f32 v72, v100, v101
    v_mfma_f32_32x32x16_bf16 v[108:123], v[48:51], v[64:67], v[108:123]
    v_exp_f32 v104, v104
    v_exp_f32 v105, v105
    v_cvt_pk_bf16_f32 v73, v102, v103
    v_exp_f32 v106, v106
    v_exp_f32 v107, v107
    v_cvt_pk_bf16_f32 v74, v104, v105
    v_cvt_pk_bf16_f32 v75, v106, v107
    s_setprio 1
    v_mfma_f32_32x32x16_bf16 v[92:107], v[36:39], v[24:27], 0
    ds_read_b128 v[32:35], v11 offset:23040
    ds_read_b32 v40, v13 offset:23040
    v_exp_f32 v76, v76
    v_exp_f32 v77, v77
    v_exp_f32 v78, v78
    v_exp_f32 v79, v79
    v_cvt_pk_bf16_f32 v60, v76, v77
    v_mfma_f32_32x32x8_bf16 v[92:107], v[42:43], v[30:31], v[92:107]
    v_exp_f32 v80, v80
    v_exp_f32 v81, v81
    v_cvt_pk_bf16_f32 v61, v78, v79
    v_exp_f32 v82, v82
    v_exp_f32 v83, v83
    v_cvt_pk_bf16_f32 v62, v80, v81
    v_mfma_f32_32x32x16_bf16 v[124:139], v[44:47], v[68:71], v[124:139]
    s_mov_b64 exec, s[16:17]
    ds_read_b128 v[52:55], v16 offset:1280
    ds_read_b128 v[56:59], v16 offset:1920
    s_mov_b64 exec, -1
    v_exp_f32 v84, v84
    v_exp_f32 v85, v85
    v_cvt_pk_bf16_f32 v63, v82, v83
    v_exp_f32 v86, v86
    v_exp_f32 v87, v87
    v_cvt_pk_bf16_f32 v64, v84, v85
    v_mfma_f32_32x32x16_bf16 v[124:139], v[48:51], v[72:75], v[124:139]
    v_exp_f32 v88, v88
    v_exp_f32 v89, v89
    v_cvt_pk_bf16_f32 v65, v86, v87
    v_exp_f32 v90, v90
    v_exp_f32 v91, v91
    v_cvt_pk_bf16_f32 v66, v88, v89
    v_cvt_pk_bf16_f32 v67, v90, v91
    s_setprio 0
    s_waitcnt lgkmcnt(0)
    v_mfma_f32_32x32x16_bf16 v[76:91], v[32:35], v[20:23], 0
    v_exp_f32 v92, v92
    v_exp_f32 v93, v93
    v_exp_f32 v94, v94
    v_exp_f32 v95, v95
    v_cvt_pk_bf16_f32 v68, v92, v93
    v_mfma_f32_32x32x8_bf16 v[76:91], v[40:41], v[28:29], v[76:91]
    v_exp_f32 v96, v96
    v_exp_f32 v97, v97
    v_cvt_pk_bf16_f32 v69, v94, v95
    v_exp_f32 v98, v98
    v_exp_f32 v99, v99
    v_cvt_pk_bf16_f32 v70, v96, v97
    v_mfma_f32_32x32x16_bf16 v[108:123], v[52:55], v[60:63], v[108:123]
    v_exp_f32 v100, v100
    v_exp_f32 v101, v101
    v_cvt_pk_bf16_f32 v71, v98, v99
    v_exp_f32 v102, v102
    v_exp_f32 v103, v103
    v_cvt_pk_bf16_f32 v72, v100, v101
    v_mfma_f32_32x32x16_bf16 v[108:123], v[56:59], v[64:67], v[108:123]
    v_exp_f32 v104, v104
    v_exp_f32 v105, v105
    v_cvt_pk_bf16_f32 v73, v102, v103
    v_exp_f32 v106, v106
    v_exp_f32 v107, v107
    v_cvt_pk_bf16_f32 v74, v104, v105
    v_cvt_pk_bf16_f32 v75, v106, v107
    s_setprio 3
    v_mfma_f32_32x32x16_bf16 v[92:107], v[32:35], v[24:27], 0
    ds_read_b128 v[36:39], v11 offset:24320
    ds_read_b32 v42, v13 offset:24320
    v_exp_f32 v76, v76
    v_exp_f32 v77, v77
    v_exp_f32 v78, v78
    v_exp_f32 v79, v79
    v_cvt_pk_bf16_f32 v60, v76, v77
    v_mfma_f32_32x32x8_bf16 v[92:107], v[40:41], v[30:31], v[92:107]
    v_exp_f32 v80, v80
    v_exp_f32 v81, v81
    v_cvt_pk_bf16_f32 v61, v78, v79
    v_exp_f32 v82, v82
    v_exp_f32 v83, v83
    v_cvt_pk_bf16_f32 v62, v80, v81
    v_mfma_f32_32x32x16_bf16 v[124:139], v[52:55], v[68:71], v[124:139]
    s_mov_b64 exec, s[16:17]
    ds_read_b128 v[44:47], v16 offset:2560
    ds_read_b128 v[48:51], v16 offset:3200
    s_mov_b64 exec, -1
    v_exp_f32 v84, v84
    v_exp_f32 v85, v85
    v_cvt_pk_bf16_f32 v63, v82, v83
    v_exp_f32 v86, v86
    v_exp_f32 v87, v87
    v_cvt_pk_bf16_f32 v64, v84, v85
    v_mfma_f32_32x32x16_bf16 v[124:139], v[56:59], v[72:75], v[124:139]
    v_exp_f32 v88, v88
    v_exp_f32 v89, v89
    v_cvt_pk_bf16_f32 v65, v86, v87
    v_exp_f32 v90, v90
    v_exp_f32 v91, v91
    v_cvt_pk_bf16_f32 v66, v88, v89
    v_cvt_pk_bf16_f32 v67, v90, v91
    s_setprio 2
    s_waitcnt lgkmcnt(0)
    v_mfma_f32_32x32x16_bf16 v[76:91], v[36:39], v[20:23], 0
    v_exp_f32 v92, v92
    v_exp_f32 v93, v93
    v_exp_f32 v94, v94
    v_exp_f32 v95, v95
    v_cvt_pk_bf16_f32 v68, v92, v93
    v_mfma_f32_32x32x8_bf16 v[76:91], v[42:43], v[28:29], v[76:91]
    v_exp_f32 v96, v96
    v_exp_f32 v97, v97
    v_cvt_pk_bf16_f32 v69, v94, v95
    v_exp_f32 v98, v98
    v_exp_f32 v99, v99
    v_cvt_pk_bf16_f32 v70, v96, v97
    v_mfma_f32_32x32x16_bf16 v[108:123], v[44:47], v[60:63], v[108:123]
    v_exp_f32 v100, v100
    v_exp_f32 v101, v101
    v_cvt_pk_bf16_f32 v71, v98, v99
    v_exp_f32 v102, v102
    v_exp_f32 v103, v103
    v_cvt_pk_bf16_f32 v72, v100, v101
    v_mfma_f32_32x32x16_bf16 v[108:123], v[48:51], v[64:67], v[108:123]
    v_exp_f32 v104, v104
    v_exp_f32 v105, v105
    v_cvt_pk_bf16_f32 v73, v102, v103
    v_exp_f32 v106, v106
    v_exp_f32 v107, v107
    v_cvt_pk_bf16_f32 v74, v104, v105
    v_cvt_pk_bf16_f32 v75, v106, v107
    s_setprio 1
    v_mfma_f32_32x32x16_bf16 v[92:107], v[36:39], v[24:27], 0
    ds_read_b128 v[32:35], v11 offset:25600
    ds_read_b32 v40, v13 offset:25600
    v_exp_f32 v76, v76
    v_exp_f32 v77, v77
    v_exp_f32 v78, v78
    v_exp_f32 v79, v79
    v_cvt_pk_bf16_f32 v60, v76, v77
    v_mfma_f32_32x32x8_bf16 v[92:107], v[42:43], v[30:31], v[92:107]
    v_exp_f32 v80, v80
    v_exp_f32 v81, v81
    v_cvt_pk_bf16_f32 v61, v78, v79
    v_exp_f32 v82, v82
    v_exp_f32 v83, v83
    v_cvt_pk_bf16_f32 v62, v80, v81
    v_mfma_f32_32x32x16_bf16 v[124:139], v[44:47], v[68:71], v[124:139]
    s_mov_b64 exec, s[16:17]
    ds_read_b128 v[52:55], v16 offset:3840
    ds_read_b128 v[56:59], v16 offset:4480
    s_mov_b64 exec, -1
    v_exp_f32 v84, v84
    v_exp_f32 v85, v85
    v_cvt_pk_bf16_f32 v63, v82, v83
    v_exp_f32 v86, v86
    v_exp_f32 v87, v87
    v_cvt_pk_bf16_f32 v64, v84, v85
    v_mfma_f32_32x32x16_bf16 v[124:139], v[48:51], v[72:75], v[124:139]
    v_exp_f32 v88, v88
    v_exp_f32 v89, v89
    v_cvt_pk_bf16_f32 v65, v86, v87
    v_exp_f32 v90, v90
    v_exp_f32 v91, v91
    v_cvt_pk_bf16_f32 v66, v88, v89
    v_cvt_pk_bf16_f32 v67, v90, v91
    s_setprio 0
    s_waitcnt lgkmcnt(0)
    v_mfma_f32_32x32x16_bf16 v[76:91], v[32:35], v[20:23], 0
    v_exp_f32 v92, v92
    v_exp_f32 v93, v93
    v_exp_f32 v94, v94
    v_exp_f32 v95, v95
    v_cvt_pk_bf16_f32 v68, v92, v93
    v_mfma_f32_32x32x8_bf16 v[76:91], v[40:41], v[28:29], v[76:91]
    v_exp_f32 v96, v96
    v_exp_f32 v97, v97
    v_cvt_pk_bf16_f32 v69, v94, v95
    v_exp_f32 v98, v98
    v_exp_f32 v99, v99
    v_cvt_pk_bf16_f32 v70, v96, v97
    v_mfma_f32_32x32x16_bf16 v[108:123], v[52:55], v[60:63], v[108:123]
    v_exp_f32 v100, v100
    v_exp_f32 v101, v101
    v_cvt_pk_bf16_f32 v71, v98, v99
    v_exp_f32 v102, v102
    v_exp_f32 v103, v103
    v_cvt_pk_bf16_f32 v72, v100, v101
    v_mfma_f32_32x32x16_bf16 v[108:123], v[56:59], v[64:67], v[108:123]
    v_exp_f32 v104, v104
    v_exp_f32 v105, v105
    v_cvt_pk_bf16_f32 v73, v102, v103
    v_exp_f32 v106, v106
    v_exp_f32 v107, v107
    v_cvt_pk_bf16_f32 v74, v104, v105
    v_cvt_pk_bf16_f32 v75, v106, v107
    s_setprio 3
    v_mfma_f32_32x32x16_bf16 v[92:107], v[32:35], v[24:27], 0
    ds_read_b128 v[36:39], v11 offset:26880
    ds_read_b32 v42, v13 offset:26880
    v_exp_f32 v76, v76
    v_exp_f32 v77, v77
    v_exp_f32 v78, v78
    v_exp_f32 v79, v79
    v_cvt_pk_bf16_f32 v60, v76, v77
    v_mfma_f32_32x32x8_bf16 v[92:107], v[40:41], v[30:31], v[92:107]
    v_exp_f32 v80, v80
    v_exp_f32 v81, v81
    v_cvt_pk_bf16_f32 v61, v78, v79
    v_exp_f32 v82, v82
    v_exp_f32 v83, v83
    v_cvt_pk_bf16_f32 v62, v80, v81
    v_mfma_f32_32x32x16_bf16 v[124:139], v[52:55], v[68:71], v[124:139]
    s_mov_b64 exec, s[16:17]
    ds_read_b128 v[44:47], v16 offset:5120
    ds_read_b128 v[48:51], v16 offset:5760
    s_mov_b64 exec, -1
    v_exp_f32 v84, v84
    v_exp_f32 v85, v85
    v_cvt_pk_bf16_f32 v63, v82, v83
    v_exp_f32 v86, v86
    v_exp_f32 v87, v87
    v_cvt_pk_bf16_f32 v64, v84, v85
    v_mfma_f32_32x32x16_bf16 v[124:139], v[56:59], v[72:75], v[124:139]
    v_exp_f32 v88, v88
    v_exp_f32 v89, v89
    v_cvt_pk_bf16_f32 v65, v86, v87
    v_exp_f32 v90, v90
    v_exp_f32 v91, v91
    v_cvt_pk_bf16_f32 v66, v88, v89
    v_cvt_pk_bf16_f32 v67, v90, v91
    s_setprio 2
    s_waitcnt lgkmcnt(0)
    v_mfma_f32_32x32x16_bf16 v[76:91], v[36:39], v[20:23], 0
    v_exp_f32 v92, v92
    v_exp_f32 v93, v93
    v_exp_f32 v94, v94
    v_exp_f32 v95, v95
    v_cvt_pk_bf16_f32 v68, v92, v93
    v_mfma_f32_32x32x8_bf16 v[76:91], v[42:43], v[28:29], v[76:91]
    v_exp_f32 v96, v96
    v_exp_f32 v97, v97
    v_cvt_pk_bf16_f32 v69, v94, v95
    v_exp_f32 v98, v98
    v_exp_f32 v99, v99
    v_cvt_pk_bf16_f32 v70, v96, v97
    v_mfma_f32_32x32x16_bf16 v[108:123], v[44:47], v[60:63], v[108:123]
    v_exp_f32 v100, v100
    v_exp_f32 v101, v101
    v_cvt_pk_bf16_f32 v71, v98, v99
    v_exp_f32 v102, v102
    v_exp_f32 v103, v103
    v_cvt_pk_bf16_f32 v72, v100, v101
    v_mfma_f32_32x32x16_bf16 v[108:123], v[48:51], v[64:67], v[108:123]
    v_exp_f32 v104, v104
    v_exp_f32 v105, v105
    v_cvt_pk_bf16_f32 v73, v102, v103
    v_exp_f32 v106, v106
    v_exp_f32 v107, v107
    v_cvt_pk_bf16_f32 v74, v104, v105
    v_cvt_pk_bf16_f32 v75, v106, v107
    s_setprio 1
    v_mfma_f32_32x32x16_bf16 v[92:107], v[36:39], v[24:27], 0
    ds_read_b128 v[32:35], v11 offset:28160
    ds_read_b32 v40, v13 offset:28160
    v_exp_f32 v76, v76
    v_exp_f32 v77, v77
    v_exp_f32 v78, v78
    v_exp_f32 v79, v79
    v_cvt_pk_bf16_f32 v60, v76, v77
    v_mfma_f32_32x32x8_bf16 v[92:107], v[42:43], v[30:31], v[92:107]
    v_exp_f32 v80, v80
    v_exp_f32 v81, v81
    v_cvt_pk_bf16_f32 v61, v78, v79
    v_exp_f32 v82, v82
    v_exp_f32 v83, v83
    v_cvt_pk_bf16_f32 v62, v80, v81
    v_mfma_f32_32x32x16_bf16 v[124:139], v[44:47], v[68:71], v[124:139]
    s_mov_b64 exec, s[16:17]
    ds_read_b128 v[52:55], v16 offset:6400
    ds_read_b128 v[56:59], v16 offset:7040
    s_mov_b64 exec, -1
    v_exp_f32 v84, v84
    v_exp_f32 v85, v85
    v_cvt_pk_bf16_f32 v63, v82, v83
    v_exp_f32 v86, v86
    v_exp_f32 v87, v87
    v_cvt_pk_bf16_f32 v64, v84, v85
    v_mfma_f32_32x32x16_bf16 v[124:139], v[48:51], v[72:75], v[124:139]
    v_exp_f32 v88, v88
    v_exp_f32 v89, v89
    v_cvt_pk_bf16_f32 v65, v86, v87
    v_exp_f32 v90, v90
    v_exp_f32 v91, v91
    v_cvt_pk_bf16_f32 v66, v88, v89
    v_cvt_pk_bf16_f32 v67, v90, v91
    s_setprio 0
    s_waitcnt lgkmcnt(0)
    v_mfma_f32_32x32x16_bf16 v[76:91], v[32:35], v[20:23], 0
    v_exp_f32 v92, v92
    v_exp_f32 v93, v93
    v_exp_f32 v94, v94
    v_exp_f32 v95, v95
    v_cvt_pk_bf16_f32 v68, v92, v93
    v_mfma_f32_32x32x8_bf16 v[76:91], v[40:41], v[28:29], v[76:91]
    v_exp_f32 v96, v96
    v_exp_f32 v97, v97
    v_cvt_pk_bf16_f32 v69, v94, v95
    v_exp_f32 v98, v98
    v_exp_f32 v99, v99
    v_cvt_pk_bf16_f32 v70, v96, v97
    v_mfma_f32_32x32x16_bf16 v[108:123], v[52:55], v[60:63], v[108:123]
    v_exp_f32 v100, v100
    v_exp_f32 v101, v101
    v_cvt_pk_bf16_f32 v71, v98, v99
    v_exp_f32 v102, v102
    v_exp_f32 v103, v103
    v_cvt_pk_bf16_f32 v72, v100, v101
    v_mfma_f32_32x32x16_bf16 v[108:123], v[56:59], v[64:67], v[108:123]
    v_exp_f32 v104, v104
    v_exp_f32 v105, v105
    v_cvt_pk_bf16_f32 v73, v102, v103
    v_exp_f32 v106, v106
    v_exp_f32 v107, v107
    v_cvt_pk_bf16_f32 v74, v104, v105
    v_cvt_pk_bf16_f32 v75, v106, v107
    s_setprio 3
    v_mfma_f32_32x32x16_bf16 v[92:107], v[32:35], v[24:27], 0
    ds_read_b128 v[36:39], v11 offset:29440
    ds_read_b32 v42, v13 offset:29440
    v_exp_f32 v76, v76
    v_exp_f32 v77, v77
    v_exp_f32 v78, v78
    v_exp_f32 v79, v79
    v_cvt_pk_bf16_f32 v60, v76, v77
    v_mfma_f32_32x32x8_bf16 v[92:107], v[40:41], v[30:31], v[92:107]
    v_exp_f32 v80, v80
    v_exp_f32 v81, v81
    v_cvt_pk_bf16_f32 v61, v78, v79
    v_exp_f32 v82, v82
    v_exp_f32 v83, v83
    v_cvt_pk_bf16_f32 v62, v80, v81
    v_mfma_f32_32x32x16_bf16 v[124:139], v[52:55], v[68:71], v[124:139]
    s_mov_b64 exec, s[16:17]
    ds_read_b128 v[44:47], v16 offset:7680
    ds_read_b128 v[48:51], v16 offset:8320
    s_mov_b64 exec, -1
    v_exp_f32 v84, v84
    v_exp_f32 v85, v85
    v_cvt_pk_bf16_f32 v63, v82, v83
    v_exp_f32 v86, v86
    v_exp_f32 v87, v87
    v_cvt_pk_bf16_f32 v64, v84, v85
    v_mfma_f32_32x32x16_bf16 v[124:139], v[56:59], v[72:75], v[124:139]
    v_exp_f32 v88, v88
    v_exp_f32 v89, v89
    v_cvt_pk_bf16_f32 v65, v86, v87
    v_exp_f32 v90, v90
    v_exp_f32 v91, v91
    v_cvt_pk_bf16_f32 v66, v88, v89
    v_cvt_pk_bf16_f32 v67, v90, v91
    s_setprio 2
    s_waitcnt lgkmcnt(0)
    v_mfma_f32_32x32x16_bf16 v[76:91], v[36:39], v[20:23], 0
    v_exp_f32 v92, v92
    v_exp_f32 v93, v93
    v_exp_f32 v94, v94
    v_exp_f32 v95, v95
    v_cvt_pk_bf16_f32 v68, v92, v93
    v_mfma_f32_32x32x8_bf16 v[76:91], v[42:43], v[28:29], v[76:91]
    v_exp_f32 v96, v96
    v_exp_f32 v97, v97
    v_cvt_pk_bf16_f32 v69, v94, v95
    v_exp_f32 v98, v98
    v_exp_f32 v99, v99
    v_cvt_pk_bf16_f32 v70, v96, v97
    v_mfma_f32_32x32x16_bf16 v[108:123], v[44:47], v[60:63], v[108:123]
    v_exp_f32 v100, v100
    v_exp_f32 v101, v101
    v_cvt_pk_bf16_f32 v71, v98, v99
    v_exp_f32 v102, v102
    v_exp_f32 v103, v103
    v_cvt_pk_bf16_f32 v72, v100, v101
    v_mfma_f32_32x32x16_bf16 v[108:123], v[48:51], v[64:67], v[108:123]
    v_exp_f32 v104, v104
    v_exp_f32 v105, v105
    v_cvt_pk_bf16_f32 v73, v102, v103
    v_exp_f32 v106, v106
    v_exp_f32 v107, v107
    v_cvt_pk_bf16_f32 v74, v104, v105
    v_cvt_pk_bf16_f32 v75, v106, v107
    s_barrier
    s_setprio 1
    v_mfma_f32_32x32x16_bf16 v[92:107], v[36:39], v[24:27], 0
    ds_read_b128 v[32:35], v12 offset:0
    ds_read_b32 v40, v14 offset:0
    v_exp_f32 v76, v76
    v_exp_f32 v77, v77
    v_exp_f32 v78, v78
    v_exp_f32 v79, v79
    v_cvt_pk_bf16_f32 v60, v76, v77
    v_mfma_f32_32x32x8_bf16 v[92:107], v[42:43], v[30:31], v[92:107]
    v_exp_f32 v80, v80
    v_exp_f32 v81, v81
    v_cvt_pk_bf16_f32 v61, v78, v79
    v_exp_f32 v82, v82
    v_exp_f32 v83, v83
    v_cvt_pk_bf16_f32 v62, v80, v81
    v_mfma_f32_32x32x16_bf16 v[124:139], v[44:47], v[68:71], v[124:139]
    s_mov_b64 exec, s[16:17]
    ds_read_b128 v[52:55], v16 offset:8960
    ds_read_b128 v[56:59], v16 offset:9600
    s_mov_b64 exec, -1
    v_exp_f32 v84, v84
    v_exp_f32 v85, v85
    v_cvt_pk_bf16_f32 v63, v82, v83
    v_exp_f32 v86, v86
    v_exp_f32 v87, v87
    v_cvt_pk_bf16_f32 v64, v84, v85
    v_mfma_f32_32x32x16_bf16 v[124:139], v[48:51], v[72:75], v[124:139]
    v_exp_f32 v88, v88
    v_exp_f32 v89, v89
    v_cvt_pk_bf16_f32 v65, v86, v87
    v_exp_f32 v90, v90
    v_exp_f32 v91, v91
    v_cvt_pk_bf16_f32 v66, v88, v89
    v_cvt_pk_bf16_f32 v67, v90, v91
    s_setprio 0
    s_waitcnt lgkmcnt(0)
    v_mfma_f32_32x32x16_bf16 v[76:91], v[32:35], v[20:23], 0
    v_exp_f32 v92, v92
    v_exp_f32 v93, v93
    v_exp_f32 v94, v94
    v_exp_f32 v95, v95
    v_cvt_pk_bf16_f32 v68, v92, v93
    v_mfma_f32_32x32x8_bf16 v[76:91], v[40:41], v[28:29], v[76:91]
    v_exp_f32 v96, v96
    v_exp_f32 v97, v97
    v_cvt_pk_bf16_f32 v69, v94, v95
    v_exp_f32 v98, v98
    v_exp_f32 v99, v99
    v_cvt_pk_bf16_f32 v70, v96, v97
    v_mfma_f32_32x32x16_bf16 v[108:123], v[52:55], v[60:63], v[108:123]
    v_exp_f32 v100, v100
    v_exp_f32 v101, v101
    v_cvt_pk_bf16_f32 v71, v98, v99
    v_exp_f32 v102, v102
    v_exp_f32 v103, v103
    v_cvt_pk_bf16_f32 v72, v100, v101
    v_mfma_f32_32x32x16_bf16 v[108:123], v[56:59], v[64:67], v[108:123]
    v_exp_f32 v104, v104
    v_exp_f32 v105, v105
    v_cvt_pk_bf16_f32 v73, v102, v103
    v_exp_f32 v106, v106
    v_exp_f32 v107, v107
    v_cvt_pk_bf16_f32 v74, v104, v105
    v_cvt_pk_bf16_f32 v75, v106, v107
    s_lshl_b32 s41, s5, 2
    s_add_u32 s41, s41, s8
    s_lshl_b32 s41, s41, 1
    s_add_u32 s42, s41, s9
    s_lshl_b32 s14, s42, 5
    s_add_u32 s14, s14, s4
    s_mul_i32 s14, s14, 1280
    s_add_u32 s14, s14, 17981440
    s_and_b32 s52, s42, 7
    s_mul_i32 s52, s52, 3072
    s_add_u32 s52, s52, 61440
    s_lshl_b32 s51, s42, 9
    s_lshr_b32 s41, s4, 3
    s_lshl_b32 s41, s41, 7
    s_add_u32 s51, s51, s41
    s_and_b32 s41, s4, 7
    s_lshl_b32 s41, s41, 2
    s_add_u32 s51, s51, s41
    s_add_u32 s51, s51, 23236608
    s_lshl_b32 s42, s42, 7
    s_add_u32 s42, s42, 17973248
    v_and_b32 v2, 31, v1
    v_lshlrev_b32 v2, 2, v2
    buffer_load_dword v18, v2, s[32:35], s42 offen
    s_lshl_b32 s10, s36, 3
    s_lshr_b32 s41, s37, 2
    s_add_u32 s10, s10, s41
    s_and_b32 s11, s37, 3
    s_mul_i32 s50, s11, 204800
    s_add_u32 s50, s50, 17154048
    s_lshl_b32 s42, s8, 13
    s_add_u32 s42, s42, 163840
    s_add_u32 s50, s50, s42
    s_setprio 3
    v_mfma_f32_32x32x16_bf16 v[92:107], v[32:35], v[24:27], 0
    ds_read_b128 v[36:39], v12 offset:1280
    ds_read_b32 v42, v14 offset:1280
    v_exp_f32 v76, v76
    v_exp_f32 v77, v77
    v_exp_f32 v78, v78
    v_exp_f32 v79, v79
    v_cvt_pk_bf16_f32 v60, v76, v77
    v_mfma_f32_32x32x8_bf16 v[92:107], v[40:41], v[30:31], v[92:107]
    v_exp_f32 v80, v80
    v_exp_f32 v81, v81
    v_cvt_pk_bf16_f32 v61, v78, v79
    v_exp_f32 v82, v82
    v_exp_f32 v83, v83
    v_cvt_pk_bf16_f32 v62, v80, v81
    v_mfma_f32_32x32x16_bf16 v[124:139], v[52:55], v[68:71], v[124:139]
    s_mov_b64 exec, s[16:17]
    ds_read_b128 v[44:47], v17 offset:0
    ds_read_b128 v[48:51], v17 offset:640
    s_mov_b64 exec, -1
    v_exp_f32 v84, v84
    v_exp_f32 v85, v85
    v_cvt_pk_bf16_f32 v63, v82, v83
    v_exp_f32 v86, v86
    v_exp_f32 v87, v87
    v_cvt_pk_bf16_f32 v64, v84, v85
    v_mfma_f32_32x32x16_bf16 v[124:139], v[56:59], v[72:75], v[124:139]
    v_exp_f32 v88, v88
    v_exp_f32 v89, v89
    v_cvt_pk_bf16_f32 v65, v86, v87
    v_exp_f32 v90, v90
    v_exp_f32 v91, v91
    v_cvt_pk_bf16_f32 v66, v88, v89
    v_cvt_pk_bf16_f32 v67, v90, v91
    s_setprio 2
    s_waitcnt lgkmcnt(0)
    v_mfma_f32_32x32x16_bf16 v[76:91], v[36:39], v[20:23], 0
    v_exp_f32 v92, v92
    v_exp_f32 v93, v93
    v_exp_f32 v94, v94
    v_exp_f32 v95, v95
    v_cvt_pk_bf16_f32 v68, v92, v93
    v_mfma_f32_32x32x8_bf16 v[76:91], v[42:43], v[28:29], v[76:91]
    v_exp_f32 v96, v96
    v_exp_f32 v97, v97
    v_cvt_pk_bf16_f32 v69, v94, v95
    v_exp_f32 v98, v98
    v_exp_f32 v99, v99
    v_cvt_pk_bf16_f32 v70, v96, v97
    v_mfma_f32_32x32x16_bf16 v[108:123], v[44:47], v[60:63], v[108:123]
    v_exp_f32 v100, v100
    v_exp_f32 v101, v101
    v_cvt_pk_bf16_f32 v71, v98, v99
    v_exp_f32 v102, v102
    v_exp_f32 v103, v103
    v_cvt_pk_bf16_f32 v72, v100, v101
    v_mfma_f32_32x32x16_bf16 v[108:123], v[48:51], v[64:67], v[108:123]
    v_exp_f32 v104, v104
    v_exp_f32 v105, v105
    v_cvt_pk_bf16_f32 v73, v102, v103
    v_exp_f32 v106, v106
    v_exp_f32 v107, v107
    v_cvt_pk_bf16_f32 v74, v104, v105
    v_cvt_pk_bf16_f32 v75, v106, v107
    s_setprio 1
    v_mfma_f32_32x32x16_bf16 v[92:107], v[36:39], v[24:27], 0
    ds_read_b128 v[32:35], v12 offset:2560
    ds_read_b32 v40, v14 offset:2560
    v_exp_f32 v76, v76
    v_exp_f32 v77, v77
    v_exp_f32 v78, v78
    v_exp_f32 v79, v79
    v_cvt_pk_bf16_f32 v60, v76, v77
    v_mfma_f32_32x32x8_bf16 v[92:107], v[42:43], v[30:31], v[92:107]
    v_exp_f32 v80, v80
    v_exp_f32 v81, v81
    v_cvt_pk_bf16_f32 v61, v78, v79
    v_exp_f32 v82, v82
    v_exp_f32 v83, v83
    v_cvt_pk_bf16_f32 v62, v80, v81
    v_mfma_f32_32x32x16_bf16 v[124:139], v[44:47], v[68:71], v[124:139]
    s_mov_b64 exec, s[16:17]
    ds_read_b128 v[52:55], v17 offset:1280
    ds_read_b128 v[56:59], v17 offset:1920
    s_mov_b64 exec, -1
    v_exp_f32 v84, v84
    v_exp_f32 v85, v85
    v_cvt_pk_bf16_f32 v63, v82, v83
    v_exp_f32 v86, v86
    v_exp_f32 v87, v87
    v_cvt_pk_bf16_f32 v64, v84, v85
    v_mfma_f32_32x32x16_bf16 v[124:139], v[48:51], v[72:75], v[124:139]
    v_exp_f32 v88, v88
    v_exp_f32 v89, v89
    v_cvt_pk_bf16_f32 v65, v86, v87
    v_exp_f32 v90, v90
    v_exp_f32 v91, v91
    v_cvt_pk_bf16_f32 v66, v88, v89
    v_cvt_pk_bf16_f32 v67, v90, v91
    s_setprio 0
    s_waitcnt lgkmcnt(0)
    v_mfma_f32_32x32x16_bf16 v[76:91], v[32:35], v[20:23], 0
    v_exp_f32 v92, v92
    v_exp_f32 v93, v93
    v_exp_f32 v94, v94
    v_exp_f32 v95, v95
    v_cvt_pk_bf16_f32 v68, v92, v93
    v_mfma_f32_32x32x8_bf16 v[76:91], v[40:41], v[28:29], v[76:91]
    v_exp_f32 v96, v96
    v_exp_f32 v97, v97
    v_cvt_pk_bf16_f32 v69, v94, v95
    v_exp_f32 v98, v98
    v_exp_f32 v99, v99
    v_cvt_pk_bf16_f32 v70, v96, v97
    v_mfma_f32_32x32x16_bf16 v[108:123], v[52:55], v[60:63], v[108:123]
    v_exp_f32 v100, v100
    v_exp_f32 v101, v101
    v_cvt_pk_bf16_f32 v71, v98, v99
    v_exp_f32 v102, v102
    v_exp_f32 v103, v103
    v_cvt_pk_bf16_f32 v72, v100, v101
    v_mfma_f32_32x32x16_bf16 v[108:123], v[56:59], v[64:67], v[108:123]
    v_exp_f32 v104, v104
    v_exp_f32 v105, v105
    v_cvt_pk_bf16_f32 v73, v102, v103
    v_exp_f32 v106, v106
    v_exp_f32 v107, v107
    v_cvt_pk_bf16_f32 v74, v104, v105
    v_cvt_pk_bf16_f32 v75, v106, v107
    s_setprio 3
    v_mfma_f32_32x32x16_bf16 v[92:107], v[32:35], v[24:27], 0
    ds_read_b128 v[36:39], v12 offset:3840
    ds_read_b32 v42, v14 offset:3840
    v_exp_f32 v76, v76
    v_exp_f32 v77, v77
    v_exp_f32 v78, v78
    v_exp_f32 v79, v79
    v_cvt_pk_bf16_f32 v60, v76, v77
    v_mfma_f32_32x32x8_bf16 v[92:107], v[40:41], v[30:31], v[92:107]
    v_exp_f32 v80, v80
    v_exp_f32 v81, v81
    v_cvt_pk_bf16_f32 v61, v78, v79
    v_exp_f32 v82, v82
    v_exp_f32 v83, v83
    v_cvt_pk_bf16_f32 v62, v80, v81
    v_mfma_f32_32x32x16_bf16 v[124:139], v[52:55], v[68:71], v[124:139]
    s_mov_b64 exec, s[16:17]
    ds_read_b128 v[44:47], v17 offset:2560
    ds_read_b128 v[48:51], v17 offset:3200
    s_mov_b64 exec, -1
    v_exp_f32 v84, v84
    v_exp_f32 v85, v85
    v_cvt_pk_bf16_f32 v63, v82, v83
    v_exp_f32 v86, v86
    v_exp_f32 v87, v87
    v_cvt_pk_bf16_f32 v64, v84, v85
    v_mfma_f32_32x32x16_bf16 v[124:139], v[56:59], v[72:75], v[124:139]
    v_exp_f32 v88, v88
    v_exp_f32 v89, v89
    v_cvt_pk_bf16_f32 v65, v86, v87
    v_exp_f32 v90, v90
    v_exp_f32 v91, v91
    v_cvt_pk_bf16_f32 v66, v88, v89
    v_cvt_pk_bf16_f32 v67, v90, v91
    s_setprio 2
    s_waitcnt lgkmcnt(0)
    v_mfma_f32_32x32x16_bf16 v[76:91], v[36:39], v[20:23], 0
    v_exp_f32 v92, v92
    v_exp_f32 v93, v93
    v_exp_f32 v94, v94
    v_exp_f32 v95, v95
    v_cvt_pk_bf16_f32 v68, v92, v93
    v_mfma_f32_32x32x8_bf16 v[76:91], v[42:43], v[28:29], v[76:91]
    v_exp_f32 v96, v96
    v_exp_f32 v97, v97
    v_cvt_pk_bf16_f32 v69, v94, v95
    v_exp_f32 v98, v98
    v_exp_f32 v99, v99
    v_cvt_pk_bf16_f32 v70, v96, v97
    v_mfma_f32_32x32x16_bf16 v[108:123], v[44:47], v[60:63], v[108:123]
    v_exp_f32 v100, v100
    v_exp_f32 v101, v101
    v_cvt_pk_bf16_f32 v71, v98, v99
    v_exp_f32 v102, v102
    v_exp_f32 v103, v103
    v_cvt_pk_bf16_f32 v72, v100, v101
    v_mfma_f32_32x32x16_bf16 v[108:123], v[48:51], v[64:67], v[108:123]
    v_exp_f32 v104, v104
    v_exp_f32 v105, v105
    v_cvt_pk_bf16_f32 v73, v102, v103
    v_exp_f32 v106, v106
    v_exp_f32 v107, v107
    v_cvt_pk_bf16_f32 v74, v104, v105
    v_cvt_pk_bf16_f32 v75, v106, v107
    s_setprio 1
    v_mfma_f32_32x32x16_bf16 v[92:107], v[36:39], v[24:27], 0
    ds_read_b128 v[32:35], v12 offset:5120
    ds_read_b32 v40, v14 offset:5120
    v_exp_f32 v76, v76
    v_exp_f32 v77, v77
    v_exp_f32 v78, v78
    v_exp_f32 v79, v79
    v_cvt_pk_bf16_f32 v60, v76, v77
    v_mfma_f32_32x32x8_bf16 v[92:107], v[42:43], v[30:31], v[92:107]
    v_exp_f32 v80, v80
    v_exp_f32 v81, v81
    v_cvt_pk_bf16_f32 v61, v78, v79
    v_exp_f32 v82, v82
    v_exp_f32 v83, v83
    v_cvt_pk_bf16_f32 v62, v80, v81
    v_mfma_f32_32x32x16_bf16 v[124:139], v[44:47], v[68:71], v[124:139]
    s_mov_b64 exec, s[16:17]
    ds_read_b128 v[52:55], v17 offset:3840
    ds_read_b128 v[56:59], v17 offset:4480
    s_mov_b64 exec, -1
    v_exp_f32 v84, v84
    v_exp_f32 v85, v85
    v_cvt_pk_bf16_f32 v63, v82, v83
    v_exp_f32 v86, v86
    v_exp_f32 v87, v87
    v_cvt_pk_bf16_f32 v64, v84, v85
    v_mfma_f32_32x32x16_bf16 v[124:139], v[48:51], v[72:75], v[124:139]
    v_exp_f32 v88, v88
    v_exp_f32 v89, v89
    v_cvt_pk_bf16_f32 v65, v86, v87
    v_exp_f32 v90, v90
    v_exp_f32 v91, v91
    v_cvt_pk_bf16_f32 v66, v88, v89
    v_cvt_pk_bf16_f32 v67, v90, v91
    s_setprio 0
    s_waitcnt lgkmcnt(0)
    v_mfma_f32_32x32x16_bf16 v[76:91], v[32:35], v[20:23], 0
    v_exp_f32 v92, v92
    v_exp_f32 v93, v93
    v_exp_f32 v94, v94
    v_exp_f32 v95, v95
    v_cvt_pk_bf16_f32 v68, v92, v93
    v_mfma_f32_32x32x8_bf16 v[76:91], v[40:41], v[28:29], v[76:91]
    v_exp_f32 v96, v96
    v_exp_f32 v97, v97
    v_cvt_pk_bf16_f32 v69, v94, v95
    v_exp_f32 v98, v98
    v_exp_f32 v99, v99
    v_cvt_pk_bf16_f32 v70, v96, v97
    v_mfma_f32_32x32x16_bf16 v[108:123], v[52:55], v[60:63], v[108:123]
    v_exp_f32 v100, v100
    v_exp_f32 v101, v101
    v_cvt_pk_bf16_f32 v71, v98, v99
    v_exp_f32 v102, v102
    v_exp_f32 v103, v103
    v_cvt_pk_bf16_f32 v72, v100, v101
    v_mfma_f32_32x32x16_bf16 v[108:123], v[56:59], v[64:67], v[108:123]
    v_exp_f32 v104, v104
    v_exp_f32 v105, v105
    v_cvt_pk_bf16_f32 v73, v102, v103
    v_exp_f32 v106, v106
    v_exp_f32 v107, v107
    v_cvt_pk_bf16_f32 v74, v104, v105
    v_cvt_pk_bf16_f32 v75, v106, v107
    s_setprio 3
    v_mfma_f32_32x32x16_bf16 v[92:107], v[32:35], v[24:27], 0
    ds_read_b128 v[36:39], v12 offset:6400
    ds_read_b32 v42, v14 offset:6400
    v_exp_f32 v76, v76
    v_exp_f32 v77, v77
    v_exp_f32 v78, v78
    v_exp_f32 v79, v79
    v_cvt_pk_bf16_f32 v60, v76, v77
    v_mfma_f32_32x32x8_bf16 v[92:107], v[40:41], v[30:31], v[92:107]
    v_exp_f32 v80, v80
    v_exp_f32 v81, v81
    v_cvt_pk_bf16_f32 v61, v78, v79
    v_exp_f32 v82, v82
    v_exp_f32 v83, v83
    v_cvt_pk_bf16_f32 v62, v80, v81
    v_mfma_f32_32x32x16_bf16 v[124:139], v[52:55], v[68:71], v[124:139]
    s_mov_b64 exec, s[16:17]
    ds_read_b128 v[44:47], v17 offset:5120
    ds_read_b128 v[48:51], v17 offset:5760
    s_mov_b64 exec, -1
    v_exp_f32 v84, v84
    v_exp_f32 v85, v85
    v_cvt_pk_bf16_f32 v63, v82, v83
    v_exp_f32 v86, v86
    v_exp_f32 v87, v87
    v_cvt_pk_bf16_f32 v64, v84, v85
    v_mfma_f32_32x32x16_bf16 v[124:139], v[56:59], v[72:75], v[124:139]
    v_exp_f32 v88, v88
    v_exp_f32 v89, v89
    v_cvt_pk_bf16_f32 v65, v86, v87
    v_exp_f32 v90, v90
    v_exp_f32 v91, v91
    v_cvt_pk_bf16_f32 v66, v88, v89
    v_cvt_pk_bf16_f32 v67, v90, v91
    s_setprio 2
    s_waitcnt lgkmcnt(0)
    v_mfma_f32_32x32x16_bf16 v[76:91], v[36:39], v[20:23], 0
    v_exp_f32 v92, v92
    v_exp_f32 v93, v93
    v_exp_f32 v94, v94
    v_exp_f32 v95, v95
    v_cvt_pk_bf16_f32 v68, v92, v93
    v_mfma_f32_32x32x8_bf16 v[76:91], v[42:43], v[28:29], v[76:91]
    v_exp_f32 v96, v96
    v_exp_f32 v97, v97
    v_cvt_pk_bf16_f32 v69, v94, v95
    v_exp_f32 v98, v98
    v_exp_f32 v99, v99
    v_cvt_pk_bf16_f32 v70, v96, v97
    v_mfma_f32_32x32x16_bf16 v[108:123], v[44:47], v[60:63], v[108:123]
    v_exp_f32 v100, v100
    v_exp_f32 v101, v101
    v_cvt_pk_bf16_f32 v71, v98, v99
    v_exp_f32 v102, v102
    v_exp_f32 v103, v103
    v_cvt_pk_bf16_f32 v72, v100, v101
    v_mfma_f32_32x32x16_bf16 v[108:123], v[48:51], v[64:67], v[108:123]
    v_exp_f32 v104, v104
    v_exp_f32 v105, v105
    v_cvt_pk_bf16_f32 v73, v102, v103
    v_exp_f32 v106, v106
    v_exp_f32 v107, v107
    v_cvt_pk_bf16_f32 v74, v104, v105
    v_cvt_pk_bf16_f32 v75, v106, v107
    s_setprio 1
    v_mfma_f32_32x32x16_bf16 v[92:107], v[36:39], v[24:27], 0
    ds_read_b128 v[32:35], v12 offset:7680
    ds_read_b32 v40, v14 offset:7680
    v_exp_f32 v76, v76
    v_exp_f32 v77, v77
    v_exp_f32 v78, v78
    v_exp_f32 v79, v79
    v_cvt_pk_bf16_f32 v60, v76, v77
    v_mfma_f32_32x32x8_bf16 v[92:107], v[42:43], v[30:31], v[92:107]
    v_exp_f32 v80, v80
    v_exp_f32 v81, v81
    v_cvt_pk_bf16_f32 v61, v78, v79
    v_exp_f32 v82, v82
    v_exp_f32 v83, v83
    v_cvt_pk_bf16_f32 v62, v80, v81
    v_mfma_f32_32x32x16_bf16 v[124:139], v[44:47], v[68:71], v[124:139]
    s_mov_b64 exec, s[16:17]
    ds_read_b128 v[52:55], v17 offset:6400
    ds_read_b128 v[56:59], v17 offset:7040
    s_mov_b64 exec, -1
    v_exp_f32 v84, v84
    v_exp_f32 v85, v85
    v_cvt_pk_bf16_f32 v63, v82, v83
    v_exp_f32 v86, v86
    v_exp_f32 v87, v87
    v_cvt_pk_bf16_f32 v64, v84, v85
    v_mfma_f32_32x32x16_bf16 v[124:139], v[48:51], v[72:75], v[124:139]
    v_exp_f32 v88, v88
    v_exp_f32 v89, v89
    v_cvt_pk_bf16_f32 v65, v86, v87
    v_exp_f32 v90, v90
    v_exp_f32 v91, v91
    v_cvt_pk_bf16_f32 v66, v88, v89
    v_cvt_pk_bf16_f32 v67, v90, v91
    s_setprio 0
    s_waitcnt lgkmcnt(0)
    v_mfma_f32_32x32x16_bf16 v[76:91], v[32:35], v[20:23], 0
    v_exp_f32 v92, v92
    v_exp_f32 v93, v93
    v_exp_f32 v94, v94
    v_exp_f32 v95, v95
    v_cvt_pk_bf16_f32 v68, v92, v93
    v_mfma_f32_32x32x8_bf16 v[76:91], v[40:41], v[28:29], v[76:91]
    v_exp_f32 v96, v96
    v_exp_f32 v97, v97
    v_cvt_pk_bf16_f32 v69, v94, v95
    v_exp_f32 v98, v98
    v_exp_f32 v99, v99
    v_cvt_pk_bf16_f32 v70, v96, v97
    v_mfma_f32_32x32x16_bf16 v[108:123], v[52:55], v[60:63], v[108:123]
    v_exp_f32 v100, v100
    v_exp_f32 v101, v101
    v_cvt_pk_bf16_f32 v71, v98, v99
    v_exp_f32 v102, v102
    v_exp_f32 v103, v103
    v_cvt_pk_bf16_f32 v72, v100, v101
    v_mfma_f32_32x32x16_bf16 v[108:123], v[56:59], v[64:67], v[108:123]
    v_exp_f32 v104, v104
    v_exp_f32 v105, v105
    v_cvt_pk_bf16_f32 v73, v102, v103
    v_exp_f32 v106, v106
    v_exp_f32 v107, v107
    v_cvt_pk_bf16_f32 v74, v104, v105
    v_cvt_pk_bf16_f32 v75, v106, v107
    s_setprio 3
    v_mfma_f32_32x32x16_bf16 v[92:107], v[32:35], v[24:27], 0
    ds_read_b128 v[36:39], v12 offset:8960
    ds_read_b32 v42, v14 offset:8960
    v_exp_f32 v76, v76
    v_exp_f32 v77, v77
    v_exp_f32 v78, v78
    v_exp_f32 v79, v79
    v_cvt_pk_bf16_f32 v60, v76, v77
    v_mfma_f32_32x32x8_bf16 v[92:107], v[40:41], v[30:31], v[92:107]
    v_exp_f32 v80, v80
    v_exp_f32 v81, v81
    v_cvt_pk_bf16_f32 v61, v78, v79
    v_exp_f32 v82, v82
    v_exp_f32 v83, v83
    v_cvt_pk_bf16_f32 v62, v80, v81
    v_mfma_f32_32x32x16_bf16 v[124:139], v[52:55], v[68:71], v[124:139]
    s_mov_b64 exec, s[16:17]
    ds_read_b128 v[44:47], v17 offset:7680
    ds_read_b128 v[48:51], v17 offset:8320
    s_mov_b64 exec, -1
    v_exp_f32 v84, v84
    v_exp_f32 v85, v85
    v_cvt_pk_bf16_f32 v63, v82, v83
    v_exp_f32 v86, v86
    v_exp_f32 v87, v87
    v_cvt_pk_bf16_f32 v64, v84, v85
    v_mfma_f32_32x32x16_bf16 v[124:139], v[56:59], v[72:75], v[124:139]
    v_exp_f32 v88, v88
    v_exp_f32 v89, v89
    v_cvt_pk_bf16_f32 v65, v86, v87
    v_exp_f32 v90, v90
    v_exp_f32 v91, v91
    v_cvt_pk_bf16_f32 v66, v88, v89
    v_cvt_pk_bf16_f32 v67, v90, v91
    s_setprio 2
    s_waitcnt lgkmcnt(0)
    v_mfma_f32_32x32x16_bf16 v[76:91], v[36:39], v[20:23], 0
    v_exp_f32 v92, v92
    v_exp_f32 v93, v93
    v_exp_f32 v94, v94
    v_exp_f32 v95, v95
    v_cvt_pk_bf16_f32 v68, v92, v93
    v_mfma_f32_32x32x8_bf16 v[76:91], v[42:43], v[28:29], v[76:91]
    v_exp_f32 v96, v96
    v_exp_f32 v97, v97
    v_cvt_pk_bf16_f32 v69, v94, v95
    v_exp_f32 v98, v98
    v_exp_f32 v99, v99
    v_cvt_pk_bf16_f32 v70, v96, v97
    v_mfma_f32_32x32x16_bf16 v[108:123], v[44:47], v[60:63], v[108:123]
    v_exp_f32 v100, v100
    v_exp_f32 v101, v101
    v_cvt_pk_bf16_f32 v71, v98, v99
    v_exp_f32 v102, v102
    v_exp_f32 v103, v103
    v_cvt_pk_bf16_f32 v72, v100, v101
    v_mfma_f32_32x32x16_bf16 v[108:123], v[48:51], v[64:67], v[108:123]
    v_exp_f32 v104, v104
    v_exp_f32 v105, v105
    v_cvt_pk_bf16_f32 v73, v102, v103
    v_exp_f32 v106, v106
    v_exp_f32 v107, v107
    v_cvt_pk_bf16_f32 v74, v104, v105
    v_cvt_pk_bf16_f32 v75, v106, v107
    s_barrier
    s_setprio 1
    v_mfma_f32_32x32x16_bf16 v[92:107], v[36:39], v[24:27], 0
    ds_read_b128 v[32:35], v11 offset:0
    ds_read_b32 v40, v13 offset:0
    v_exp_f32 v76, v76
    v_exp_f32 v77, v77
    v_exp_f32 v78, v78
    v_exp_f32 v79, v79
    v_cvt_pk_bf16_f32 v60, v76, v77
    v_mfma_f32_32x32x8_bf16 v[92:107], v[42:43], v[30:31], v[92:107]
    v_exp_f32 v80, v80
    v_exp_f32 v81, v81
    v_cvt_pk_bf16_f32 v61, v78, v79
    v_exp_f32 v82, v82
    v_exp_f32 v83, v83
    v_cvt_pk_bf16_f32 v62, v80, v81
    v_mfma_f32_32x32x16_bf16 v[124:139], v[44:47], v[68:71], v[124:139]
    s_mov_b64 exec, s[16:17]
    ds_read_b128 v[52:55], v17 offset:8960
    ds_read_b128 v[56:59], v17 offset:9600
    s_mov_b64 exec, -1
    v_exp_f32 v84, v84
    v_exp_f32 v85, v85
    v_cvt_pk_bf16_f32 v63, v82, v83
    v_exp_f32 v86, v86
    v_exp_f32 v87, v87
    v_cvt_pk_bf16_f32 v64, v84, v85
    v_mfma_f32_32x32x16_bf16 v[124:139], v[48:51], v[72:75], v[124:139]
    v_exp_f32 v88, v88
    v_exp_f32 v89, v89
    v_cvt_pk_bf16_f32 v65, v86, v87
    v_exp_f32 v90, v90
    v_exp_f32 v91, v91
    v_cvt_pk_bf16_f32 v66, v88, v89
    v_cvt_pk_bf16_f32 v67, v90, v91
    s_setprio 0
    s_waitcnt lgkmcnt(0)
    v_mfma_f32_32x32x16_bf16 v[76:91], v[32:35], v[20:23], 0
    v_exp_f32 v92, v92
    v_exp_f32 v93, v93
    v_exp_f32 v94, v94
    v_exp_f32 v95, v95
    v_cvt_pk_bf16_f32 v68, v92, v93
    v_mfma_f32_32x32x8_bf16 v[76:91], v[40:41], v[28:29], v[76:91]
    v_exp_f32 v96, v96
    v_exp_f32 v97, v97
    v_cvt_pk_bf16_f32 v69, v94, v95
    v_exp_f32 v98, v98
    v_exp_f32 v99, v99
    v_cvt_pk_bf16_f32 v70, v96, v97
    v_mfma_f32_32x32x16_bf16 v[108:123], v[52:55], v[60:63], v[108:123]
    v_exp_f32 v100, v100
    v_exp_f32 v101, v101
    v_cvt_pk_bf16_f32 v71, v98, v99
    v_exp_f32 v102, v102
    v_exp_f32 v103, v103
    v_cvt_pk_bf16_f32 v72, v100, v101
    v_mfma_f32_32x32x16_bf16 v[108:123], v[56:59], v[64:67], v[108:123]
    v_exp_f32 v104, v104
    v_exp_f32 v105, v105
    v_cvt_pk_bf16_f32 v73, v102, v103
    v_exp_f32 v106, v106
    v_exp_f32 v107, v107
    v_cvt_pk_bf16_f32 v74, v104, v105
    v_cvt_pk_bf16_f32 v75, v106, v107
    s_setprio 3
    v_mfma_f32_32x32x16_bf16 v[92:107], v[32:35], v[24:27], 0
    ds_read_b128 v[36:39], v11 offset:1280
    ds_read_b32 v42, v13 offset:1280
    v_exp_f32 v76, v76
    v_exp_f32 v77, v77
    v_exp_f32 v78, v78
    v_exp_f32 v79, v79
    v_cvt_pk_bf16_f32 v60, v76, v77
    v_mfma_f32_32x32x8_bf16 v[92:107], v[40:41], v[30:31], v[92:107]
    v_exp_f32 v80, v80
    v_exp_f32 v81, v81
    v_cvt_pk_bf16_f32 v61, v78, v79
    v_exp_f32 v82, v82
    v_exp_f32 v83, v83
    v_cvt_pk_bf16_f32 v62, v80, v81
    v_mfma_f32_32x32x16_bf16 v[124:139], v[52:55], v[68:71], v[124:139]
    s_mov_b64 exec, s[16:17]
    ds_read_b128 v[44:47], v15 offset:0
    ds_read_b128 v[48:51], v15 offset:640
    s_mov_b64 exec, -1
    v_exp_f32 v84, v84
    v_exp_f32 v85, v85
    v_cvt_pk_bf16_f32 v63, v82, v83
    v_exp_f32 v86, v86
    v_exp_f32 v87, v87
    v_cvt_pk_bf16_f32 v64, v84, v85
    v_mfma_f32_32x32x16_bf16 v[124:139], v[56:59], v[72:75], v[124:139]
    v_exp_f32 v88, v88
    v_exp_f32 v89, v89
    v_cvt_pk_bf16_f32 v65, v86, v87
    v_exp_f32 v90, v90
    v_exp_f32 v91, v91
    v_cvt_pk_bf16_f32 v66, v88, v89
    v_cvt_pk_bf16_f32 v67, v90, v91
    s_setprio 2
    s_waitcnt lgkmcnt(0)
    v_mfma_f32_32x32x16_bf16 v[76:91], v[36:39], v[20:23], 0
    v_exp_f32 v92, v92
    v_exp_f32 v93, v93
    v_exp_f32 v94, v94
    v_exp_f32 v95, v95
    v_cvt_pk_bf16_f32 v68, v92, v93
    v_mfma_f32_32x32x8_bf16 v[76:91], v[42:43], v[28:29], v[76:91]
    v_exp_f32 v96, v96
    v_exp_f32 v97, v97
    v_cvt_pk_bf16_f32 v69, v94, v95
    v_exp_f32 v98, v98
    v_exp_f32 v99, v99
    v_cvt_pk_bf16_f32 v70, v96, v97
    v_mfma_f32_32x32x16_bf16 v[108:123], v[44:47], v[60:63], v[108:123]
    v_exp_f32 v100, v100
    v_exp_f32 v101, v101
    v_cvt_pk_bf16_f32 v71, v98, v99
    v_exp_f32 v102, v102
    v_exp_f32 v103, v103
    v_cvt_pk_bf16_f32 v72, v100, v101
    v_mfma_f32_32x32x16_bf16 v[108:123], v[48:51], v[64:67], v[108:123]
    v_exp_f32 v104, v104
    v_exp_f32 v105, v105
    v_cvt_pk_bf16_f32 v73, v102, v103
    v_exp_f32 v106, v106
    v_exp_f32 v107, v107
    v_cvt_pk_bf16_f32 v74, v104, v105
    v_cvt_pk_bf16_f32 v75, v106, v107
    s_setprio 1
    v_mfma_f32_32x32x16_bf16 v[92:107], v[36:39], v[24:27], 0
    ds_read_b128 v[32:35], v11 offset:2560
    ds_read_b32 v40, v13 offset:2560
    v_exp_f32 v76, v76
    v_exp_f32 v77, v77
    v_exp_f32 v78, v78
    v_exp_f32 v79, v79
    v_cvt_pk_bf16_f32 v60, v76, v77
    v_mfma_f32_32x32x8_bf16 v[92:107], v[42:43], v[30:31], v[92:107]
    v_exp_f32 v80, v80
    v_exp_f32 v81, v81
    v_cvt_pk_bf16_f32 v61, v78, v79
    v_exp_f32 v82, v82
    v_exp_f32 v83, v83
    v_cvt_pk_bf16_f32 v62, v80, v81
    v_mfma_f32_32x32x16_bf16 v[124:139], v[44:47], v[68:71], v[124:139]
    s_mov_b64 exec, s[16:17]
    ds_read_b128 v[52:55], v15 offset:1280
    ds_read_b128 v[56:59], v15 offset:1920
    s_mov_b64 exec, -1
    v_exp_f32 v84, v84
    v_exp_f32 v85, v85
    v_cvt_pk_bf16_f32 v63, v82, v83
    v_exp_f32 v86, v86
    v_exp_f32 v87, v87
    v_cvt_pk_bf16_f32 v64, v84, v85
    v_mfma_f32_32x32x16_bf16 v[124:139], v[48:51], v[72:75], v[124:139]
    v_exp_f32 v88, v88
    v_exp_f32 v89, v89
    v_cvt_pk_bf16_f32 v65, v86, v87
    v_exp_f32 v90, v90
    v_exp_f32 v91, v91
    v_cvt_pk_bf16_f32 v66, v88, v89
    v_cvt_pk_bf16_f32 v67, v90, v91
    s_setprio 0
    s_waitcnt lgkmcnt(0)
    v_mfma_f32_32x32x16_bf16 v[76:91], v[32:35], v[20:23], 0
    v_exp_f32 v92, v92
    v_exp_f32 v93, v93
    v_exp_f32 v94, v94
    v_exp_f32 v95, v95
    v_cvt_pk_bf16_f32 v68, v92, v93
    v_mfma_f32_32x32x8_bf16 v[76:91], v[40:41], v[28:29], v[76:91]
    v_exp_f32 v96, v96
    v_exp_f32 v97, v97
    v_cvt_pk_bf16_f32 v69, v94, v95
    v_exp_f32 v98, v98
    v_exp_f32 v99, v99
    v_cvt_pk_bf16_f32 v70, v96, v97
    v_mfma_f32_32x32x16_bf16 v[108:123], v[52:55], v[60:63], v[108:123]
    v_exp_f32 v100, v100
    v_exp_f32 v101, v101
    v_cvt_pk_bf16_f32 v71, v98, v99
    v_exp_f32 v102, v102
    v_exp_f32 v103, v103
    v_cvt_pk_bf16_f32 v72, v100, v101
    v_mfma_f32_32x32x16_bf16 v[108:123], v[56:59], v[64:67], v[108:123]
    v_exp_f32 v104, v104
    v_exp_f32 v105, v105
    v_cvt_pk_bf16_f32 v73, v102, v103
    v_exp_f32 v106, v106
    v_exp_f32 v107, v107
    v_cvt_pk_bf16_f32 v74, v104, v105
    v_cvt_pk_bf16_f32 v75, v106, v107
    s_cmp_eq_u32 s9, 0
    s_cbranch_scc1 gated_mix__softmax_full_mha__glu_gated_glu__prompt_kernel_noearly
    buffer_load_dwordx4 v[140:143], v8, s[32:35], s50 offen offset:0
    buffer_load_dwordx4 v[144:147], v8, s[32:35], s50 offen offset:1024
    buffer_load_dwordx4 v[148:151], v8, s[32:35], s50 offen offset:2048
    buffer_load_dwordx4 v[152:155], v8, s[32:35], s50 offen offset:3072
    s_add_u32 s41, s50, 4096
    buffer_load_dwordx4 v[156:159], v8, s[32:35], s41 offen offset:0
    buffer_load_dwordx4 v[160:163], v8, s[32:35], s41 offen offset:1024
    buffer_load_dwordx4 v[164:167], v8, s[32:35], s41 offen offset:2048
gated_mix__softmax_full_mha__glu_gated_glu__prompt_kernel_noearly:
    s_setprio 3
    v_mfma_f32_32x32x16_bf16 v[92:107], v[32:35], v[24:27], 0
    ds_read_b128 v[36:39], v11 offset:3840
    ds_read_b32 v42, v13 offset:3840
    v_exp_f32 v76, v76
    v_exp_f32 v77, v77
    v_exp_f32 v78, v78
    v_exp_f32 v79, v79
    v_cvt_pk_bf16_f32 v60, v76, v77
    v_mfma_f32_32x32x8_bf16 v[92:107], v[40:41], v[30:31], v[92:107]
    v_exp_f32 v80, v80
    v_exp_f32 v81, v81
    v_cvt_pk_bf16_f32 v61, v78, v79
    v_exp_f32 v82, v82
    v_exp_f32 v83, v83
    v_cvt_pk_bf16_f32 v62, v80, v81
    v_mfma_f32_32x32x16_bf16 v[124:139], v[52:55], v[68:71], v[124:139]
    s_mov_b64 exec, s[16:17]
    ds_read_b128 v[44:47], v15 offset:2560
    ds_read_b128 v[48:51], v15 offset:3200
    s_mov_b64 exec, -1
    v_exp_f32 v84, v84
    v_exp_f32 v85, v85
    v_cvt_pk_bf16_f32 v63, v82, v83
    v_exp_f32 v86, v86
    v_exp_f32 v87, v87
    v_cvt_pk_bf16_f32 v64, v84, v85
    v_mfma_f32_32x32x16_bf16 v[124:139], v[56:59], v[72:75], v[124:139]
    v_exp_f32 v88, v88
    v_exp_f32 v89, v89
    v_cvt_pk_bf16_f32 v65, v86, v87
    v_exp_f32 v90, v90
    v_exp_f32 v91, v91
    v_cvt_pk_bf16_f32 v66, v88, v89
    v_cvt_pk_bf16_f32 v67, v90, v91
    s_setprio 2
    s_waitcnt lgkmcnt(0)
    v_mfma_f32_32x32x16_bf16 v[76:91], v[36:39], v[20:23], 0
    v_exp_f32 v92, v92
    v_exp_f32 v93, v93
    v_exp_f32 v94, v94
    v_exp_f32 v95, v95
    v_cvt_pk_bf16_f32 v68, v92, v93
    v_mfma_f32_32x32x8_bf16 v[76:91], v[42:43], v[28:29], v[76:91]
    v_exp_f32 v96, v96
    v_exp_f32 v97, v97
    v_cvt_pk_bf16_f32 v69, v94, v95
    v_exp_f32 v98, v98
    v_exp_f32 v99, v99
    v_cvt_pk_bf16_f32 v70, v96, v97
    v_mfma_f32_32x32x16_bf16 v[108:123], v[44:47], v[60:63], v[108:123]
    v_exp_f32 v100, v100
    v_exp_f32 v101, v101
    v_cvt_pk_bf16_f32 v71, v98, v99
    v_exp_f32 v102, v102
    v_exp_f32 v103, v103
    v_cvt_pk_bf16_f32 v72, v100, v101
    v_mfma_f32_32x32x16_bf16 v[108:123], v[48:51], v[64:67], v[108:123]
    v_exp_f32 v104, v104
    v_exp_f32 v105, v105
    v_cvt_pk_bf16_f32 v73, v102, v103
    v_exp_f32 v106, v106
    v_exp_f32 v107, v107
    v_cvt_pk_bf16_f32 v74, v104, v105
    v_cvt_pk_bf16_f32 v75, v106, v107
    s_barrier
    s_setprio 1
    v_mfma_f32_32x32x16_bf16 v[92:107], v[36:39], v[24:27], 0
    ds_read_b128 v[32:35], v11 offset:5120
    ds_read_b32 v40, v13 offset:5120
    v_exp_f32 v76, v76
    v_exp_f32 v77, v77
    v_exp_f32 v78, v78
    v_exp_f32 v79, v79
    v_cvt_pk_bf16_f32 v60, v76, v77
    v_mfma_f32_32x32x8_bf16 v[92:107], v[42:43], v[30:31], v[92:107]
    v_exp_f32 v80, v80
    v_exp_f32 v81, v81
    v_cvt_pk_bf16_f32 v61, v78, v79
    v_exp_f32 v82, v82
    v_exp_f32 v83, v83
    v_cvt_pk_bf16_f32 v62, v80, v81
    v_mfma_f32_32x32x16_bf16 v[124:139], v[44:47], v[68:71], v[124:139]
    s_mov_b64 exec, s[16:17]
    ds_read_b128 v[52:55], v15 offset:3840
    ds_read_b128 v[56:59], v15 offset:4480
    s_mov_b64 exec, -1
    v_exp_f32 v84, v84
    v_exp_f32 v85, v85
    v_cvt_pk_bf16_f32 v63, v82, v83
    v_exp_f32 v86, v86
    v_exp_f32 v87, v87
    v_cvt_pk_bf16_f32 v64, v84, v85
    v_mfma_f32_32x32x16_bf16 v[124:139], v[48:51], v[72:75], v[124:139]
    v_exp_f32 v88, v88
    v_exp_f32 v89, v89
    v_cvt_pk_bf16_f32 v65, v86, v87
    v_exp_f32 v90, v90
    v_exp_f32 v91, v91
    v_cvt_pk_bf16_f32 v66, v88, v89
    v_cvt_pk_bf16_f32 v67, v90, v91
    s_setprio 0
    s_waitcnt lgkmcnt(0)
    v_mfma_f32_32x32x16_bf16 v[76:91], v[32:35], v[20:23], 0
    v_exp_f32 v92, v92
    v_exp_f32 v93, v93
    v_exp_f32 v94, v94
    v_exp_f32 v95, v95
    v_cvt_pk_bf16_f32 v68, v92, v93
    v_mfma_f32_32x32x8_bf16 v[76:91], v[40:41], v[28:29], v[76:91]
    v_exp_f32 v96, v96
    v_exp_f32 v97, v97
    v_cvt_pk_bf16_f32 v69, v94, v95
    v_exp_f32 v98, v98
    v_exp_f32 v99, v99
    v_cvt_pk_bf16_f32 v70, v96, v97
    v_mfma_f32_32x32x16_bf16 v[108:123], v[52:55], v[60:63], v[108:123]
    v_exp_f32 v100, v100
    v_exp_f32 v101, v101
    v_cvt_pk_bf16_f32 v71, v98, v99
    v_exp_f32 v102, v102
    v_exp_f32 v103, v103
    v_cvt_pk_bf16_f32 v72, v100, v101
    v_mfma_f32_32x32x16_bf16 v[108:123], v[56:59], v[64:67], v[108:123]
    v_exp_f32 v104, v104
    v_exp_f32 v105, v105
    v_cvt_pk_bf16_f32 v73, v102, v103
    v_exp_f32 v106, v106
    v_exp_f32 v107, v107
    v_cvt_pk_bf16_f32 v74, v104, v105
    v_cvt_pk_bf16_f32 v75, v106, v107
    s_setprio 3
    v_mfma_f32_32x32x16_bf16 v[92:107], v[32:35], v[24:27], 0
    ds_read_b128 v[36:39], v11 offset:6400
    ds_read_b32 v42, v13 offset:6400
    v_exp_f32 v76, v76
    v_exp_f32 v77, v77
    v_exp_f32 v78, v78
    v_exp_f32 v79, v79
    v_cvt_pk_bf16_f32 v60, v76, v77
    v_mfma_f32_32x32x8_bf16 v[92:107], v[40:41], v[30:31], v[92:107]
    v_exp_f32 v80, v80
    v_exp_f32 v81, v81
    v_cvt_pk_bf16_f32 v61, v78, v79
    v_exp_f32 v82, v82
    v_exp_f32 v83, v83
    v_cvt_pk_bf16_f32 v62, v80, v81
    v_mfma_f32_32x32x16_bf16 v[124:139], v[52:55], v[68:71], v[124:139]
    s_mov_b64 exec, s[16:17]
    ds_read_b128 v[44:47], v15 offset:5120
    ds_read_b128 v[48:51], v15 offset:5760
    s_mov_b64 exec, -1
    v_exp_f32 v84, v84
    v_exp_f32 v85, v85
    v_cvt_pk_bf16_f32 v63, v82, v83
    v_exp_f32 v86, v86
    v_exp_f32 v87, v87
    v_cvt_pk_bf16_f32 v64, v84, v85
    v_mfma_f32_32x32x16_bf16 v[124:139], v[56:59], v[72:75], v[124:139]
    v_exp_f32 v88, v88
    v_exp_f32 v89, v89
    v_cvt_pk_bf16_f32 v65, v86, v87
    v_exp_f32 v90, v90
    v_exp_f32 v91, v91
    v_cvt_pk_bf16_f32 v66, v88, v89
    v_cvt_pk_bf16_f32 v67, v90, v91
    s_setprio 2
    s_waitcnt lgkmcnt(0)
    v_mfma_f32_32x32x16_bf16 v[76:91], v[36:39], v[20:23], 0
    v_exp_f32 v92, v92
    v_exp_f32 v93, v93
    v_exp_f32 v94, v94
    v_exp_f32 v95, v95
    v_cvt_pk_bf16_f32 v68, v92, v93
    v_mfma_f32_32x32x8_bf16 v[76:91], v[42:43], v[28:29], v[76:91]
    v_exp_f32 v96, v96
    v_exp_f32 v97, v97
    v_cvt_pk_bf16_f32 v69, v94, v95
    v_exp_f32 v98, v98
    v_exp_f32 v99, v99
    v_cvt_pk_bf16_f32 v70, v96, v97
    v_mfma_f32_32x32x16_bf16 v[108:123], v[44:47], v[60:63], v[108:123]
    v_exp_f32 v100, v100
    v_exp_f32 v101, v101
    v_cvt_pk_bf16_f32 v71, v98, v99
    v_exp_f32 v102, v102
    v_exp_f32 v103, v103
    v_cvt_pk_bf16_f32 v72, v100, v101
    v_mfma_f32_32x32x16_bf16 v[108:123], v[48:51], v[64:67], v[108:123]
    v_exp_f32 v104, v104
    v_exp_f32 v105, v105
    v_cvt_pk_bf16_f32 v73, v102, v103
    v_exp_f32 v106, v106
    v_exp_f32 v107, v107
    v_cvt_pk_bf16_f32 v74, v104, v105
    v_cvt_pk_bf16_f32 v75, v106, v107
    s_setprio 1
    v_mfma_f32_32x32x16_bf16 v[92:107], v[36:39], v[24:27], 0
    ds_read_b128 v[32:35], v11 offset:7680
    ds_read_b32 v40, v13 offset:7680
    v_exp_f32 v76, v76
    v_exp_f32 v77, v77
    v_exp_f32 v78, v78
    v_exp_f32 v79, v79
    v_cvt_pk_bf16_f32 v60, v76, v77
    v_mfma_f32_32x32x8_bf16 v[92:107], v[42:43], v[30:31], v[92:107]
    v_exp_f32 v80, v80
    v_exp_f32 v81, v81
    v_cvt_pk_bf16_f32 v61, v78, v79
    v_exp_f32 v82, v82
    v_exp_f32 v83, v83
    v_cvt_pk_bf16_f32 v62, v80, v81
    v_mfma_f32_32x32x16_bf16 v[124:139], v[44:47], v[68:71], v[124:139]
    s_mov_b64 exec, s[16:17]
    ds_read_b128 v[52:55], v15 offset:6400
    ds_read_b128 v[56:59], v15 offset:7040
    s_mov_b64 exec, -1
    v_exp_f32 v84, v84
    v_exp_f32 v85, v85
    v_cvt_pk_bf16_f32 v63, v82, v83
    v_exp_f32 v86, v86
    v_exp_f32 v87, v87
    v_cvt_pk_bf16_f32 v64, v84, v85
    v_mfma_f32_32x32x16_bf16 v[124:139], v[48:51], v[72:75], v[124:139]
    v_exp_f32 v88, v88
    v_exp_f32 v89, v89
    v_cvt_pk_bf16_f32 v65, v86, v87
    v_exp_f32 v90, v90
    v_exp_f32 v91, v91
    v_cvt_pk_bf16_f32 v66, v88, v89
    v_cvt_pk_bf16_f32 v67, v90, v91
    s_setprio 0
    s_waitcnt lgkmcnt(0)
    v_mfma_f32_32x32x16_bf16 v[76:91], v[32:35], v[20:23], 0
    v_exp_f32 v92, v92
    v_exp_f32 v93, v93
    v_exp_f32 v94, v94
    v_exp_f32 v95, v95
    v_cvt_pk_bf16_f32 v68, v92, v93
    v_mfma_f32_32x32x8_bf16 v[76:91], v[40:41], v[28:29], v[76:91]
    v_exp_f32 v96, v96
    v_exp_f32 v97, v97
    v_cvt_pk_bf16_f32 v69, v94, v95
    v_exp_f32 v98, v98
    v_exp_f32 v99, v99
    v_cvt_pk_bf16_f32 v70, v96, v97
    v_mfma_f32_32x32x16_bf16 v[108:123], v[52:55], v[60:63], v[108:123]
    v_exp_f32 v100, v100
    v_exp_f32 v101, v101
    v_cvt_pk_bf16_f32 v71, v98, v99
    v_exp_f32 v102, v102
    v_exp_f32 v103, v103
    v_cvt_pk_bf16_f32 v72, v100, v101
    v_mfma_f32_32x32x16_bf16 v[108:123], v[56:59], v[64:67], v[108:123]
    v_exp_f32 v104, v104
    v_exp_f32 v105, v105
    v_cvt_pk_bf16_f32 v73, v102, v103
    v_exp_f32 v106, v106
    v_exp_f32 v107, v107
    v_cvt_pk_bf16_f32 v74, v104, v105
    v_cvt_pk_bf16_f32 v75, v106, v107
    s_setprio 3
    v_mfma_f32_32x32x16_bf16 v[92:107], v[32:35], v[24:27], 0
    ds_read_b128 v[36:39], v11 offset:8960
    ds_read_b32 v42, v13 offset:8960
    v_exp_f32 v76, v76
    v_exp_f32 v77, v77
    v_exp_f32 v78, v78
    v_exp_f32 v79, v79
    v_cvt_pk_bf16_f32 v60, v76, v77
    v_mfma_f32_32x32x8_bf16 v[92:107], v[40:41], v[30:31], v[92:107]
    v_exp_f32 v80, v80
    v_exp_f32 v81, v81
    v_cvt_pk_bf16_f32 v61, v78, v79
    v_exp_f32 v82, v82
    v_exp_f32 v83, v83
    v_cvt_pk_bf16_f32 v62, v80, v81
    v_mfma_f32_32x32x16_bf16 v[124:139], v[52:55], v[68:71], v[124:139]
    s_mov_b64 exec, s[16:17]
    ds_read_b128 v[44:47], v15 offset:7680
    ds_read_b128 v[48:51], v15 offset:8320
    s_mov_b64 exec, -1
    v_exp_f32 v84, v84
    v_exp_f32 v85, v85
    v_cvt_pk_bf16_f32 v63, v82, v83
    v_exp_f32 v86, v86
    v_exp_f32 v87, v87
    v_cvt_pk_bf16_f32 v64, v84, v85
    v_mfma_f32_32x32x16_bf16 v[124:139], v[56:59], v[72:75], v[124:139]
    v_exp_f32 v88, v88
    v_exp_f32 v89, v89
    v_cvt_pk_bf16_f32 v65, v86, v87
    v_exp_f32 v90, v90
    v_exp_f32 v91, v91
    v_cvt_pk_bf16_f32 v66, v88, v89
    v_cvt_pk_bf16_f32 v67, v90, v91
    s_setprio 2
    s_waitcnt lgkmcnt(0)
    v_mfma_f32_32x32x16_bf16 v[76:91], v[36:39], v[20:23], 0
    v_exp_f32 v92, v92
    v_exp_f32 v93, v93
    v_exp_f32 v94, v94
    v_exp_f32 v95, v95
    v_cvt_pk_bf16_f32 v68, v92, v93
    v_mfma_f32_32x32x8_bf16 v[76:91], v[42:43], v[28:29], v[76:91]
    v_exp_f32 v96, v96
    v_exp_f32 v97, v97
    v_cvt_pk_bf16_f32 v69, v94, v95
    v_exp_f32 v98, v98
    v_exp_f32 v99, v99
    v_cvt_pk_bf16_f32 v70, v96, v97
    v_mfma_f32_32x32x16_bf16 v[108:123], v[44:47], v[60:63], v[108:123]
    v_exp_f32 v100, v100
    v_exp_f32 v101, v101
    v_cvt_pk_bf16_f32 v71, v98, v99
    v_exp_f32 v102, v102
    v_exp_f32 v103, v103
    v_cvt_pk_bf16_f32 v72, v100, v101
    v_mfma_f32_32x32x16_bf16 v[108:123], v[48:51], v[64:67], v[108:123]
    v_exp_f32 v104, v104
    v_exp_f32 v105, v105
    v_cvt_pk_bf16_f32 v73, v102, v103
    v_exp_f32 v106, v106
    v_exp_f32 v107, v107
    v_cvt_pk_bf16_f32 v74, v104, v105
    v_cvt_pk_bf16_f32 v75, v106, v107
    s_setprio 1
    v_mfma_f32_32x32x16_bf16 v[92:107], v[36:39], v[24:27], 0
    v_exp_f32 v76, v76
    v_exp_f32 v77, v77
    v_exp_f32 v78, v78
    v_exp_f32 v79, v79
    v_cvt_pk_bf16_f32 v60, v76, v77
    v_mfma_f32_32x32x8_bf16 v[92:107], v[42:43], v[30:31], v[92:107]
    v_exp_f32 v80, v80
    v_exp_f32 v81, v81
    v_cvt_pk_bf16_f32 v61, v78, v79
    v_exp_f32 v82, v82
    v_exp_f32 v83, v83
    v_cvt_pk_bf16_f32 v62, v80, v81
    v_mfma_f32_32x32x16_bf16 v[124:139], v[44:47], v[68:71], v[124:139]
    s_mov_b64 exec, s[16:17]
    ds_read_b128 v[52:55], v15 offset:8960
    ds_read_b128 v[56:59], v15 offset:9600
    s_mov_b64 exec, -1
    v_exp_f32 v84, v84
    v_exp_f32 v85, v85
    v_cvt_pk_bf16_f32 v63, v82, v83
    v_exp_f32 v86, v86
    v_exp_f32 v87, v87
    v_cvt_pk_bf16_f32 v64, v84, v85
    v_mfma_f32_32x32x16_bf16 v[124:139], v[48:51], v[72:75], v[124:139]
    v_exp_f32 v88, v88
    v_exp_f32 v89, v89
    v_cvt_pk_bf16_f32 v65, v86, v87
    v_exp_f32 v90, v90
    v_exp_f32 v91, v91
    v_cvt_pk_bf16_f32 v66, v88, v89
    v_cvt_pk_bf16_f32 v67, v90, v91
    s_setprio 0
    s_waitcnt lgkmcnt(0)
    v_mfma_f32_32x32x16_bf16 v[108:123], v[52:55], v[60:63], v[108:123]
    v_exp_f32 v92, v92
    v_exp_f32 v93, v93
    v_exp_f32 v94, v94
    v_exp_f32 v95, v95
    v_cvt_pk_bf16_f32 v68, v92, v93
    v_mfma_f32_32x32x16_bf16 v[108:123], v[56:59], v[64:67], v[108:123]
    v_exp_f32 v96, v96
    v_exp_f32 v97, v97
    v_cvt_pk_bf16_f32 v69, v94, v95
    v_exp_f32 v98, v98
    v_exp_f32 v99, v99
    v_cvt_pk_bf16_f32 v70, v96, v97
    v_exp_f32 v100, v100
    v_exp_f32 v101, v101
    v_cvt_pk_bf16_f32 v71, v98, v99
    v_exp_f32 v102, v102
    v_exp_f32 v103, v103
    v_cvt_pk_bf16_f32 v72, v100, v101
    v_exp_f32 v104, v104
    v_exp_f32 v105, v105
    v_cvt_pk_bf16_f32 v73, v102, v103
    v_exp_f32 v106, v106
    v_exp_f32 v107, v107
    v_cvt_pk_bf16_f32 v74, v104, v105
    v_cvt_pk_bf16_f32 v75, v106, v107
    s_nop 0
    v_mfma_f32_32x32x16_bf16 v[124:139], v[52:55], v[68:71], v[124:139]
    v_mfma_f32_32x32x16_bf16 v[124:139], v[56:59], v[72:75], v[124:139]
    s_xor_b32 s43, s9, 1
    s_sub_u32 s43, s43, s9
    s_mul_i32 s43, s43, 3072
    s_add_u32 s43, s43, s52
    v_add_u32 v2, s43, v8
    v_add_u32 v3, s52, v8
    v_lshlrev_b32 v4, 3, v1
    v_cmp_gt_u32 vcc, 32, v1
    v_mov_b32 v5, 1073741824
    s_waitcnt vmcnt(0)
    v_cndmask_b32 v4, v5, v4, vcc
    s_cmp_eq_u32 s9, 0
    s_cbranch_scc1 gated_mix__softmax_full_mha__glu_gated_glu__prompt_kernel_keep0
    ds_write_b128 v2, v[108:111] offset:0
    ds_write_b128 v2, v[112:115] offset:1024
    ds_write_b128 v2, v[116:119] offset:2048
    v_mov_b32 v20, v24
    v_mov_b32 v21, v25
    v_mov_b32 v22, v26
    v_mov_b32 v23, v27
    v_mov_b32 v28, v30
    s_waitcnt lgkmcnt(0)
    v_mov_b32 v108, v124
    v_mov_b32 v109, v125
    v_mov_b32 v110, v126
    v_mov_b32 v111, v127
    v_mov_b32 v112, v128
    v_mov_b32 v113, v129
    v_mov_b32 v114, v130
    v_mov_b32 v115, v131
    v_mov_b32 v116, v132
    v_mov_b32 v117, v133
    v_mov_b32 v118, v134
    v_mov_b32 v119, v135
    s_branch gated_mix__softmax_full_mha__glu_gated_glu__prompt_kernel_sent
gated_mix__softmax_full_mha__glu_gated_glu__prompt_kernel_keep0:
    ds_write_b128 v2, v[124:127] offset:0
    ds_write_b128 v2, v[128:131] offset:1024
    ds_write_b128 v2, v[132:135] offset:2048
gated_mix__softmax_full_mha__glu_gated_glu__prompt_kernel_sent:
    s_waitcnt lgkmcnt(0)
    v_and_b32 v11, 7, v1
    v_lshlrev_b32 v11, 2, v11
    s_lshl_b32 s53, s10, 9
    s_lshl_b32 s43, s8, 7
    s_add_u32 s53, s53, s43
    s_add_u32 s53, s53, 23236608
    s_cmp_eq_u32 s9, 0
    s_cselect_b32 s43, s53, 1073741824
    s_barrier
    buffer_load_dword v12, v11, s[32:35], s43 offen sc1
    ds_read_b128 v[124:127], v3 offset:0
    ds_read_b128 v[128:131], v3 offset:1024
    ds_read_b128 v[132:135], v3 offset:2048
    s_waitcnt lgkmcnt(0)
    v_add_f32 v108, v108, v124
    v_add_f32 v109, v109, v125
    v_add_f32 v110, v110, v126
    v_add_f32 v111, v111, v127
    v_add_f32 v112, v112, v128
    v_add_f32 v113, v113, v129
    v_add_f32 v114, v114, v130
    v_add_f32 v115, v115, v131
    v_add_f32 v116, v116, v132
    v_add_f32 v117, v117, v133
    v_add_f32 v118, v118, v134
    v_add_f32 v119, v119, v135
    v_mov_b32 v5, v116
    v_mov_b32 v6, v116
    s_nop 1
    v_permlane32_swap_b32 v5, v6
    v_rcp_f32 v5, v6
    s_nop 0
    v_mul_f32 v5, v5, v18
    v_mul_f32 v124, v108, v5
    v_mul_f32 v125, v109, v5
    v_mul_f32 v126, v110, v5
    v_mul_f32 v127, v111, v5
    v_mul_f32 v128, v112, v5
    v_mul_f32 v129, v113, v5
    v_mul_f32 v130, v114, v5
    v_mul_f32 v131, v115, v5
    v_mul_f32 v132, v116, v5
    v_mul_f32 v133, v117, v5
    v_mul_f32 v134, v118, v5
    v_mul_f32 v135, v119, v5
    v_cvt_pk_bf16_f32 v124, v124, v125
    v_cvt_pk_bf16_f32 v125, v126, v127
    v_cvt_pk_bf16_f32 v126, v128, v129
    v_cvt_pk_bf16_f32 v127, v130, v131
    v_cvt_pk_bf16_f32 v128, v132, v133
    v_cvt_pk_bf16_f32 v129, v134, v135
    buffer_store_dwordx4 v[124:127], v8, s[32:35], s14 offen sc1
    buffer_store_dwordx2 v[128:129], v4, s[32:35], s14 offen offset:1024 sc1
    v_max3_f32 v7, abs(v108), abs(v109), abs(v6)
    v_max3_f32 v7, abs(v110), abs(v111), v7
    v_max3_f32 v7, abs(v112), abs(v113), v7
    v_max3_f32 v7, abs(v114), abs(v115), v7
    v_max3_f32 v7, abs(v116), abs(v117), v7
    v_max3_f32 v7, abs(v118), abs(v119), v7
    v_add_f32 v2, v108, v109
    v_add_f32 v2, v2, v110
    v_add_f32 v2, v2, v111
    v_add_f32 v2, v2, v112
    v_add_f32 v2, v2, v113
    v_add_f32 v2, v2, v114
    v_add_f32 v2, v2, v115
    v_add_f32 v2, v2, v116
    v_add_f32 v2, v2, v117
    v_add_f32 v2, v2, v118
    v_add_f32 v2, v2, v119
    v_mov_b32 v3, 0x71800000
    v_cmp_nlt_f32 s[18:19], v7, v3
    v_cmp_u_f32 s[46:47], v2, v2
    s_nop 1
    s_or_b64 s[18:19], s[18:19], s[46:47]
    s_cbranch_scc1 gated_mix__softmax_full_mha__glu_gated_glu__prompt_kernel_slow
gated_mix__softmax_full_mha__glu_gated_glu__prompt_kernel_tail:
    v_mov_b32 v2, 0
    v_mov_b32 v3, 1
    s_waitcnt vmcnt(0)
    s_mov_b64 exec, 1
    buffer_store_dword v3, v2, s[32:35], s51 offen sc1
    s_mov_b64 exec, -1
    v_mov_b32 v2, 161804
    s_mov_b64 exec, 1
    ds_add_u32 v2, v3
    s_mov_b64 exec, -1
    s_mul_i32 s44, s8, 10240
    s_cmp_ge_u32 s8, 2
    s_cselect_b32 s42, 110592, 0
    s_add_u32 s52, s44, s42
    s_cmp_lg_u32 s9, 0
    s_cbranch_scc1 gated_mix__softmax_full_mha__glu_gated_glu__prompt_kernel_quarter
    v_cmp_ne_u32 vcc, 1, v12
    s_cbranch_vccz gated_mix__softmax_full_mha__glu_gated_glu__prompt_kernel_poll3_ok
    s_mov_b32 s48, 0x40000
gated_mix__softmax_full_mha__glu_gated_glu__prompt_kernel_poll3:
    buffer_load_dword v3, v11, s[32:35], s53 offen sc1
    s_waitcnt vmcnt(0)
    v_cmp_ne_u32 vcc, 1, v3
    s_cbranch_vccz gated_mix__softmax_full_mha__glu_gated_glu__prompt_kernel_poll3_ok
    s_sleep 4
    s_sub_u32 s48, s48, 1
    s_cbranch_scc0 gated_mix__softmax_full_mha__glu_gated_glu__prompt_kernel_poll3
gated_mix__softmax_full_mha__glu_gated_glu__prompt_kernel_poll3_ok:
    s_mul_i32 s42, s10, 40960
    s_add_u32 s42, s42, s44
    s_add_u32 m0, s52, 0
    s_add_u32 s41, s42, 17981440
    buffer_load_dwordx4 v8, s[32:35], s41 offen offset:0 lds
    buffer_load_dwordx4 v8, s[32:35], s41 offen offset:1024 lds
    buffer_load_dwordx4 v8, s[32:35], s41 offen offset:2048 lds
    buffer_load_dwordx4 v8, s[32:35], s41 offen offset:3072 lds
    s_add_u32 m0, s52, 4096
    s_add_u32 s41, s42, 17985536
    buffer_load_dwordx4 v8, s[32:35], s41 offen offset:0 lds
    buffer_load_dwordx4 v8, s[32:35], s41 offen offset:1024 lds
    buffer_load_dwordx4 v8, s[32:35], s41 offen offset:2048 lds
    buffer_load_dwordx4 v8, s[32:35], s41 offen offset:3072 lds
    s_add_u32 m0, s52, 8192
    s_add_u32 s41, s42, 17989632
    buffer_load_dwordx4 v8, s[32:35], s41 offen offset:0 lds
    buffer_load_dwordx4 v8, s[32:35], s41 offen offset:1024 lds
    s_lshl_b32 s42, s8, 2
    s_add_u32 s42, s42, 161808
    v_mov_b32 v2, s42
    v_mov_b32 v3, 1
    s_waitcnt vmcnt(0)
    ds_write_b32 v2, v3
    s_endpgm
gated_mix__softmax_full_mha__glu_gated_glu__prompt_kernel_quarter:
    s_add_u32 s41, s50, 7168
    buffer_load_dwordx4 v[32:35], v8, s[32:35], s41 offen
    s_mul_i32 s41, s8, -6144
    s_add_u32 s41, s41, s50
    s_add_u32 s41, s41, 32768
    buffer_load_dwordx4 v[36:39], v8, s[32:35], s41 offen offset:0
    buffer_load_dwordx4 v[40:43], v8, s[32:35], s41 offen offset:1024
    v_and_b32 v4, 31, v1
    v_lshlrev_b32 v5, 2, v4
    s_lshl_b32 s41, s10, 7
    s_add_u32 s41, s41, 17973248
    buffer_load_dword v7, v5, s[32:35], s41 offen
    v_lshrrev_b32 v6, 5, v1
    v_mul_u32_u24 v10, 1280, v6
    v_lshl_add_u32 v10, v4, 3, v10
    s_mul_i32 s42, s11, 5
    s_add_u32 s42, s42, 4
    s_lshl_b32 s42, s42, 6
    s_mul_i32 s43, s10, 40960
    s_add_u32 s14, s42, s43
    v_mul_u32_u24 v12, 1280, v4
    v_lshl_add_u32 v12, v6, 4, v12
    s_mov_b32 s24, s22
    s_mov_b32 s25, s23
    s_mov_b32 s26, 2621440
    s_mov_b32 s27, 0x00020000
    v_add_u32 v9, s52, v8
    v_add_u32 v10, s52, v10
    s_lshl_b32 s41, s8, 12
    s_add_u32 s41, s41, 57344
    v_add_u32 v11, s41, v8
    s_cmp_lg_u32 s8, 0
    s_cbranch_scc1 gated_mix__softmax_full_mha__glu_gated_glu__prompt_kernel_zero
    s_lshl_b32 s41, 4, 11
    s_add_u32 s41, s41, 65536
    v_add_u32 v5, s41, v8
    v_add_u32 v2, 65536, v5
    ds_read_b128 v[124:127], v2 offset:20480
    ds_read_b128 v[128:131], v2 offset:21504
    ds_read_b128 v[132:135], v5 offset:20480
    ds_read_b128 v[136:139], v5 offset:21504
    s_waitcnt lgkmcnt(0)
    v_lshlrev_b32 v108, 16, v124
    v_and_b32 v109, 0xffff0000, v124
    v_lshlrev_b32 v110, 16, v125
    v_and_b32 v111, 0xffff0000, v125
    v_lshlrev_b32 v112, 16, v126
    v_and_b32 v113, 0xffff0000, v126
    v_lshlrev_b32 v114, 16, v127
    v_and_b32 v115, 0xffff0000, v127
    v_lshlrev_b32 v116, 16, v128
    v_and_b32 v117, 0xffff0000, v128
    v_lshlrev_b32 v118, 16, v129
    v_and_b32 v119, 0xffff0000, v129
    v_lshlrev_b32 v120, 16, v130
    v_and_b32 v121, 0xffff0000, v130
    v_lshlrev_b32 v122, 16, v131
    v_and_b32 v123, 0xffff0000, v131
    v_lshlrev_b32 v3, 16, v132
    v_and_b32 v132, 0xffff0000, v132
    v_add_f32 v108, v108, v3
    v_add_f32 v109, v109, v132
    v_lshlrev_b32 v3, 16, v133
    v_and_b32 v133, 0xffff0000, v133
    v_add_f32 v110, v110, v3
    v_add_f32 v111, v111, v133
    v_lshlrev_b32 v3, 16, v134
    v_and_b32 v134, 0xffff0000, v134
    v_add_f32 v112, v112, v3
    v_add_f32 v113, v113, v134
    v_lshlrev_b32 v3, 16, v135
    v_and_b32 v135, 0xffff0000, v135
    v_add_f32 v114, v114, v3
    v_add_f32 v115, v115, v135
    v_lshlrev_b32 v3, 16, v136
    v_and_b32 v136, 0xffff0000, v136
    v_add_f32 v116, v116, v3
    v_add_f32 v117, v117, v136
    v_lshlrev_b32 v3, 16, v137
    v_and_b32 v137, 0xffff0000, v137
    v_add_f32 v118, v118, v3
    v_add_f32 v119, v119, v137
    v_lshlrev_b32 v3, 16, v138
    v_and_b32 v138, 0xffff0000, v138
    v_add_f32 v120, v120, v3
    v_add_f32 v121, v121, v138
    v_lshlrev_b32 v3, 16, v139
    v_and_b32 v139, 0xffff0000, v139
    v_add_f32 v122, v122, v3
    v_add_f32 v123, v123, v139
    ds_read_b128 v[124:127], v5 offset:45056
    ds_read_b128 v[128:131], v5 offset:46080
    ds_read_b128 v[132:135], v5 offset:55296
    ds_read_b128 v[136:139], v5 offset:56320
    s_waitcnt lgkmcnt(0)
    v_lshlrev_b32 v3, 16, v124
    v_and_b32 v124, 0xffff0000, v124
    v_add_f32 v108, v108, v3
    v_add_f32 v109, v109, v124
    v_lshlrev_b32 v3, 16, v125
    v_and_b32 v125, 0xffff0000, v125
    v_add_f32 v110, v110, v3
    v_add_f32 v111, v111, v125
    v_lshlrev_b32 v3, 16, v126
    v_and_b32 v126, 0xffff0000, v126
    v_add_f32 v112, v112, v3
    v_add_f32 v113, v113, v126
    v_lshlrev_b32 v3, 16, v127
    v_and_b32 v127, 0xffff0000, v127
    v_add_f32 v114, v114, v3
    v_add_f32 v115, v115, v127
    v_lshlrev_b32 v3, 16, v128
    v_and_b32 v128, 0xffff0000, v128
    v_add_f32 v116, v116, v3
    v_add_f32 v117, v117, v128
    v_lshlrev_b32 v3, 16, v129
    v_and_b32 v129, 0xffff0000, v129
    v_add_f32 v118, v118, v3
    v_add_f32 v119, v119, v129
    v_lshlrev_b32 v3, 16, v130
    v_and_b32 v130, 0xffff0000, v130
    v_add_f32 v120, v120, v3
    v_add_f32 v121, v121, v130
    v_lshlrev_b32 v3, 16, v131
    v_and_b32 v131, 0xffff0000, v131
    v_add_f32 v122, v122, v3
    v_add_f32 v123, v123, v131
    v_lshlrev_b32 v3, 16, v132
    v_and_b32 v132, 0xffff0000, v132
    v_add_f32 v108, v108, v3
    v_add_f32 v109, v109, v132
    v_lshlrev_b32 v3, 16, v133
    v_and_b32 v133, 0xffff0000, v133
    v_add_f32 v110, v110, v3
    v_add_f32 v111, v111, v133
    v_lshlrev_b32 v3, 16, v134
    v_and_b32 v134, 0xffff0000, v134
    v_add_f32 v112, v112, v3
    v_add_f32 v113, v113, v134
    v_lshlrev_b32 v3, 16, v135
    v_and_b32 v135, 0xffff0000, v135
    v_add_f32 v114, v114, v3
    v_add_f32 v115, v115, v135
    v_lshlrev_b32 v3, 16, v136
    v_and_b32 v136, 0xffff0000, v136
    v_add_f32 v116, v116, v3
    v_add_f32 v117, v117, v136
    v_lshlrev_b32 v3, 16, v137
    v_and_b32 v137, 0xffff0000, v137
    v_add_f32 v118, v118, v3
    v_add_f32 v119, v119, v137
    v_lshlrev_b32 v3, 16, v138
    v_and_b32 v138, 0xffff0000, v138
    v_add_f32 v120, v120, v3
    v_add_f32 v121, v121, v138
    v_lshlrev_b32 v3, 16, v139
    v_and_b32 v139, 0xffff0000, v139
    v_add_f32 v122, v122, v3
    v_add_f32 v123, v123, v139
    s_waitcnt vmcnt(0)
    v_sub_f32 v7, 1.0, v7
    v_mul_f32 v108, v108, v7
    v_mul_f32 v109, v109, v7
    v_mul_f32 v110, v110, v7
    v_mul_f32 v111, v111, v7
    v_mul_f32 v112, v112, v7
    v_mul_f32 v113, v113, v7
    v_mul_f32 v114, v114, v7
    v_mul_f32 v115, v115, v7
    v_mul_f32 v116, v116, v7
    v_mul_f32 v117, v117, v7
    v_mul_f32 v118, v118, v7
    v_mul_f32 v119, v119, v7
    v_mul_f32 v120, v120, v7
    v_mul_f32 v121, v121, v7
    v_mul_f32 v122, v122, v7
    v_mul_f32 v123, v123, v7
    s_branch gated_mix__softmax_full_mha__glu_gated_glu__prompt_kernel_inited
gated_mix__softmax_full_mha__glu_gated_glu__prompt_kernel_zero:
    v_mov_b32 v108, 0
    v_mov_b32 v109, 0
    v_mov_b32 v110, 0
    v_mov_b32 v111, 0
    v_mov_b32 v112, 0
    v_mov_b32 v113, 0
    v_mov_b32 v114, 0
    v_mov_b32 v115, 0
    v_mov_b32 v116, 0
    v_mov_b32 v117, 0
    v_mov_b32 v118, 0
    v_mov_b32 v119, 0
    v_mov_b32 v120, 0
    v_mov_b32 v121, 0
    v_mov_b32 v122, 0
    v_mov_b32 v123, 0
gated_mix__softmax_full_mha__glu_gated_glu__prompt_kernel_inited:
    s_setprio 3
    v_mov_b32 v2, 161804
    s_mov_b32 s48, 0x800000
gated_mix__softmax_full_mha__glu_gated_glu__prompt_kernel_xspin:
    ds_read_b32 v3, v2
    s_waitcnt lgkmcnt(0)
    v_cmp_ne_u32 vcc, 8, v3
    s_cbranch_vccz gated_mix__softmax_full_mha__glu_gated_glu__prompt_kernel_xspin_ok
    s_sleep 1
    s_sub_u32 s48, s48, 1
    s_cbranch_scc0 gated_mix__softmax_full_mha__glu_gated_glu__prompt_kernel_xspin
gated_mix__softmax_full_mha__glu_gated_glu__prompt_kernel_xspin_ok:
    s_lshl_b32 s42, s8, 2
    s_add_u32 s42, s42, 161808
    v_mov_b32 v2, s42
    s_waitcnt vmcnt(0)
    s_mov_b32 s48, 0x800000
gated_mix__softmax_full_mha__glu_gated_glu__prompt_kernel_qspin:
    ds_read_b32 v3, v2
    s_waitcnt lgkmcnt(0)
    v_cmp_ne_u32 vcc, 1, v3
    s_cbranch_vccz gated_mix__softmax_full_mha__glu_gated_glu__prompt_kernel_qspin_ok
    s_sleep 1
    s_sub_u32 s48, s48, 1
    s_cbranch_scc0 gated_mix__softmax_full_mha__glu_gated_glu__prompt_kernel_qspin
gated_mix__softmax_full_mha__glu_gated_glu__prompt_kernel_qspin_ok:
    ds_read_b128 v[124:127], v9 offset:0
    ds_read_b128 v[128:131], v9 offset:1280
    ds_read_b128 v[132:135], v9 offset:2560
    s_waitcnt lgkmcnt(2)
    v_mfma_f32_32x32x16_bf16 v[108:123], v[140:143], v[124:127], v[108:123]
    ds_read_b128 v[136:139], v9 offset:3840
    s_waitcnt lgkmcnt(2)
    v_mfma_f32_32x32x16_bf16 v[108:123], v[144:147], v[128:131], v[108:123]
    ds_read_b128 v[124:127], v9 offset:5120
    s_waitcnt lgkmcnt(2)
    v_mfma_f32_32x32x16_bf16 v[108:123], v[148:151], v[132:135], v[108:123]
    ds_read_b128 v[128:131], v9 offset:6400
    s_waitcnt lgkmcnt(2)
    v_mfma_f32_32x32x16_bf16 v[108:123], v[152:155], v[136:139], v[108:123]
    ds_read_b128 v[132:135], v9 offset:7680
    s_waitcnt lgkmcnt(2)
    v_mfma_f32_32x32x16_bf16 v[108:123], v[156:159], v[124:127], v[108:123]
    ds_read_b128 v[136:139], v9 offset:8960
    s_waitcnt lgkmcnt(2)
    v_mfma_f32_32x32x16_bf16 v[108:123], v[160:163], v[128:131], v[108:123]
    ds_read_b64 v[124:125], v10 offset:1024
    ds_read_b64 v[126:127], v10 offset:3584
    s_waitcnt lgkmcnt(3)
    v_mfma_f32_32x32x16_bf16 v[108:123], v[164:167], v[132:135], v[108:123]
    ds_read_b64 v[128:129], v10 offset:6144
    ds_read_b64 v[130:131], v10 offset:8704
    s_waitcnt lgkmcnt(4)
    v_mfma_f32_32x32x16_bf16 v[108:123], v[32:35], v[136:139], v[108:123]
    s_waitcnt lgkmcnt(2)
    v_mfma_f32_32x32x16_bf16 v[108:123], v[36:39], v[124:127], v[108:123]
    s_waitcnt lgkmcnt(0)
    v_mfma_f32_32x32x16_bf16 v[108:123], v[40:43], v[128:131], v[108:123]
    s_cmp_eq_u32 s8, 0
    s_cbranch_scc1 gated_mix__softmax_full_mha__glu_gated_glu__prompt_kernel_q0
    s_nop 7
    v_mov_b32 v2, 161800
    v_mov_b32 v3, 1
    ds_write_b128 v11, v[108:111] offset:0
    ds_write_b128 v11, v[112:115] offset:1024
    ds_write_b128 v11, v[116:119] offset:2048
    ds_write_b128 v11, v[120:123] offset:3072
    s_waitcnt lgkmcnt(0)
    s_mov_b64 exec, 1
    ds_add_u32 v2, v3
    s_endpgm
gated_mix__softmax_full_mha__glu_gated_glu__prompt_kernel_q0:
    v_mov_b32 v2, 161800
    s_mov_b32 s48, 0x800000
gated_mix__softmax_full_mha__glu_gated_glu__prompt_kernel_q0spin:
    ds_read_b32 v3, v2
    s_waitcnt lgkmcnt(0)
    v_cmp_ne_u32 vcc, 3, v3
    s_cbranch_vccz gated_mix__softmax_full_mha__glu_gated_glu__prompt_kernel_q0spin_ok
    s_sleep 1
    s_sub_u32 s48, s48, 1
    s_cbranch_scc0 gated_mix__softmax_full_mha__glu_gated_glu__prompt_kernel_q0spin
gated_mix__softmax_full_mha__glu_gated_glu__prompt_kernel_q0spin_ok:
    ds_read_b128 v[32:35], v11 offset:4096
    ds_read_b128 v[36:39], v11 offset:5120
    ds_read_b128 v[40:43], v11 offset:6144
    ds_read_b128 v[44:47], v11 offset:7168
    ds_read_b128 v[48:51], v11 offset:8192
    ds_read_b128 v[52:55], v11 offset:9216
    ds_read_b128 v[56:59], v11 offset:10240
    ds_read_b128 v[60:63], v11 offset:11264
    ds_read_b128 v[64:67], v11 offset:12288
    ds_read_b128 v[68:71], v11 offset:13312
    ds_read_b128 v[72:75], v11 offset:14336
    ds_read_b128 v[76:79], v11 offset:15360
    s_waitcnt lgkmcnt(8)
    v_add_f32 v108, v108, v32
    v_add_f32 v109, v109, v33
    v_add_f32 v110, v110, v34
    v_add_f32 v111, v111, v35
    v_add_f32 v112, v112, v36
    v_add_f32 v113, v113, v37
    v_add_f32 v114, v114, v38
    v_add_f32 v115, v115, v39
    v_add_f32 v116, v116, v40
    v_add_f32 v117, v117, v41
    v_add_f32 v118, v118, v42
    v_add_f32 v119, v119, v43
    v_add_f32 v120, v120, v44
    v_add_f32 v121, v121, v45
    v_add_f32 v122, v122, v46
    v_add_f32 v123, v123, v47
    s_waitcnt lgkmcnt(4)
    v_add_f32 v108, v108, v48
    v_add_f32 v109, v109, v49
    v_add_f32 v110, v110, v50
    v_add_f32 v111, v111, v51
    v_add_f32 v112, v112, v52
    v_add_f32 v113, v113, v53
    v_add_f32 v114, v114, v54
    v_add_f32 v115, v115, v55
    v_add_f32 v116, v116, v56
    v_add_f32 v117, v117, v57
    v_add_f32 v118, v118, v58
    v_add_f32 v119, v119, v59
    v_add_f32 v120, v120, v60
    v_add_f32 v121, v121, v61
    v_add_f32 v122, v122, v62
    v_add_f32 v123, v123, v63
    s_waitcnt lgkmcnt(0)
    v_add_f32 v108, v108, v64
    v_add_f32 v109, v109, v65
    v_add_f32 v110, v110, v66
    v_add_f32 v111, v111, v67
    v_add_f32 v112, v112, v68
    v_add_f32 v113, v113, v69
    v_add_f32 v114, v114, v70
    v_add_f32 v115, v115, v71
    v_add_f32 v116, v116, v72
    v_add_f32 v117, v117, v73
    v_add_f32 v118, v118, v74
    v_add_f32 v119, v119, v75
    v_add_f32 v120, v120, v76
    v_add_f32 v121, v121, v77
    v_add_f32 v122, v122, v78
    v_add_f32 v123, v123, v79
    v_cvt_pk_bf16_f32 v124, v108, v109
    v_cvt_pk_bf16_f32 v125, v110, v111
    v_cvt_pk_bf16_f32 v126, v112, v113
    v_cvt_pk_bf16_f32 v127, v114, v115
    v_cvt_pk_bf16_f32 v128, v116, v117
    v_cvt_pk_bf16_f32 v129, v118, v119
    v_cvt_pk_bf16_f32 v130, v120, v121
    v_cvt_pk_bf16_f32 v131, v122, v123
    s_nop 1
    v_permlane32_swap_b32 v124, v126
    v_permlane32_swap_b32 v125, v127
    v_permlane32_swap_b32 v128, v130
    v_permlane32_swap_b32 v129, v131
    buffer_store_dwordx4 v[124:127], v12, s[24:27], s14 offen offset:0
    buffer_store_dwordx4 v[128:131], v12, s[24:27], s14 offen offset:32
    s_endpgm
gated_mix__softmax_full_mha__glu_gated_glu__prompt_kernel_slow:
    v_mov_b32 v29, 0
    v_mov_b32 v3, 0xff800000
    s_mov_b32 s15, s6
    s_add_u32 s44, s6, 81920
gated_mix__softmax_full_mha__glu_gated_glu__prompt_kernel_slow1:
    buffer_load_dwordx4 v[32:35], v8, s[32:35], s15 offen
    buffer_load_dword v40, v9, s[32:35], s15 offen offset:1024
    s_waitcnt vmcnt(0)
    v_mfma_f32_32x32x16_bf16 v[76:91], v[32:35], v[20:23], 0
    v_mfma_f32_32x32x8_bf16 v[76:91], v[40:41], v[28:29], v[76:91]
    s_nop 11
    v_max3_f32 v3, v76, v77, v3
    v_max3_f32 v3, v3, v78, v79
    v_max3_f32 v3, v3, v80, v81
    v_max3_f32 v3, v3, v82, v83
    v_max3_f32 v3, v3, v84, v85
    v_max3_f32 v3, v3, v86, v87
    v_max3_f32 v3, v3, v88, v89
    v_max3_f32 v3, v3, v90, v91
    s_add_u32 s15, s15, 1280
    s_cmp_lt_u32 s15, s44
    s_cbranch_scc1 gated_mix__softmax_full_mha__glu_gated_glu__prompt_kernel_slow1
    v_mov_b32 v5, v3
    s_nop 1
    v_permlane32_swap_b32 v3, v5
    v_max_f32 v3, v3, v5
    v_sub_f32 v3, 0, v3
    v_and_b32 v5, 0xffff0000, v3
    v_sub_f32 v3, v3, v5
    v_and_b32 v6, 0xffff0000, v3
    v_sub_f32 v3, v3, v6
    v_cmp_gt_u32 vcc, 32, v1
    v_lshrrev_b32 v5, 16, v5
    v_or_b32 v5, v5, v6
    v_lshrrev_b32 v3, 16, v3
    v_cndmask_b32 v29, v3, v5, vcc
    v_mov_b32 v108, 0
    v_mov_b32 v109, 0
    v_mov_b32 v110, 0
    v_mov_b32 v111, 0
    v_mov_b32 v112, 0
    v_mov_b32 v113, 0
    v_mov_b32 v114, 0
    v_mov_b32 v115, 0
    v_mov_b32 v116, 0
    v_mov_b32 v117, 0
    v_mov_b32 v118, 0
    v_mov_b32 v119, 0
    v_mov_b32 v120, 0
    v_mov_b32 v121, 0
    v_mov_b32 v122, 0
    v_mov_b32 v123, 0
    s_mov_b32 s15, s6
    s_mov_b32 s41, s7
gated_mix__softmax_full_mha__glu_gated_glu__prompt_kernel_slow2:
    buffer_load_dwordx4 v[32:35], v8, s[32:35], s15 offen
    buffer_load_dword v40, v9, s[32:35], s15 offen offset:1024
    s_mov_b64 exec, s[16:17]
    buffer_load_dwordx4 v[44:47], v10, s[32:35], s41 offen
    buffer_load_dwordx4 v[48:51], v10, s[32:35], s41 offen offset:640
    s_mov_b64 exec, -1
    s_waitcnt vmcnt(0)
    v_mfma_f32_32x32x16_bf16 v[76:91], v[32:35], v[20:23], 0
    v_mfma_f32_32x32x8_bf16 v[76:91], v[40:41], v[28:29], v[76:91]
    s_nop 11
    v_exp_f32 v76, v76
    v_exp_f32 v77, v77
    v_exp_f32 v78, v78
    v_exp_f32 v79, v79
    v_cvt_pk_bf16_f32 v60, v76, v77
    v_exp_f32 v80, v80
    v_exp_f32 v81, v81
    v_cvt_pk_bf16_f32 v61, v78, v79
    v_exp_f32 v82, v82
    v_exp_f32 v83, v83
    v_cvt_pk_bf16_f32 v62, v80, v81
    v_exp_f32 v84, v84
    v_exp_f32 v85, v85
    v_cvt_pk_bf16_f32 v63, v82, v83
    v_exp_f32 v86, v86
    v_exp_f32 v87, v87
    v_cvt_pk_bf16_f32 v64, v84, v85
    v_exp_f32 v88, v88
    v_exp_f32 v89, v89
    v_cvt_pk_bf16_f32 v65, v86, v87
    v_exp_f32 v90, v90
    v_exp_f32 v91, v91
    v_cvt_pk_bf16_f32 v66, v88, v89
    v_cvt_pk_bf16_f32 v67, v90, v91
    s_nop 1
    v_mfma_f32_32x32x16_bf16 v[108:123], v[44:47], v[60:63], v[108:123]
    v_mfma_f32_32x32x16_bf16 v[108:123], v[48:51], v[64:67], v[108:123]
    s_add_u32 s15, s15, 1280
    s_add_u32 s41, s41, 1280
    s_cmp_lt_u32 s15, s44
    s_cbranch_scc1 gated_mix__softmax_full_mha__glu_gated_glu__prompt_kernel_slow2
    s_nop 11
    v_mov_b32 v5, v116
    v_mov_b32 v6, v116
    s_nop 1
    v_permlane32_swap_b32 v5, v6
    v_rcp_f32 v5, v6
    s_nop 0
    v_mul_f32 v5, v5, v18
    v_mul_f32 v124, v108, v5
    v_mul_f32 v125, v109, v5
    v_mul_f32 v126, v110, v5
    v_mul_f32 v127, v111, v5
    v_mul_f32 v128, v112, v5
    v_mul_f32 v129, v113, v5
    v_mul_f32 v130, v114, v5
    v_mul_f32 v131, v115, v5
    v_mul_f32 v132, v116, v5
    v_mul_f32 v133, v117, v5
    v_mul_f32 v134, v118, v5
    v_mul_f32 v135, v119, v5
    v_cvt_pk_bf16_f32 v124, v124, v125
    v_cvt_pk_bf16_f32 v125, v126, v127
    v_cvt_pk_bf16_f32 v126, v128, v129
    v_cvt_pk_bf16_f32 v127, v130, v131
    v_cvt_pk_bf16_f32 v128, v132, v133
    v_cvt_pk_bf16_f32 v129, v134, v135
    buffer_store_dwordx4 v[124:127], v8, s[32:35], s14 offen sc1
    buffer_store_dwordx2 v[128:129], v4, s[32:35], s14 offen offset:1024 sc1
    s_branch gated_mix__softmax_full_mha__glu_gated_glu__prompt_kernel_tail
gated_mix__softmax_full_mha__glu_gated_glu__prompt_kernel_aux:
    s_lshr_b32 s41, s37, 3
    s_lshl_b32 s4, s36, 2
    s_add_u32 s4, s4, s41
    s_and_b32 s5, s37, 7
    s_mul_i32 s6, s4, 81920
    s_add_u32 s7, s6, 5242880
    s_sub_u32 s54, s38, 8
    v_lshlrev_b32 v8, 4, v1
    s_cmp_ge_u32 s54, 2
    s_cbranch_scc1 gated_mix__softmax_full_mha__glu_gated_glu__prompt_kernel_first_done
    s_lshr_b32 s42, s4, 4
    s_lshl_b32 s42, s42, 7
    s_lshl_b32 s43, s36, 10
    s_add_u32 s42, s42, s43
    s_add_u32 s44, s42, 23224320
    s_cmp_eq_u32 s54, 0
    s_cbranch_scc1 gated_mix__softmax_full_mha__glu_gated_glu__prompt_kernel_kv
    v_and_b32 v2, 1, v1
    s_lshl_b32 s43, s5, 1
    v_add_lshl_u32 v2, v2, s43, 2
    s_mov_b32 s48, 0x40000
gated_mix__softmax_full_mha__glu_gated_glu__prompt_kernel_pollq:
    buffer_load_dword v3, v2, s[32:35], s44 offen sc1
    s_waitcnt vmcnt(0)
    v_cmp_ne_u32 vcc, 1, v3
    s_cbranch_vccz gated_mix__softmax_full_mha__glu_gated_glu__prompt_kernel_pollq_ok
    s_sleep 6
    s_sub_u32 s48, s48, 1
    s_cbranch_scc0 gated_mix__softmax_full_mha__glu_gated_glu__prompt_kernel_pollq
gated_mix__softmax_full_mha__glu_gated_glu__prompt_kernel_pollq_ok:
    s_mul_i32 s42, s5, 10240
    s_add_u32 s42, s42, s6
    s_mov_b32 m0, 151552
    s_add_u32 s41, s42, 0
    buffer_load_dwordx4 v8, s[32:35], s41 offen offset:0 lds
    buffer_load_dwordx4 v8, s[32:35], s41 offen offset:1024 lds
    buffer_load_dwordx4 v8, s[32:35], s41 offen offset:2048 lds
    buffer_load_dwordx4 v8, s[32:35], s41 offen offset:3072 lds
    s_mov_b32 m0, 155648
    s_add_u32 s41, s42, 4096
    buffer_load_dwordx4 v8, s[32:35], s41 offen offset:0 lds
    buffer_load_dwordx4 v8, s[32:35], s41 offen offset:1024 lds
    buffer_load_dwordx4 v8, s[32:35], s41 offen offset:2048 lds
    buffer_load_dwordx4 v8, s[32:35], s41 offen offset:3072 lds
    s_mov_b32 m0, 159744
    s_add_u32 s41, s42, 8192
    buffer_load_dwordx4 v8, s[32:35], s41 offen offset:0 lds
    buffer_load_dwordx4 v8, s[32:35], s41 offen offset:1024 lds
    s_waitcnt vmcnt(0)
    s_branch gated_mix__softmax_full_mha__glu_gated_glu__prompt_kernel_first_done
gated_mix__softmax_full_mha__glu_gated_glu__prompt_kernel_kv:
    v_and_b32 v4, 15, v1
    v_lshlrev_b32 v4, 2, v4
    v_bfe_u32 v5, v1, 4, 1
    v_lshlrev_b32 v5, 8, v5
    v_add3_u32 v4, v4, v5, 0
    v_add_u32 v4, 256, v4
    s_mov_b32 s48, 0x40000
gated_mix__softmax_full_mha__glu_gated_glu__prompt_kernel_poll1:
    buffer_load_dword v3, v4, s[32:35], s44 offen sc1
    s_waitcnt vmcnt(0)
    v_cmp_ne_u32 vcc, 1, v3
    s_cbranch_vccz gated_mix__softmax_full_mha__glu_gated_glu__prompt_kernel_poll1_ok
    s_sleep 6
    s_sub_u32 s48, s48, 1
    s_cbranch_scc0 gated_mix__softmax_full_mha__glu_gated_glu__prompt_kernel_poll1
gated_mix__softmax_full_mha__glu_gated_glu__prompt_kernel_poll1_ok:
    s_mov_b32 m0, 0
    s_add_u32 s41, s6, 2621440
    buffer_load_dwordx4 v8, s[32:35], s41 offen offset:0 lds
    buffer_load_dwordx4 v8, s[32:35], s41 offen offset:1024 lds
    buffer_load_dwordx4 v8, s[32:35], s41 offen offset:2048 lds
    buffer_load_dwordx4 v8, s[32:35], s41 offen offset:3072 lds
    s_mov_b32 m0, 131072
    s_add_u32 s41, s7, 0
    buffer_load_dwordx4 v8, s[32:35], s41 offen offset:0 lds
    buffer_load_dwordx4 v8, s[32:35], s41 offen offset:1024 lds
    buffer_load_dwordx4 v8, s[32:35], s41 offen offset:2048 lds
    s_mov_b32 m0, 10240
    s_add_u32 s41, s6, 2631680
    buffer_load_dwordx4 v8, s[32:35], s41 offen offset:0 lds
    buffer_load_dwordx4 v8, s[32:35], s41 offen offset:1024 lds
    buffer_load_dwordx4 v8, s[32:35], s41 offen offset:2048 lds
    buffer_load_dwordx4 v8, s[32:35], s41 offen offset:3072 lds
    s_mov_b32 m0, 141312
    s_add_u32 s41, s7, 10240
    buffer_load_dwordx4 v8, s[32:35], s41 offen offset:0 lds
    buffer_load_dwordx4 v8, s[32:35], s41 offen offset:1024 lds
    buffer_load_dwordx4 v8, s[32:35], s41 offen offset:2048 lds
    s_mov_b32 m0, 4096
    s_add_u32 s41, s6, 2625536
    buffer_load_dwordx4 v8, s[32:35], s41 offen offset:0 lds
    buffer_load_dwordx4 v8, s[32:35], s41 offen offset:1024 lds
    buffer_load_dwordx4 v8, s[32:35], s41 offen offset:2048 lds
    buffer_load_dwordx4 v8, s[32:35], s41 offen offset:3072 lds
    s_mov_b32 m0, 8192
    s_add_u32 s41, s6, 2629632
    buffer_load_dwordx4 v8, s[32:35], s41 offen offset:0 lds
    buffer_load_dwordx4 v8, s[32:35], s41 offen offset:1024 lds
    s_mov_b32 m0, 134144
    s_add_u32 s41, s7, 3072
    buffer_load_dwordx4 v8, s[32:35], s41 offen offset:0 lds
    buffer_load_dwordx4 v8, s[32:35], s41 offen offset:1024 lds
    buffer_load_dwordx4 v8, s[32:35], s41 offen offset:2048 lds
    buffer_load_dwordx4 v8, s[32:35], s41 offen offset:3072 lds
    s_mov_b32 m0, 138240
    s_add_u32 s41, s7, 7168
    buffer_load_dwordx4 v8, s[32:35], s41 offen offset:0 lds
    buffer_load_dwordx4 v8, s[32:35], s41 offen offset:1024 lds
    buffer_load_dwordx4 v8, s[32:35], s41 offen offset:2048 lds
    s_mov_b32 m0, 14336
    s_add_u32 s41, s6, 2635776
    buffer_load_dwordx4 v8, s[32:35], s41 offen offset:0 lds
    buffer_load_dwordx4 v8, s[32:35], s41 offen offset:1024 lds
    buffer_load_dwordx4 v8, s[32:35], s41 offen offset:2048 lds
    buffer_load_dwordx4 v8, s[32:35], s41 offen offset:3072 lds
    s_mov_b32 m0, 18432
    s_add_u32 s41, s6, 2639872
    buffer_load_dwordx4 v8, s[32:35], s41 offen offset:0 lds
    buffer_load_dwordx4 v8, s[32:35], s41 offen offset:1024 lds
    s_mov_b32 m0, 144384
    s_add_u32 s41, s7, 13312
    buffer_load_dwordx4 v8, s[32:35], s41 offen offset:0 lds
    buffer_load_dwordx4 v8, s[32:35], s41 offen offset:1024 lds
    buffer_load_dwordx4 v8, s[32:35], s41 offen offset:2048 lds
    buffer_load_dwordx4 v8, s[32:35], s41 offen offset:3072 lds
    s_mov_b32 m0, 148480
    s_add_u32 s41, s7, 17408
    buffer_load_dwordx4 v8, s[32:35], s41 offen offset:0 lds
    buffer_load_dwordx4 v8, s[32:35], s41 offen offset:1024 lds
    buffer_load_dwordx4 v8, s[32:35], s41 offen offset:2048 lds
    s_waitcnt vmcnt(26)
gated_mix__softmax_full_mha__glu_gated_glu__prompt_kernel_first_done:
    s_mul_i32 s13, s54, 5120
    s_add_u32 s6, s6, s13
    s_add_u32 s7, s7, s13
    s_lshl_b32 s10, s36, 3
    s_lshr_b32 s41, s37, 2
    s_add_u32 s10, s10, s41
    s_and_b32 s11, s37, 3
    s_mul_i32 s50, s11, 204800
    s_add_u32 s50, s50, 17154048
    s_mul_i32 s41, s10, 110592
    s_add_u32 s41, s41, 7864320
    v_add_u32 v9, s41, v8
    s_mul_i32 s41, s11, 552960
    s_add_u32 s41, s41, 14942208
    v_add_u32 v10, s41, v8
    s_add_u32 s41, s41, 110592
    v_add_u32 v11, s41, v8
    s_add_u32 s41, s41, 110592
    v_add_u32 v12, s41, v8
    s_add_u32 s41, s41, 110592
    v_add_u32 v13, s41, v8
    s_add_u32 s41, s41, 110592
    v_add_u32 v14, s41, v8
    s_mul_i32 s12, s54, 27648
    s_setprio 3
    s_barrier
    s_add_u32 m0, s13, 20480
    s_add_u32 s41, s6, 2641920
    buffer_load_dwordx4 v8, s[32:35], s41 offen offset:0 lds
    buffer_load_dwordx4 v8, s[32:35], s41 offen offset:1024 lds
    buffer_load_dwordx4 v8, s[32:35], s41 offen offset:2048 lds
    buffer_load_dwordx4 v8, s[32:35], s41 offen offset:3072 lds
    s_add_u32 m0, s13, 24576
    s_add_u32 s41, s6, 2646016
    buffer_load_dwordx4 v8, s[32:35], s41 offen offset:0 lds
    s_add_u32 m0, s13, 40960
    s_add_u32 s41, s7, 20480
    buffer_load_dwordx4 v8, s[32:35], s41 offen offset:0 lds
    buffer_load_dwordx4 v8, s[32:35], s41 offen offset:1024 lds
    buffer_load_dwordx4 v8, s[32:35], s41 offen offset:2048 lds
    buffer_load_dwordx4 v8, s[32:35], s41 offen offset:3072 lds
    s_add_u32 m0, s13, 45056
    s_add_u32 s41, s7, 24576
    buffer_load_dwordx4 v8, s[32:35], s41 offen offset:0 lds
    s_waitcnt vmcnt(10)
    s_barrier
    s_waitcnt vmcnt(0)
    s_barrier
    s_cmp_lg_u32 s54, 1
    s_cbranch_scc1 gated_mix__softmax_full_mha__glu_gated_glu__prompt_kernel_nohf
    s_cmp_ge_u32 s37, 30
    s_cbranch_scc1 gated_mix__softmax_full_mha__glu_gated_glu__prompt_kernel_nohf
    s_cmp_lt_u32 s39, 6
    s_cbranch_scc1 gated_mix__softmax_full_mha__glu_gated_glu__prompt_kernel_nohf
    s_lshl_b32 s41, s40, 7
    s_lshl_b32 s42, s39, 2
    s_add_u32 s41, s41, s42
    s_add_u32 s41, s41, 23232488
    v_mov_b32 v2, 0
    v_mov_b32 v3, 1
    s_mov_b64 exec, 1
    buffer_store_dword v3, v2, s[32:35], s41 offen sc1
    s_mov_b64 exec, -1
gated_mix__softmax_full_mha__glu_gated_glu__prompt_kernel_nohf:
    s_add_u32 m0, s13, 61440
    s_add_u32 s41, s6, 2662400
    buffer_load_dwordx4 v8, s[32:35], s41 offen offset:0 lds
    buffer_load_dwordx4 v8, s[32:35], s41 offen offset:1024 lds
    buffer_load_dwordx4 v8, s[32:35], s41 offen offset:2048 lds
    buffer_load_dwordx4 v8, s[32:35], s41 offen offset:3072 lds
    s_add_u32 m0, s13, 65536
    s_add_u32 s41, s6, 2666496
    buffer_load_dwordx4 v8, s[32:35], s41 offen offset:0 lds
    s_add_u32 m0, s13, 81920
    s_add_u32 s41, s7, 40960
    buffer_load_dwordx4 v8, s[32:35], s41 offen offset:0 lds
    buffer_load_dwordx4 v8, s[32:35], s41 offen offset:1024 lds
    buffer_load_dwordx4 v8, s[32:35], s41 offen offset:2048 lds
    buffer_load_dwordx4 v8, s[32:35], s41 offen offset:3072 lds
    s_add_u32 m0, s13, 86016
    s_add_u32 s41, s7, 45056
    buffer_load_dwordx4 v8, s[32:35], s41 offen offset:0 lds
    v_mov_b32 v4, 161796
    s_cmp_lg_u32 s54, 0
    s_cbranch_scc1 gated_mix__softmax_full_mha__glu_gated_glu__prompt_kernel_hwait
    v_min_u32 v2, 8, v1
    v_lshlrev_b32 v2, 2, v2
    s_lshr_b32 s42, s10, 2
    s_lshl_b32 s42, s42, 7
    s_add_u32 s42, s42, 23232512
    s_mov_b32 s48, 0x40000
gated_mix__softmax_full_mha__glu_gated_glu__prompt_kernel_poll2:
    buffer_load_dword v3, v2, s[32:35], s42 offen sc1
    s_waitcnt vmcnt(0)
    v_cmp_ne_u32 vcc, 1, v3
    s_cbranch_vccz gated_mix__softmax_full_mha__glu_gated_glu__prompt_kernel_poll2_ok
    s_sleep 6
    s_sub_u32 s48, s48, 1
    s_cbranch_scc0 gated_mix__softmax_full_mha__glu_gated_glu__prompt_kernel_poll2
gated_mix__softmax_full_mha__glu_gated_glu__prompt_kernel_poll2_ok:
    v_and_b32 v2, 15, v1
    v_lshlrev_b32 v2, 2, v2
    s_lshl_b32 s42, s36, 10
    s_add_u32 s42, s42, 23225088
    s_mov_b32 s48, 0x40000
gated_mix__softmax_full_mha__glu_gated_glu__prompt_kernel_poll2m:
    buffer_load_dword v3, v2, s[32:35], s42 offen sc1
    s_waitcnt vmcnt(0)
    v_cmp_ne_u32 vcc, 1, v3
    s_cbranch_vccz gated_mix__softmax_full_mha__glu_gated_glu__prompt_kernel_poll2m_ok
    s_sleep 6
    s_sub_u32 s48, s48, 1
    s_cbranch_scc0 gated_mix__softmax_full_mha__glu_gated_glu__prompt_kernel_poll2m
gated_mix__softmax_full_mha__glu_gated_glu__prompt_kernel_poll2m_ok:
    v_mov_b32 v3, 1
    ds_write_b32 v4, v3
    s_branch gated_mix__softmax_full_mha__glu_gated_glu__prompt_kernel_hgo
gated_mix__softmax_full_mha__glu_gated_glu__prompt_kernel_hwait:
    s_mov_b32 s48, 0x400000
    s_waitcnt vmcnt(0)
gated_mix__softmax_full_mha__glu_gated_glu__prompt_kernel_hspin:
    ds_read_b32 v3, v4
    s_waitcnt lgkmcnt(0)
    v_cmp_ne_u32 vcc, 1, v3
    s_cbranch_vccz gated_mix__softmax_full_mha__glu_gated_glu__prompt_kernel_hgo
    s_sleep 4
    s_sub_u32 s48, s48, 1
    s_cbranch_scc0 gated_mix__softmax_full_mha__glu_gated_glu__prompt_kernel_hspin
gated_mix__softmax_full_mha__glu_gated_glu__prompt_kernel_hgo:
    buffer_load_dwordx4 v[20:23], v10, s[32:35], s12 offen offset:0
    buffer_load_dwordx4 v[24:27], v11, s[32:35], s12 offen offset:0
    buffer_load_dwordx4 v[28:31], v12, s[32:35], s12 offen offset:0
    buffer_load_dwordx4 v[32:35], v13, s[32:35], s12 offen offset:0
    buffer_load_dwordx4 v[36:39], v14, s[32:35], s12 offen offset:0
    buffer_load_dwordx4 v[16:19], v9, s[32:35], s12 offen offset:0
    buffer_load_dwordx4 v[44:47], v10, s[32:35], s12 offen offset:1024
    buffer_load_dwordx4 v[48:51], v11, s[32:35], s12 offen offset:1024
    buffer_load_dwordx4 v[52:55], v12, s[32:35], s12 offen offset:1024
    buffer_load_dwordx4 v[56:59], v13, s[32:35], s12 offen offset:1024
    buffer_load_dwordx4 v[60:63], v14, s[32:35], s12 offen offset:1024
    buffer_load_dwordx4 v[40:43], v9, s[32:35], s12 offen offset:1024
    buffer_load_dwordx4 v[68:71], v10, s[32:35], s12 offen offset:2048
    buffer_load_dwordx4 v[72:75], v11, s[32:35], s12 offen offset:2048
    buffer_load_dwordx4 v[76:79], v12, s[32:35], s12 offen offset:2048
    buffer_load_dwordx4 v[80:83], v13, s[32:35], s12 offen offset:2048
    buffer_load_dwordx4 v[84:87], v14, s[32:35], s12 offen offset:2048
    buffer_load_dwordx4 v[64:67], v9, s[32:35], s12 offen offset:2048
    s_setprio 0
    s_waitcnt vmcnt(12)
    v_mfma_f32_32x32x16_bf16 v[88:103], v[20:23], v[16:19], 0
    v_mfma_f32_32x32x16_bf16 v[104:119], v[24:27], v[16:19], 0
    v_mfma_f32_32x32x16_bf16 v[120:135], v[28:31], v[16:19], 0
    v_mfma_f32_32x32x16_bf16 v[136:151], v[32:35], v[16:19], 0
    v_mfma_f32_32x32x16_bf16 v[152:167], v[36:39], v[16:19], 0
    buffer_load_dwordx4 v[20:23], v10, s[32:35], s12 offen offset:3072
    buffer_load_dwordx4 v[24:27], v11, s[32:35], s12 offen offset:3072
    buffer_load_dwordx4 v[28:31], v12, s[32:35], s12 offen offset:3072
    buffer_load_dwordx4 v[32:35], v13, s[32:35], s12 offen offset:3072
    buffer_load_dwordx4 v[36:39], v14, s[32:35], s12 offen offset:3072
    buffer_load_dwordx4 v[16:19], v9, s[32:35], s12 offen offset:3072
    s_waitcnt vmcnt(12)
    v_mfma_f32_32x32x16_bf16 v[88:103], v[44:47], v[40:43], v[88:103]
    v_mfma_f32_32x32x16_bf16 v[104:119], v[48:51], v[40:43], v[104:119]
    v_mfma_f32_32x32x16_bf16 v[120:135], v[52:55], v[40:43], v[120:135]
    v_mfma_f32_32x32x16_bf16 v[136:151], v[56:59], v[40:43], v[136:151]
    v_mfma_f32_32x32x16_bf16 v[152:167], v[60:63], v[40:43], v[152:167]
    s_add_u32 s12, s12, 4096
    buffer_load_dwordx4 v[44:47], v10, s[32:35], s12 offen offset:0
    buffer_load_dwordx4 v[48:51], v11, s[32:35], s12 offen offset:0
    buffer_load_dwordx4 v[52:55], v12, s[32:35], s12 offen offset:0
    buffer_load_dwordx4 v[56:59], v13, s[32:35], s12 offen offset:0
    buffer_load_dwordx4 v[60:63], v14, s[32:35], s12 offen offset:0
    buffer_load_dwordx4 v[40:43], v9, s[32:35], s12 offen offset:0
    s_waitcnt vmcnt(12)
    v_mfma_f32_32x32x16_bf16 v[88:103], v[68:71], v[64:67], v[88:103]
    v_mfma_f32_32x32x16_bf16 v[104:119], v[72:75], v[64:67], v[104:119]
    v_mfma_f32_32x32x16_bf16 v[120:135], v[76:79], v[64:67], v[120:135]
    v_mfma_f32_32x32x16_bf16 v[136:151], v[80:83], v[64:67], v[136:151]
    v_mfma_f32_32x32x16_bf16 v[152:167], v[84:87], v[64:67], v[152:167]
    buffer_load_dwordx4 v[68:71], v10, s[32:35], s12 offen offset:1024
    buffer_load_dwordx4 v[72:75], v11, s[32:35], s12 offen offset:1024
    buffer_load_dwordx4 v[76:79], v12, s[32:35], s12 offen offset:1024
    buffer_load_dwordx4 v[80:83], v13, s[32:35], s12 offen offset:1024
    buffer_load_dwordx4 v[84:87], v14, s[32:35], s12 offen offset:1024
    buffer_load_dwordx4 v[64:67], v9, s[32:35], s12 offen offset:1024
    s_waitcnt vmcnt(12)
    v_mfma_f32_32x32x16_bf16 v[88:103], v[20:23], v[16:19], v[88:103]
    v_mfma_f32_32x32x16_bf16 v[104:119], v[24:27], v[16:19], v[104:119]
    v_mfma_f32_32x32x16_bf16 v[120:135], v[28:31], v[16:19], v[120:135]
    v_mfma_f32_32x32x16_bf16 v[136:151], v[32:35], v[16:19], v[136:151]
    v_mfma_f32_32x32x16_bf16 v[152:167], v[36:39], v[16:19], v[152:167]
    buffer_load_dwordx4 v[20:23], v10, s[32:35], s12 offen offset:2048
    buffer_load_dwordx4 v[24:27], v11, s[32:35], s12 offen offset:2048
    buffer_load_dwordx4 v[28:31], v12, s[32:35], s12 offen offset:2048
    buffer_load_dwordx4 v[32:35], v13, s[32:35], s12 offen offset:2048
    buffer_load_dwordx4 v[36:39], v14, s[32:35], s12 offen offset:2048
    buffer_load_dwordx4 v[16:19], v9, s[32:35], s12 offen offset:2048
    s_waitcnt vmcnt(12)
    v_mfma_f32_32x32x16_bf16 v[88:103], v[44:47], v[40:43], v[88:103]
    v_mfma_f32_32x32x16_bf16 v[104:119], v[48:51], v[40:43], v[104:119]
    v_mfma_f32_32x32x16_bf16 v[120:135], v[52:55], v[40:43], v[120:135]
    v_mfma_f32_32x32x16_bf16 v[136:151], v[56:59], v[40:43], v[136:151]
    v_mfma_f32_32x32x16_bf16 v[152:167], v[60:63], v[40:43], v[152:167]
    buffer_load_dwordx4 v[44:47], v10, s[32:35], s12 offen offset:3072
    buffer_load_dwordx4 v[48:51], v11, s[32:35], s12 offen offset:3072
    buffer_load_dwordx4 v[52:55], v12, s[32:35], s12 offen offset:3072
    buffer_load_dwordx4 v[56:59], v13, s[32:35], s12 offen offset:3072
    buffer_load_dwordx4 v[60:63], v14, s[32:35], s12 offen offset:3072
    buffer_load_dwordx4 v[40:43], v9, s[32:35], s12 offen offset:3072
    v_and_b32 v2, 31, v1
    v_min_u32 v2, 8, v2
    v_lshrrev_b32 v3, 5, v1
    v_lshlrev_b32 v3, 5, v3
    v_add_lshl_u32 v2, v2, v3, 2
    s_lshl_b32 s42, s5, 8
    s_add_u32 s42, s42, 23232512
    s_cmp_eq_u32 s54, 0
    s_cselect_b32 s42, s42, 1073741824
    buffer_load_dword v3, v2, s[32:35], s42 offen sc1
    s_waitcnt vmcnt(13)
    v_mfma_f32_32x32x16_bf16 v[88:103], v[68:71], v[64:67], v[88:103]
    v_mfma_f32_32x32x16_bf16 v[104:119], v[72:75], v[64:67], v[104:119]
    v_mfma_f32_32x32x16_bf16 v[120:135], v[76:79], v[64:67], v[120:135]
    v_mfma_f32_32x32x16_bf16 v[136:151], v[80:83], v[64:67], v[136:151]
    v_mfma_f32_32x32x16_bf16 v[152:167], v[84:87], v[64:67], v[152:167]
    s_add_u32 s12, s12, 4096
    buffer_load_dwordx4 v[68:71], v10, s[32:35], s12 offen offset:0
    buffer_load_dwordx4 v[72:75], v11, s[32:35], s12 offen offset:0
    buffer_load_dwordx4 v[76:79], v12, s[32:35], s12 offen offset:0
    buffer_load_dwordx4 v[80:83], v13, s[32:35], s12 offen offset:0
    buffer_load_dwordx4 v[84:87], v14, s[32:35], s12 offen offset:0
    buffer_load_dwordx4 v[64:67], v9, s[32:35], s12 offen offset:0
    s_waitcnt vmcnt(13)
    v_mfma_f32_32x32x16_bf16 v[88:103], v[20:23], v[16:19], v[88:103]
    v_mfma_f32_32x32x16_bf16 v[104:119], v[24:27], v[16:19], v[104:119]
    v_mfma_f32_32x32x16_bf16 v[120:135], v[28:31], v[16:19], v[120:135]
    v_mfma_f32_32x32x16_bf16 v[136:151], v[32:35], v[16:19], v[136:151]
    v_mfma_f32_32x32x16_bf16 v[152:167], v[36:39], v[16:19], v[152:167]
    buffer_load_dwordx4 v[20:23], v10, s[32:35], s12 offen offset:1024
    buffer_load_dwordx4 v[24:27], v11, s[32:35], s12 offen offset:1024
    buffer_load_dwordx4 v[28:31], v12, s[32:35], s12 offen offset:1024
    buffer_load_dwordx4 v[32:35], v13, s[32:35], s12 offen offset:1024
    buffer_load_dwordx4 v[36:39], v14, s[32:35], s12 offen offset:1024
    buffer_load_dwordx4 v[16:19], v9, s[32:35], s12 offen offset:1024
    s_waitcnt vmcnt(13)
    v_mfma_f32_32x32x16_bf16 v[88:103], v[44:47], v[40:43], v[88:103]
    v_mfma_f32_32x32x16_bf16 v[104:119], v[48:51], v[40:43], v[104:119]
    v_mfma_f32_32x32x16_bf16 v[120:135], v[52:55], v[40:43], v[120:135]
    v_mfma_f32_32x32x16_bf16 v[136:151], v[56:59], v[40:43], v[136:151]
    v_mfma_f32_32x32x16_bf16 v[152:167], v[60:63], v[40:43], v[152:167]
    buffer_load_dwordx4 v[44:47], v10, s[32:35], s12 offen offset:2048
    buffer_load_dwordx4 v[48:51], v11, s[32:35], s12 offen offset:2048
    buffer_load_dwordx4 v[52:55], v12, s[32:35], s12 offen offset:2048
    buffer_load_dwordx4 v[56:59], v13, s[32:35], s12 offen offset:2048
    buffer_load_dwordx4 v[60:63], v14, s[32:35], s12 offen offset:2048
    buffer_load_dwordx4 v[40:43], v9, s[32:35], s12 offen offset:2048
    s_waitcnt vmcnt(12)
    v_mfma_f32_32x32x16_bf16 v[88:103], v[68:71], v[64:67], v[88:103]
    v_mfma_f32_32x32x16_bf16 v[104:119], v[72:75], v[64:67], v[104:119]
    v_mfma_f32_32x32x16_bf16 v[120:135], v[76:79], v[64:67], v[120:135]
    v_mfma_f32_32x32x16_bf16 v[136:151], v[80:83], v[64:67], v[136:151]
    v_mfma_f32_32x32x16_bf16 v[152:167], v[84:87], v[64:67], v[152:167]
    buffer_load_dwordx4 v[68:71], v10, s[32:35], s12 offen offset:3072
    buffer_load_dwordx4 v[72:75], v11, s[32:35], s12 offen offset:3072
    buffer_load_dwordx4 v[76:79], v12, s[32:35], s12 offen offset:3072
    buffer_load_dwordx4 v[80:83], v13, s[32:35], s12 offen offset:3072
    buffer_load_dwordx4 v[84:87], v14, s[32:35], s12 offen offset:3072
    buffer_load_dwordx4 v[64:67], v9, s[32:35], s12 offen offset:3072
    s_cmp_lg_u32 s54, 0
    s_cbranch_scc1 gated_mix__softmax_full_mha__glu_gated_glu__prompt_kernel_poll2q_ok
    v_cmp_ne_u32 vcc, 1, v3
    s_cbranch_vccz gated_mix__softmax_full_mha__glu_gated_glu__prompt_kernel_poll2q_ok
    s_mov_b32 s48, 0x40000
gated_mix__softmax_full_mha__glu_gated_glu__prompt_kernel_poll2q:
    buffer_load_dword v3, v2, s[32:35], s42 offen sc1
    s_waitcnt vmcnt(0)
    v_cmp_ne_u32 vcc, 1, v3
    s_cbranch_vccz gated_mix__softmax_full_mha__glu_gated_glu__prompt_kernel_poll2q_ok
    s_sleep 6
    s_sub_u32 s48, s48, 1
    s_cbranch_scc0 gated_mix__softmax_full_mha__glu_gated_glu__prompt_kernel_poll2q
gated_mix__softmax_full_mha__glu_gated_glu__prompt_kernel_poll2q_ok:
    s_barrier
    s_add_u32 m0, s13, 0
    s_add_u32 s41, s6, 2682880
    buffer_load_dwordx4 v8, s[32:35], s41 offen offset:0 lds
    buffer_load_dwordx4 v8, s[32:35], s41 offen offset:1024 lds
    buffer_load_dwordx4 v8, s[32:35], s41 offen offset:2048 lds
    buffer_load_dwordx4 v8, s[32:35], s41 offen offset:3072 lds
    s_add_u32 m0, s13, 4096
    s_add_u32 s41, s6, 2686976
    buffer_load_dwordx4 v8, s[32:35], s41 offen offset:0 lds
    s_add_u32 m0, s13, 131072
    s_add_u32 s41, s7, 61440
    buffer_load_dwordx4 v8, s[32:35], s41 offen offset:0 lds
    buffer_load_dwordx4 v8, s[32:35], s41 offen offset:1024 lds
    buffer_load_dwordx4 v8, s[32:35], s41 offen offset:2048 lds
    buffer_load_dwordx4 v8, s[32:35], s41 offen offset:3072 lds
    s_add_u32 m0, s13, 135168
    s_add_u32 s41, s7, 65536
    buffer_load_dwordx4 v8, s[32:35], s41 offen offset:0 lds
    s_waitcnt vmcnt(22)
    v_mfma_f32_32x32x16_bf16 v[88:103], v[20:23], v[16:19], v[88:103]
    v_mfma_f32_32x32x16_bf16 v[104:119], v[24:27], v[16:19], v[104:119]
    v_mfma_f32_32x32x16_bf16 v[120:135], v[28:31], v[16:19], v[120:135]
    v_mfma_f32_32x32x16_bf16 v[136:151], v[32:35], v[16:19], v[136:151]
    v_mfma_f32_32x32x16_bf16 v[152:167], v[36:39], v[16:19], v[152:167]
    s_add_u32 s12, s12, 4096
    buffer_load_dwordx4 v[20:23], v10, s[32:35], s12 offen offset:0
    buffer_load_dwordx4 v[24:27], v11, s[32:35], s12 offen offset:0
    buffer_load_dwordx4 v[28:31], v12, s[32:35], s12 offen offset:0
    buffer_load_dwordx4 v[32:35], v13, s[32:35], s12 offen offset:0
    buffer_load_dwordx4 v[36:39], v14, s[32:35], s12 offen offset:0
    buffer_load_dwordx4 v[16:19], v9, s[32:35], s12 offen offset:0
    s_waitcnt vmcnt(22)
    v_mfma_f32_32x32x16_bf16 v[88:103], v[44:47], v[40:43], v[88:103]
    v_mfma_f32_32x32x16_bf16 v[104:119], v[48:51], v[40:43], v[104:119]
    v_mfma_f32_32x32x16_bf16 v[120:135], v[52:55], v[40:43], v[120:135]
    v_mfma_f32_32x32x16_bf16 v[136:151], v[56:59], v[40:43], v[136:151]
    v_mfma_f32_32x32x16_bf16 v[152:167], v[60:63], v[40:43], v[152:167]
    buffer_load_dwordx4 v[44:47], v10, s[32:35], s12 offen offset:1024
    buffer_load_dwordx4 v[48:51], v11, s[32:35], s12 offen offset:1024
    buffer_load_dwordx4 v[52:55], v12, s[32:35], s12 offen offset:1024
    buffer_load_dwordx4 v[56:59], v13, s[32:35], s12 offen offset:1024
    buffer_load_dwordx4 v[60:63], v14, s[32:35], s12 offen offset:1024
    buffer_load_dwordx4 v[40:43], v9, s[32:35], s12 offen offset:1024
    s_waitcnt vmcnt(22)
    v_mfma_f32_32x32x16_bf16 v[88:103], v[68:71], v[64:67], v[88:103]
    v_mfma_f32_32x32x16_bf16 v[104:119], v[72:75], v[64:67], v[104:119]
    v_mfma_f32_32x32x16_bf16 v[120:135], v[76:79], v[64:67], v[120:135]
    v_mfma_f32_32x32x16_bf16 v[136:151], v[80:83], v[64:67], v[136:151]
    v_mfma_f32_32x32x16_bf16 v[152:167], v[84:87], v[64:67], v[152:167]
    buffer_load_dwordx4 v[68:71], v10, s[32:35], s12 offen offset:2048
    buffer_load_dwordx4 v[72:75], v11, s[32:35], s12 offen offset:2048
    buffer_load_dwordx4 v[76:79], v12, s[32:35], s12 offen offset:2048
    buffer_load_dwordx4 v[80:83], v13, s[32:35], s12 offen offset:2048
    buffer_load_dwordx4 v[84:87], v14, s[32:35], s12 offen offset:2048
    buffer_load_dwordx4 v[64:67], v9, s[32:35], s12 offen offset:2048
    s_waitcnt vmcnt(12)
    v_mfma_f32_32x32x16_bf16 v[88:103], v[20:23], v[16:19], v[88:103]
    v_mfma_f32_32x32x16_bf16 v[104:119], v[24:27], v[16:19], v[104:119]
    v_mfma_f32_32x32x16_bf16 v[120:135], v[28:31], v[16:19], v[120:135]
    v_mfma_f32_32x32x16_bf16 v[136:151], v[32:35], v[16:19], v[136:151]
    v_mfma_f32_32x32x16_bf16 v[152:167], v[36:39], v[16:19], v[152:167]
    buffer_load_dwordx4 v[20:23], v10, s[32:35], s12 offen offset:3072
    buffer_load_dwordx4 v[24:27], v11, s[32:35], s12 offen offset:3072
    buffer_load_dwordx4 v[28:31], v12, s[32:35], s12 offen offset:3072
    buffer_load_dwordx4 v[32:35], v13, s[32:35], s12 offen offset:3072
    buffer_load_dwordx4 v[36:39], v14, s[32:35], s12 offen offset:3072
    buffer_load_dwordx4 v[16:19], v9, s[32:35], s12 offen offset:3072
    s_waitcnt vmcnt(12)
    v_mfma_f32_32x32x16_bf16 v[88:103], v[44:47], v[40:43], v[88:103]
    v_mfma_f32_32x32x16_bf16 v[104:119], v[48:51], v[40:43], v[104:119]
    v_mfma_f32_32x32x16_bf16 v[120:135], v[52:55], v[40:43], v[120:135]
    v_mfma_f32_32x32x16_bf16 v[136:151], v[56:59], v[40:43], v[136:151]
    v_mfma_f32_32x32x16_bf16 v[152:167], v[60:63], v[40:43], v[152:167]
    s_add_u32 s12, s12, 4096
    buffer_load_dwordx4 v[44:47], v10, s[32:35], s12 offen offset:0
    buffer_load_dwordx4 v[48:51], v11, s[32:35], s12 offen offset:0
    buffer_load_dwordx4 v[52:55], v12, s[32:35], s12 offen offset:0
    buffer_load_dwordx4 v[56:59], v13, s[32:35], s12 offen offset:0
    buffer_load_dwordx4 v[60:63], v14, s[32:35], s12 offen offset:0
    buffer_load_dwordx4 v[40:43], v9, s[32:35], s12 offen offset:0
    s_waitcnt vmcnt(12)
    v_mfma_f32_32x32x16_bf16 v[88:103], v[68:71], v[64:67], v[88:103]
    v_mfma_f32_32x32x16_bf16 v[104:119], v[72:75], v[64:67], v[104:119]
    v_mfma_f32_32x32x16_bf16 v[120:135], v[76:79], v[64:67], v[120:135]
    v_mfma_f32_32x32x16_bf16 v[136:151], v[80:83], v[64:67], v[136:151]
    v_mfma_f32_32x32x16_bf16 v[152:167], v[84:87], v[64:67], v[152:167]
    buffer_load_dwordx4 v[68:71], v10, s[32:35], s12 offen offset:1024
    buffer_load_dwordx4 v[72:75], v11, s[32:35], s12 offen offset:1024
    buffer_load_dwordx4 v[76:79], v12, s[32:35], s12 offen offset:1024
    buffer_load_dwordx4 v[80:83], v13, s[32:35], s12 offen offset:1024
    buffer_load_dwordx4 v[84:87], v14, s[32:35], s12 offen offset:1024
    buffer_load_dwordx4 v[64:67], v9, s[32:35], s12 offen offset:1024
    s_waitcnt vmcnt(12)
    v_mfma_f32_32x32x16_bf16 v[88:103], v[20:23], v[16:19], v[88:103]
    v_mfma_f32_32x32x16_bf16 v[104:119], v[24:27], v[16:19], v[104:119]
    v_mfma_f32_32x32x16_bf16 v[120:135], v[28:31], v[16:19], v[120:135]
    v_mfma_f32_32x32x16_bf16 v[136:151], v[32:35], v[16:19], v[136:151]
    v_mfma_f32_32x32x16_bf16 v[152:167], v[36:39], v[16:19], v[152:167]
    buffer_load_dwordx4 v[20:23], v10, s[32:35], s12 offen offset:2048
    buffer_load_dwordx4 v[24:27], v11, s[32:35], s12 offen offset:2048
    buffer_load_dwordx4 v[28:31], v12, s[32:35], s12 offen offset:2048
    buffer_load_dwordx4 v[32:35], v13, s[32:35], s12 offen offset:2048
    buffer_load_dwordx4 v[36:39], v14, s[32:35], s12 offen offset:2048
    buffer_load_dwordx4 v[16:19], v9, s[32:35], s12 offen offset:2048
    s_waitcnt vmcnt(12)
    v_mfma_f32_32x32x16_bf16 v[88:103], v[44:47], v[40:43], v[88:103]
    v_mfma_f32_32x32x16_bf16 v[104:119], v[48:51], v[40:43], v[104:119]
    v_mfma_f32_32x32x16_bf16 v[120:135], v[52:55], v[40:43], v[120:135]
    v_mfma_f32_32x32x16_bf16 v[136:151], v[56:59], v[40:43], v[136:151]
    v_mfma_f32_32x32x16_bf16 v[152:167], v[60:63], v[40:43], v[152:167]
    buffer_load_dwordx4 v[44:47], v10, s[32:35], s12 offen offset:3072
    buffer_load_dwordx4 v[48:51], v11, s[32:35], s12 offen offset:3072
    buffer_load_dwordx4 v[52:55], v12, s[32:35], s12 offen offset:3072
    buffer_load_dwordx4 v[56:59], v13, s[32:35], s12 offen offset:3072
    buffer_load_dwordx4 v[60:63], v14, s[32:35], s12 offen offset:3072
    buffer_load_dwordx4 v[40:43], v9, s[32:35], s12 offen offset:3072
    s_waitcnt vmcnt(12)
    v_mfma_f32_32x32x16_bf16 v[88:103], v[68:71], v[64:67], v[88:103]
    v_mfma_f32_32x32x16_bf16 v[104:119], v[72:75], v[64:67], v[104:119]
    v_mfma_f32_32x32x16_bf16 v[120:135], v[76:79], v[64:67], v[120:135]
    v_mfma_f32_32x32x16_bf16 v[136:151], v[80:83], v[64:67], v[136:151]
    v_mfma_f32_32x32x16_bf16 v[152:167], v[84:87], v[64:67], v[152:167]
    s_add_u32 s12, s12, 4096
    buffer_load_dwordx4 v[68:71], v10, s[32:35], s12 offen offset:0
    buffer_load_dwordx4 v[72:75], v11, s[32:35], s12 offen offset:0
    buffer_load_dwordx4 v[76:79], v12, s[32:35], s12 offen offset:0
    buffer_load_dwordx4 v[80:83], v13, s[32:35], s12 offen offset:0
    buffer_load_dwordx4 v[84:87], v14, s[32:35], s12 offen offset:0
    buffer_load_dwordx4 v[64:67], v9, s[32:35], s12 offen offset:0
    s_barrier
    s_mul_i32 s43, s54, 3
    s_add_u32 s43, s43, 0
    s_cmp_ge_u32 s43, 10
    s_cselect_b32 s42, 40960, 0
    s_lshl_b32 s44, s43, 12
    s_add_u32 s42, s42, s44
    s_add_u32 m0, s42, 20480
    s_mul_i32 s43, s54, 8192
    s_add_u32 s43, s43, s50
    s_add_u32 s43, s43, 7168
    buffer_load_dwordx4 v8, s[32:35], s43 offen offset:0 lds
    s_add_u32 s43, s43, 39936
    buffer_load_dwordx4 v8, s[32:35], s43 offen offset:1024 lds
    s_add_u32 s43, s43, 39936
    buffer_load_dwordx4 v8, s[32:35], s43 offen offset:2048 lds
    s_add_u32 s43, s43, 39936
    buffer_load_dwordx4 v8, s[32:35], s43 offen offset:3072 lds
    s_mul_i32 s43, s54, 3
    s_add_u32 s43, s43, 1
    s_cmp_ge_u32 s43, 10
    s_cselect_b32 s42, 40960, 0
    s_lshl_b32 s44, s43, 12
    s_add_u32 s42, s42, s44
    s_add_u32 m0, s42, 20480
    s_mul_i32 s43, s54, 2048
    s_add_u32 s43, s43, s50
    s_add_u32 s43, s43, 32768
    buffer_load_dwordx4 v8, s[32:35], s43 offen offset:0 lds
    s_add_u32 s43, s43, 39936
    buffer_load_dwordx4 v8, s[32:35], s43 offen offset:1024 lds
    s_add_u32 s43, s43, 39936
    buffer_load_dwordx4 v8, s[32:35], s43 offen offset:2048 lds
    s_add_u32 s43, s43, 39936
    buffer_load_dwordx4 v8, s[32:35], s43 offen offset:3072 lds
    s_mul_i32 s43, s54, 3
    s_add_u32 s43, s43, 2
    s_cmp_ge_u32 s43, 10
    s_cselect_b32 s42, 40960, 0
    s_lshl_b32 s44, s43, 12
    s_add_u32 s42, s42, s44
    s_add_u32 m0, s42, 20480
    s_mul_i32 s43, s54, 2048
    s_add_u32 s43, s43, s50
    s_add_u32 s43, s43, 33792
    buffer_load_dwordx4 v8, s[32:35], s43 offen offset:0 lds
    s_add_u32 s43, s43, 39936
    buffer_load_dwordx4 v8, s[32:35], s43 offen offset:1024 lds
    s_add_u32 s43, s43, 39936
    buffer_load_dwordx4 v8, s[32:35], s43 offen offset:2048 lds
    s_add_u32 s43, s43, 39936
    buffer_load_dwordx4 v8, s[32:35], s43 offen offset:3072 lds
    s_waitcnt vmcnt(24)
    v_mfma_f32_32x32x16_bf16 v[88:103], v[20:23], v[16:19], v[88:103]
    v_mfma_f32_32x32x16_bf16 v[104:119], v[24:27], v[16:19], v[104:119]
    v_mfma_f32_32x32x16_bf16 v[120:135], v[28:31], v[16:19], v[120:135]
    v_mfma_f32_32x32x16_bf16 v[136:151], v[32:35], v[16:19], v[136:151]
    v_mfma_f32_32x32x16_bf16 v[152:167], v[36:39], v[16:19], v[152:167]
    buffer_load_dwordx4 v[20:23], v10, s[32:35], s12 offen offset:1024
    buffer_load_dwordx4 v[24:27], v11, s[32:35], s12 offen offset:1024
    buffer_load_dwordx4 v[28:31], v12, s[32:35], s12 offen offset:1024
    buffer_load_dwordx4 v[32:35], v13, s[32:35], s12 offen offset:1024
    buffer_load_dwordx4 v[36:39], v14, s[32:35], s12 offen offset:1024
    buffer_load_dwordx4 v[16:19], v9, s[32:35], s12 offen offset:1024
    s_waitcnt vmcnt(24)
    v_mfma_f32_32x32x16_bf16 v[88:103], v[44:47], v[40:43], v[88:103]
    v_mfma_f32_32x32x16_bf16 v[104:119], v[48:51], v[40:43], v[104:119]
    v_mfma_f32_32x32x16_bf16 v[120:135], v[52:55], v[40:43], v[120:135]
    v_mfma_f32_32x32x16_bf16 v[136:151], v[56:59], v[40:43], v[136:151]
    v_mfma_f32_32x32x16_bf16 v[152:167], v[60:63], v[40:43], v[152:167]
    buffer_load_dwordx4 v[44:47], v10, s[32:35], s12 offen offset:2048
    buffer_load_dwordx4 v[48:51], v11, s[32:35], s12 offen offset:2048
    buffer_load_dwordx4 v[52:55], v12, s[32:35], s12 offen offset:2048
    buffer_load_dwordx4 v[56:59], v13, s[32:35], s12 offen offset:2048
    buffer_load_dwordx4 v[60:63], v14, s[32:35], s12 offen offset:2048
    buffer_load_dwordx4 v[40:43], v9, s[32:35], s12 offen offset:2048
    s_waitcnt vmcnt(24)
    v_mfma_f32_32x32x16_bf16 v[88:103], v[68:71], v[64:67], v[88:103]
    v_mfma_f32_32x32x16_bf16 v[104:119], v[72:75], v[64:67], v[104:119]
    v_mfma_f32_32x32x16_bf16 v[120:135], v[76:79], v[64:67], v[120:135]
    v_mfma_f32_32x32x16_bf16 v[136:151], v[80:83], v[64:67], v[136:151]
    v_mfma_f32_32x32x16_bf16 v[152:167], v[84:87], v[64:67], v[152:167]
    buffer_load_dwordx4 v[68:71], v10, s[32:35], s12 offen offset:3072
    buffer_load_dwordx4 v[72:75], v11, s[32:35], s12 offen offset:3072
    buffer_load_dwordx4 v[76:79], v12, s[32:35], s12 offen offset:3072
    buffer_load_dwordx4 v[80:83], v13, s[32:35], s12 offen offset:3072
    buffer_load_dwordx4 v[84:87], v14, s[32:35], s12 offen offset:3072
    buffer_load_dwordx4 v[64:67], v9, s[32:35], s12 offen offset:3072
    s_waitcnt vmcnt(12)
    v_mfma_f32_32x32x16_bf16 v[88:103], v[20:23], v[16:19], v[88:103]
    v_mfma_f32_32x32x16_bf16 v[104:119], v[24:27], v[16:19], v[104:119]
    v_mfma_f32_32x32x16_bf16 v[120:135], v[28:31], v[16:19], v[120:135]
    v_mfma_f32_32x32x16_bf16 v[136:151], v[32:35], v[16:19], v[136:151]
    v_mfma_f32_32x32x16_bf16 v[152:167], v[36:39], v[16:19], v[152:167]
    s_add_u32 s12, s12, 4096
    buffer_load_dwordx4 v[20:23], v10, s[32:35], s12 offen offset:0
    buffer_load_dwordx4 v[24:27], v11, s[32:35], s12 offen offset:0
    buffer_load_dwordx4 v[28:31], v12, s[32:35], s12 offen offset:0
    buffer_load_dwordx4 v[32:35], v13, s[32:35], s12 offen offset:0
    buffer_load_dwordx4 v[36:39], v14, s[32:35], s12 offen offset:0
    buffer_load_dwordx4 v[16:19], v9, s[32:35], s12 offen offset:0
    s_waitcnt vmcnt(12)
    v_mfma_f32_32x32x16_bf16 v[88:103], v[44:47], v[40:43], v[88:103]
    v_mfma_f32_32x32x16_bf16 v[104:119], v[48:51], v[40:43], v[104:119]
    v_mfma_f32_32x32x16_bf16 v[120:135], v[52:55], v[40:43], v[120:135]
    v_mfma_f32_32x32x16_bf16 v[136:151], v[56:59], v[40:43], v[136:151]
    v_mfma_f32_32x32x16_bf16 v[152:167], v[60:63], v[40:43], v[152:167]
    buffer_load_dwordx4 v[44:47], v10, s[32:35], s12 offen offset:1024
    buffer_load_dwordx4 v[48:51], v11, s[32:35], s12 offen offset:1024
    buffer_load_dwordx4 v[52:55], v12, s[32:35], s12 offen offset:1024
    buffer_load_dwordx4 v[56:59], v13, s[32:35], s12 offen offset:1024
    buffer_load_dwordx4 v[60:63], v14, s[32:35], s12 offen offset:1024
    buffer_load_dwordx4 v[40:43], v9, s[32:35], s12 offen offset:1024
    s_barrier
    s_waitcnt vmcnt(12)
    v_mfma_f32_32x32x16_bf16 v[88:103], v[68:71], v[64:67], v[88:103]
    v_mfma_f32_32x32x16_bf16 v[104:119], v[72:75], v[64:67], v[104:119]
    v_mfma_f32_32x32x16_bf16 v[120:135], v[76:79], v[64:67], v[120:135]
    v_mfma_f32_32x32x16_bf16 v[136:151], v[80:83], v[64:67], v[136:151]
    v_mfma_f32_32x32x16_bf16 v[152:167], v[84:87], v[64:67], v[152:167]
    buffer_load_dwordx4 v[68:71], v10, s[32:35], s12 offen offset:2048
    buffer_load_dwordx4 v[72:75], v11, s[32:35], s12 offen offset:2048
    buffer_load_dwordx4 v[76:79], v12, s[32:35], s12 offen offset:2048
    buffer_load_dwordx4 v[80:83], v13, s[32:35], s12 offen offset:2048
    buffer_load_dwordx4 v[84:87], v14, s[32:35], s12 offen offset:2048
    buffer_load_dwordx4 v[64:67], v9, s[32:35], s12 offen offset:2048
    s_waitcnt vmcnt(12)
    v_mfma_f32_32x32x16_bf16 v[88:103], v[20:23], v[16:19], v[88:103]
    v_mfma_f32_32x32x16_bf16 v[104:119], v[24:27], v[16:19], v[104:119]
    v_mfma_f32_32x32x16_bf16 v[120:135], v[28:31], v[16:19], v[120:135]
    v_mfma_f32_32x32x16_bf16 v[136:151], v[32:35], v[16:19], v[136:151]
    v_mfma_f32_32x32x16_bf16 v[152:167], v[36:39], v[16:19], v[152:167]
    s_waitcnt vmcnt(6)
    v_mfma_f32_32x32x16_bf16 v[88:103], v[44:47], v[40:43], v[88:103]
    v_mfma_f32_32x32x16_bf16 v[104:119], v[48:51], v[40:43], v[104:119]
    v_mfma_f32_32x32x16_bf16 v[120:135], v[52:55], v[40:43], v[120:135]
    v_mfma_f32_32x32x16_bf16 v[136:151], v[56:59], v[40:43], v[136:151]
    v_mfma_f32_32x32x16_bf16 v[152:167], v[60:63], v[40:43], v[152:167]
    s_waitcnt vmcnt(0)
    v_mfma_f32_32x32x16_bf16 v[88:103], v[68:71], v[64:67], v[88:103]
    v_mfma_f32_32x32x16_bf16 v[104:119], v[72:75], v[64:67], v[104:119]
    v_mfma_f32_32x32x16_bf16 v[120:135], v[76:79], v[64:67], v[120:135]
    v_mfma_f32_32x32x16_bf16 v[136:151], v[80:83], v[64:67], v[136:151]
    v_mfma_f32_32x32x16_bf16 v[152:167], v[84:87], v[64:67], v[152:167]
    s_setprio 3
    s_mov_b32 s42, 151552
    s_cmp_eq_u32 s54, 1
    s_cselect_b32 s42, 86016, s42
    s_cmp_eq_u32 s54, 2
    s_cselect_b32 s42, 110592, s42
    s_cmp_eq_u32 s54, 3
    s_cselect_b32 s42, 120832, s42
    v_add_u32 v2, s42, v8
    s_nop 3
    v_cvt_pk_bf16_f32 v16, v88, v89
    v_cvt_pk_bf16_f32 v17, v90, v91
    v_cvt_pk_bf16_f32 v18, v92, v93
    v_cvt_pk_bf16_f32 v19, v94, v95
    ds_write_b128 v2, v[16:19] offset:0
    v_cvt_pk_bf16_f32 v20, v96, v97
    v_cvt_pk_bf16_f32 v21, v98, v99
    v_cvt_pk_bf16_f32 v22, v100, v101
    v_cvt_pk_bf16_f32 v23, v102, v103
    ds_write_b128 v2, v[20:23] offset:1024
    v_cvt_pk_bf16_f32 v24, v104, v105
    v_cvt_pk_bf16_f32 v25, v106, v107
    v_cvt_pk_bf16_f32 v26, v108, v109
    v_cvt_pk_bf16_f32 v27, v110, v111
    ds_write_b128 v2, v[24:27] offset:2048
    v_cvt_pk_bf16_f32 v28, v112, v113
    v_cvt_pk_bf16_f32 v29, v114, v115
    v_cvt_pk_bf16_f32 v30, v116, v117
    v_cvt_pk_bf16_f32 v31, v118, v119
    ds_write_b128 v2, v[28:31] offset:3072
    v_cvt_pk_bf16_f32 v32, v120, v121
    v_cvt_pk_bf16_f32 v33, v122, v123
    v_cvt_pk_bf16_f32 v34, v124, v125
    v_cvt_pk_bf16_f32 v35, v126, v127
    ds_write_b128 v2, v[32:35] offset:4096
    v_cvt_pk_bf16_f32 v36, v128, v129
    v_cvt_pk_bf16_f32 v37, v130, v131
    v_cvt_pk_bf16_f32 v38, v132, v133
    v_cvt_pk_bf16_f32 v39, v134, v135
    ds_write_b128 v2, v[36:39] offset:5120
    v_cvt_pk_bf16_f32 v40, v136, v137
    v_cvt_pk_bf16_f32 v41, v138, v139
    v_cvt_pk_bf16_f32 v42, v140, v141
    v_cvt_pk_bf16_f32 v43, v142, v143
    ds_write_b128 v2, v[40:43] offset:6144
    v_cvt_pk_bf16_f32 v44, v144, v145
    v_cvt_pk_bf16_f32 v45, v146, v147
    v_cvt_pk_bf16_f32 v46, v148, v149
    v_cvt_pk_bf16_f32 v47, v150, v151
    ds_write_b128 v2, v[44:47] offset:7168
    v_cvt_pk_bf16_f32 v48, v152, v153
    v_cvt_pk_bf16_f32 v49, v154, v155
    v_cvt_pk_bf16_f32 v50, v156, v157
    v_cvt_pk_bf16_f32 v51, v158, v159
    ds_write_b128 v2, v[48:51] offset:8192
    v_cvt_pk_bf16_f32 v52, v160, v161
    v_cvt_pk_bf16_f32 v53, v162, v163
    v_cvt_pk_bf16_f32 v54, v164, v165
    v_cvt_pk_bf16_f32 v55, v166, v167
    ds_write_b128 v2, v[52:55] offset:9216
    s_waitcnt lgkmcnt(0)
    s_mul_i32 s41, s54, 40960
    s_add_u32 s50, s50, s41
    v_and_b32 v4, 31, v1
    v_lshlrev_b32 v5, 2, v4
    s_lshl_b32 s41, s10, 7
    s_add_u32 s41, s41, 17973248
    buffer_load_dword v7, v5, s[32:35], s41 offen
    v_lshrrev_b32 v6, 5, v1
    v_mul_u32_u24 v10, 1280, v6
    v_lshl_add_u32 v10, v4, 3, v10
    s_mul_i32 s42, s11, 5
    s_add_u32 s42, s42, s54
    s_lshl_b32 s42, s42, 6
    s_mul_i32 s43, s10, 40960
    s_add_u32 s14, s42, s43
    v_mul_u32_u24 v12, 1280, v4
    v_lshl_add_u32 v12, v6, 4, v12
    s_mov_b32 s24, s22
    s_mov_b32 s25, s23
    s_mov_b32 s26, 2621440
    s_mov_b32 s27, 0x00020000
    s_add_u32 s12, s50, 0
    buffer_load_dwordx4 v[56:59], v8, s[32:35], s12 offen offset:0
    buffer_load_dwordx4 v[60:63], v8, s[32:35], s12 offen offset:1024
    buffer_load_dwordx4 v[64:67], v8, s[32:35], s12 offen offset:2048
    buffer_load_dwordx4 v[68:71], v8, s[32:35], s12 offen offset:3072
    s_add_u32 s12, s50, 4096
    buffer_load_dwordx4 v[72:75], v8, s[32:35], s12 offen offset:0
    buffer_load_dwordx4 v[76:79], v8, s[32:35], s12 offen offset:1024
    buffer_load_dwordx4 v[80:83], v8, s[32:35], s12 offen offset:2048
    s_add_u32 s12, s50, 8192
    buffer_load_dwordx4 v[84:87], v8, s[32:35], s12 offen offset:0
    buffer_load_dwordx4 v[88:91], v8, s[32:35], s12 offen offset:1024
    buffer_load_dwordx4 v[92:95], v8, s[32:35], s12 offen offset:2048
    buffer_load_dwordx4 v[96:99], v8, s[32:35], s12 offen offset:3072
    s_add_u32 s12, s50, 12288
    buffer_load_dwordx4 v[100:103], v8, s[32:35], s12 offen offset:0
    buffer_load_dwordx4 v[104:107], v8, s[32:35], s12 offen offset:1024
    buffer_load_dwordx4 v[108:111], v8, s[32:35], s12 offen offset:2048
    s_add_u32 s12, s50, 16384
    buffer_load_dwordx4 v[112:115], v8, s[32:35], s12 offen offset:0
    buffer_load_dwordx4 v[116:119], v8, s[32:35], s12 offen offset:1024
    buffer_load_dwordx4 v[120:123], v8, s[32:35], s12 offen offset:2048
    buffer_load_dwordx4 v[124:127], v8, s[32:35], s12 offen offset:3072
    s_add_u32 s12, s50, 20480
    buffer_load_dwordx4 v[128:131], v8, s[32:35], s12 offen offset:0
    buffer_load_dwordx4 v[132:135], v8, s[32:35], s12 offen offset:1024
    buffer_load_dwordx4 v[136:139], v8, s[32:35], s12 offen offset:2048
    s_add_u32 s12, s50, 24576
    buffer_load_dwordx4 v[140:143], v8, s[32:35], s12 offen offset:0
    buffer_load_dwordx4 v[144:147], v8, s[32:35], s12 offen offset:1024
    buffer_load_dwordx4 v[148:151], v8, s[32:35], s12 offen offset:2048
    buffer_load_dwordx4 v[152:155], v8, s[32:35], s12 offen offset:3072
    s_add_u32 s12, s50, 28672
    buffer_load_dwordx4 v[156:159], v8, s[32:35], s12 offen offset:0
    buffer_load_dwordx4 v[160:163], v8, s[32:35], s12 offen offset:1024
    buffer_load_dwordx4 v[164:167], v8, s[32:35], s12 offen offset:2048
    v_add_u32 v9, 131072, v8
    v_add_u32 v11, 131072, v10
    s_lshl_b32 s41, s54, 10
    v_add_u32 v13, s41, v8
    v_add_u32 v14, 65536, v13
    s_setprio 0
    s_barrier
    s_lshl_b32 s41, s54, 11
    s_add_u32 s41, s41, 65536
    v_add_u32 v5, s41, v8
    v_add_u32 v2, 65536, v5
    ds_read_b128 v[32:35], v2 offset:20480
    ds_read_b128 v[36:39], v2 offset:21504
    ds_read_b128 v[40:43], v5 offset:20480
    ds_read_b128 v[44:47], v5 offset:21504
    s_waitcnt lgkmcnt(0)
    v_lshlrev_b32 v16, 16, v32
    v_and_b32 v17, 0xffff0000, v32
    v_lshlrev_b32 v18, 16, v33
    v_and_b32 v19, 0xffff0000, v33
    v_lshlrev_b32 v20, 16, v34
    v_and_b32 v21, 0xffff0000, v34
    v_lshlrev_b32 v22, 16, v35
    v_and_b32 v23, 0xffff0000, v35
    v_lshlrev_b32 v24, 16, v36
    v_and_b32 v25, 0xffff0000, v36
    v_lshlrev_b32 v26, 16, v37
    v_and_b32 v27, 0xffff0000, v37
    v_lshlrev_b32 v28, 16, v38
    v_and_b32 v29, 0xffff0000, v38
    v_lshlrev_b32 v30, 16, v39
    v_and_b32 v31, 0xffff0000, v39
    v_lshlrev_b32 v3, 16, v40
    v_and_b32 v40, 0xffff0000, v40
    v_add_f32 v16, v16, v3
    v_add_f32 v17, v17, v40
    v_lshlrev_b32 v3, 16, v41
    v_and_b32 v41, 0xffff0000, v41
    v_add_f32 v18, v18, v3
    v_add_f32 v19, v19, v41
    v_lshlrev_b32 v3, 16, v42
    v_and_b32 v42, 0xffff0000, v42
    v_add_f32 v20, v20, v3
    v_add_f32 v21, v21, v42
    v_lshlrev_b32 v3, 16, v43
    v_and_b32 v43, 0xffff0000, v43
    v_add_f32 v22, v22, v3
    v_add_f32 v23, v23, v43
    v_lshlrev_b32 v3, 16, v44
    v_and_b32 v44, 0xffff0000, v44
    v_add_f32 v24, v24, v3
    v_add_f32 v25, v25, v44
    v_lshlrev_b32 v3, 16, v45
    v_and_b32 v45, 0xffff0000, v45
    v_add_f32 v26, v26, v3
    v_add_f32 v27, v27, v45
    v_lshlrev_b32 v3, 16, v46
    v_and_b32 v46, 0xffff0000, v46
    v_add_f32 v28, v28, v3
    v_add_f32 v29, v29, v46
    v_lshlrev_b32 v3, 16, v47
    v_and_b32 v47, 0xffff0000, v47
    v_add_f32 v30, v30, v3
    v_add_f32 v31, v31, v47
    ds_read_b128 v[32:35], v5 offset:45056
    ds_read_b128 v[36:39], v5 offset:46080
    ds_read_b128 v[40:43], v5 offset:55296
    ds_read_b128 v[44:47], v5 offset:56320
    s_waitcnt lgkmcnt(0)
    v_lshlrev_b32 v3, 16, v32
    v_and_b32 v32, 0xffff0000, v32
    v_add_f32 v16, v16, v3
    v_add_f32 v17, v17, v32
    v_lshlrev_b32 v3, 16, v33
    v_and_b32 v33, 0xffff0000, v33
    v_add_f32 v18, v18, v3
    v_add_f32 v19, v19, v33
    v_lshlrev_b32 v3, 16, v34
    v_and_b32 v34, 0xffff0000, v34
    v_add_f32 v20, v20, v3
    v_add_f32 v21, v21, v34
    v_lshlrev_b32 v3, 16, v35
    v_and_b32 v35, 0xffff0000, v35
    v_add_f32 v22, v22, v3
    v_add_f32 v23, v23, v35
    v_lshlrev_b32 v3, 16, v36
    v_and_b32 v36, 0xffff0000, v36
    v_add_f32 v24, v24, v3
    v_add_f32 v25, v25, v36
    v_lshlrev_b32 v3, 16, v37
    v_and_b32 v37, 0xffff0000, v37
    v_add_f32 v26, v26, v3
    v_add_f32 v27, v27, v37
    v_lshlrev_b32 v3, 16, v38
    v_and_b32 v38, 0xffff0000, v38
    v_add_f32 v28, v28, v3
    v_add_f32 v29, v29, v38
    v_lshlrev_b32 v3, 16, v39
    v_and_b32 v39, 0xffff0000, v39
    v_add_f32 v30, v30, v3
    v_add_f32 v31, v31, v39
    v_lshlrev_b32 v3, 16, v40
    v_and_b32 v40, 0xffff0000, v40
    v_add_f32 v16, v16, v3
    v_add_f32 v17, v17, v40
    v_lshlrev_b32 v3, 16, v41
    v_and_b32 v41, 0xffff0000, v41
    v_add_f32 v18, v18, v3
    v_add_f32 v19, v19, v41
    v_lshlrev_b32 v3, 16, v42
    v_and_b32 v42, 0xffff0000, v42
    v_add_f32 v20, v20, v3
    v_add_f32 v21, v21, v42
    v_lshlrev_b32 v3, 16, v43
    v_and_b32 v43, 0xffff0000, v43
    v_add_f32 v22, v22, v3
    v_add_f32 v23, v23, v43
    v_lshlrev_b32 v3, 16, v44
    v_and_b32 v44, 0xffff0000, v44
    v_add_f32 v24, v24, v3
    v_add_f32 v25, v25, v44
    v_lshlrev_b32 v3, 16, v45
    v_and_b32 v45, 0xffff0000, v45
    v_add_f32 v26, v26, v3
    v_add_f32 v27, v27, v45
    v_lshlrev_b32 v3, 16, v46
    v_and_b32 v46, 0xffff0000, v46
    v_add_f32 v28, v28, v3
    v_add_f32 v29, v29, v46
    v_lshlrev_b32 v3, 16, v47
    v_and_b32 v47, 0xffff0000, v47
    v_add_f32 v30, v30, v3
    v_add_f32 v31, v31, v47
    s_waitcnt vmcnt(28)
    v_sub_f32 v7, 1.0, v7
    v_mul_f32 v16, v16, v7
    v_mul_f32 v17, v17, v7
    v_mul_f32 v18, v18, v7
    v_mul_f32 v19, v19, v7
    v_mul_f32 v20, v20, v7
    v_mul_f32 v21, v21, v7
    v_mul_f32 v22, v22, v7
    v_mul_f32 v23, v23, v7
    v_mul_f32 v24, v24, v7
    v_mul_f32 v25, v25, v7
    v_mul_f32 v26, v26, v7
    v_mul_f32 v27, v27, v7
    v_mul_f32 v28, v28, v7
    v_mul_f32 v29, v29, v7
    v_mul_f32 v30, v30, v7
    v_mul_f32 v31, v31, v7
    v_mov_b32 v2, 161808
    s_waitcnt vmcnt(0)
    s_mov_b32 s48, 0x800000
gated_mix__softmax_full_mha__glu_gated_glu__prompt_kernel_os0:
    ds_read_b32 v3, v2
    s_waitcnt lgkmcnt(0)
    v_cmp_ne_u32 vcc, 1, v3
    s_cbranch_vccz gated_mix__softmax_full_mha__glu_gated_glu__prompt_kernel_os0_ok
    s_sleep 1
    s_sub_u32 s48, s48, 1
    s_cbranch_scc0 gated_mix__softmax_full_mha__glu_gated_glu__prompt_kernel_os0
gated_mix__softmax_full_mha__glu_gated_glu__prompt_kernel_os0_ok:
    ds_read_b128 v[32:35], v8 offset:0
    ds_read_b128 v[36:39], v8 offset:1280
    ds_read_b128 v[40:43], v8 offset:2560
    s_waitcnt lgkmcnt(2)
    v_mfma_f32_32x32x16_bf16 v[16:31], v[56:59], v[32:35], v[16:31]
    ds_read_b128 v[44:47], v8 offset:3840
    s_waitcnt lgkmcnt(2)
    v_mfma_f32_32x32x16_bf16 v[16:31], v[60:63], v[36:39], v[16:31]
    ds_read_b128 v[32:35], v8 offset:5120
    s_waitcnt lgkmcnt(2)
    v_mfma_f32_32x32x16_bf16 v[16:31], v[64:67], v[40:43], v[16:31]
    ds_read_b32 v3, v2 offset:4
    ds_read_b128 v[36:39], v8 offset:6400
    s_waitcnt lgkmcnt(3)
    v_mfma_f32_32x32x16_bf16 v[16:31], v[68:71], v[44:47], v[16:31]
    ds_read_b128 v[48:51], v13 offset:20480
    ds_read_b128 v[40:43], v8 offset:7680
    s_waitcnt lgkmcnt(4)
    v_mfma_f32_32x32x16_bf16 v[16:31], v[72:75], v[32:35], v[16:31]
    ds_read_b128 v[52:55], v13 offset:24576
    ds_read_b128 v[44:47], v8 offset:8960
    s_waitcnt lgkmcnt(4)
    v_mfma_f32_32x32x16_bf16 v[16:31], v[76:79], v[36:39], v[16:31]
    ds_read_b64 v[32:33], v10 offset:1024
    ds_read_b64 v[34:35], v10 offset:3584
    s_waitcnt lgkmcnt(4)
    v_mfma_f32_32x32x16_bf16 v[16:31], v[80:83], v[40:43], v[16:31]
    ds_read_b64 v[36:37], v10 offset:6144
    ds_read_b64 v[38:39], v10 offset:8704
    s_waitcnt lgkmcnt(4)
    v_mfma_f32_32x32x16_bf16 v[16:31], v[48:51], v[44:47], v[16:31]
    ds_read_b128 v[48:51], v13 offset:28672
    v_cmp_ne_u32 vcc, 1, v3
    s_cbranch_vccz gated_mix__softmax_full_mha__glu_gated_glu__prompt_kernel_os1_ok
    v_add_u32 v4, 4, v2
    s_mov_b32 s48, 0x800000
gated_mix__softmax_full_mha__glu_gated_glu__prompt_kernel_os1:
    ds_read_b32 v3, v4
    s_waitcnt lgkmcnt(0)
    v_cmp_ne_u32 vcc, 1, v3
    s_cbranch_vccz gated_mix__softmax_full_mha__glu_gated_glu__prompt_kernel_os1_ok
    s_sleep 1
    s_sub_u32 s48, s48, 1
    s_cbranch_scc0 gated_mix__softmax_full_mha__glu_gated_glu__prompt_kernel_os1
gated_mix__softmax_full_mha__glu_gated_glu__prompt_kernel_os1_ok:
    ds_read_b128 v[40:43], v8 offset:10240
    s_waitcnt lgkmcnt(4)
    v_mfma_f32_32x32x16_bf16 v[16:31], v[52:55], v[32:35], v[16:31]
    ds_read_b128 v[44:47], v8 offset:11520
    s_waitcnt lgkmcnt(2)
    v_mfma_f32_32x32x16_bf16 v[16:31], v[48:51], v[36:39], v[16:31]
    ds_read_b128 v[32:35], v8 offset:12800
    s_waitcnt lgkmcnt(2)
    v_mfma_f32_32x32x16_bf16 v[16:31], v[84:87], v[40:43], v[16:31]
    ds_read_b128 v[36:39], v8 offset:14080
    s_waitcnt lgkmcnt(2)
    v_mfma_f32_32x32x16_bf16 v[16:31], v[88:91], v[44:47], v[16:31]
    ds_read_b128 v[40:43], v8 offset:15360
    s_waitcnt lgkmcnt(2)
    v_mfma_f32_32x32x16_bf16 v[16:31], v[92:95], v[32:35], v[16:31]
    ds_read_b32 v3, v2 offset:8
    ds_read_b128 v[44:47], v8 offset:16640
    s_waitcnt lgkmcnt(3)
    v_mfma_f32_32x32x16_bf16 v[16:31], v[96:99], v[36:39], v[16:31]
    ds_read_b128 v[48:51], v13 offset:32768
    ds_read_b128 v[32:35], v8 offset:17920
    s_waitcnt lgkmcnt(4)
    v_mfma_f32_32x32x16_bf16 v[16:31], v[100:103], v[40:43], v[16:31]
    ds_read_b128 v[52:55], v13 offset:36864
    ds_read_b128 v[36:39], v8 offset:19200
    s_waitcnt lgkmcnt(4)
    v_mfma_f32_32x32x16_bf16 v[16:31], v[104:107], v[44:47], v[16:31]
    ds_read_b64 v[40:41], v10 offset:11264
    ds_read_b64 v[42:43], v10 offset:13824
    s_waitcnt lgkmcnt(4)
    v_mfma_f32_32x32x16_bf16 v[16:31], v[108:111], v[32:35], v[16:31]
    ds_read_b64 v[44:45], v10 offset:16384
    ds_read_b64 v[46:47], v10 offset:18944
    s_waitcnt lgkmcnt(4)
    v_mfma_f32_32x32x16_bf16 v[16:31], v[48:51], v[36:39], v[16:31]
    ds_read_b128 v[48:51], v13 offset:40960
    v_cmp_ne_u32 vcc, 1, v3
    s_cbranch_vccz gated_mix__softmax_full_mha__glu_gated_glu__prompt_kernel_os2_ok
    v_add_u32 v4, 8, v2
    s_mov_b32 s48, 0x800000
gated_mix__softmax_full_mha__glu_gated_glu__prompt_kernel_os2:
    ds_read_b32 v3, v4
    s_waitcnt lgkmcnt(0)
    v_cmp_ne_u32 vcc, 1, v3
    s_cbranch_vccz gated_mix__softmax_full_mha__glu_gated_glu__prompt_kernel_os2_ok
    s_sleep 1
    s_sub_u32 s48, s48, 1
    s_cbranch_scc0 gated_mix__softmax_full_mha__glu_gated_glu__prompt_kernel_os2
gated_mix__softmax_full_mha__glu_gated_glu__prompt_kernel_os2_ok:
    ds_read_b128 v[32:35], v9 offset:0
    s_waitcnt lgkmcnt(4)
    v_mfma_f32_32x32x16_bf16 v[16:31], v[52:55], v[40:43], v[16:31]
    ds_read_b128 v[36:39], v9 offset:1280
    s_waitcnt lgkmcnt(2)
    v_mfma_f32_32x32x16_bf16 v[16:31], v[48:51], v[44:47], v[16:31]
    ds_read_b128 v[40:43], v9 offset:2560
    s_waitcnt lgkmcnt(2)
    v_mfma_f32_32x32x16_bf16 v[16:31], v[112:115], v[32:35], v[16:31]
    ds_read_b128 v[44:47], v9 offset:3840
    s_waitcnt lgkmcnt(2)
    v_mfma_f32_32x32x16_bf16 v[16:31], v[116:119], v[36:39], v[16:31]
    ds_read_b128 v[32:35], v9 offset:5120
    s_waitcnt lgkmcnt(2)
    v_mfma_f32_32x32x16_bf16 v[16:31], v[120:123], v[40:43], v[16:31]
    ds_read_b32 v3, v2 offset:12
    ds_read_b128 v[36:39], v9 offset:6400
    s_waitcnt lgkmcnt(3)
    v_mfma_f32_32x32x16_bf16 v[16:31], v[124:127], v[44:47], v[16:31]
    ds_read_b128 v[48:51], v13 offset:45056
    ds_read_b128 v[40:43], v9 offset:7680
    s_waitcnt lgkmcnt(4)
    v_mfma_f32_32x32x16_bf16 v[16:31], v[128:131], v[32:35], v[16:31]
    ds_read_b128 v[52:55], v13 offset:49152
    ds_read_b128 v[44:47], v9 offset:8960
    s_waitcnt lgkmcnt(4)
    v_mfma_f32_32x32x16_bf16 v[16:31], v[132:135], v[36:39], v[16:31]
    ds_read_b64 v[32:33], v11 offset:1024
    ds_read_b64 v[34:35], v11 offset:3584
    s_waitcnt lgkmcnt(4)
    v_mfma_f32_32x32x16_bf16 v[16:31], v[136:139], v[40:43], v[16:31]
    ds_read_b64 v[36:37], v11 offset:6144
    ds_read_b64 v[38:39], v11 offset:8704
    s_waitcnt lgkmcnt(4)
    v_mfma_f32_32x32x16_bf16 v[16:31], v[48:51], v[44:47], v[16:31]
    ds_read_b128 v[48:51], v13 offset:53248
    v_cmp_ne_u32 vcc, 1, v3
    s_cbranch_vccz gated_mix__softmax_full_mha__glu_gated_glu__prompt_kernel_os3_ok
    v_add_u32 v4, 12, v2
    s_mov_b32 s48, 0x800000
gated_mix__softmax_full_mha__glu_gated_glu__prompt_kernel_os3:
    ds_read_b32 v3, v4
    s_waitcnt lgkmcnt(0)
    v_cmp_ne_u32 vcc, 1, v3
    s_cbranch_vccz gated_mix__softmax_full_mha__glu_gated_glu__prompt_kernel_os3_ok
    s_sleep 1
    s_sub_u32 s48, s48, 1
    s_cbranch_scc0 gated_mix__softmax_full_mha__glu_gated_glu__prompt_kernel_os3
gated_mix__softmax_full_mha__glu_gated_glu__prompt_kernel_os3_ok:
    ds_read_b128 v[40:43], v9 offset:10240
    s_waitcnt lgkmcnt(4)
    v_mfma_f32_32x32x16_bf16 v[16:31], v[52:55], v[32:35], v[16:31]
    ds_read_b128 v[44:47], v9 offset:11520
    s_waitcnt lgkmcnt(2)
    v_mfma_f32_32x32x16_bf16 v[16:31], v[48:51], v[36:39], v[16:31]
    ds_read_b128 v[32:35], v9 offset:12800
    s_waitcnt lgkmcnt(2)
    v_mfma_f32_32x32x16_bf16 v[16:31], v[140:143], v[40:43], v[16:31]
    ds_read_b128 v[36:39], v9 offset:14080
    s_waitcnt lgkmcnt(2)
    v_mfma_f32_32x32x16_bf16 v[16:31], v[144:147], v[44:47], v[16:31]
    ds_read_b128 v[40:43], v9 offset:15360
    s_waitcnt lgkmcnt(2)
    v_mfma_f32_32x32x16_bf16 v[16:31], v[148:151], v[32:35], v[16:31]
    ds_read_b128 v[44:47], v9 offset:16640
    s_waitcnt lgkmcnt(2)
    v_mfma_f32_32x32x16_bf16 v[16:31], v[152:155], v[36:39], v[16:31]
    ds_read_b128 v[48:51], v13 offset:57344
    ds_read_b128 v[32:35], v9 offset:17920
    s_waitcnt lgkmcnt(3)
    v_mfma_f32_32x32x16_bf16 v[16:31], v[156:159], v[40:43], v[16:31]
    ds_read_b128 v[52:55], v14 offset:36864
    ds_read_b128 v[36:39], v9 offset:19200
    s_waitcnt lgkmcnt(4)
    v_mfma_f32_32x32x16_bf16 v[16:31], v[160:163], v[44:47], v[16:31]
    ds_read_b64 v[40:41], v11 offset:11264
    ds_read_b64 v[42:43], v11 offset:13824
    s_waitcnt lgkmcnt(4)
    v_mfma_f32_32x32x16_bf16 v[16:31], v[164:167], v[32:35], v[16:31]
    ds_read_b64 v[44:45], v11 offset:16384
    ds_read_b64 v[46:47], v11 offset:18944
    s_waitcnt lgkmcnt(4)
    v_mfma_f32_32x32x16_bf16 v[16:31], v[48:51], v[36:39], v[16:31]
    ds_read_b128 v[48:51], v14 offset:40960
    s_waitcnt lgkmcnt(3)
    v_mfma_f32_32x32x16_bf16 v[16:31], v[52:55], v[40:43], v[16:31]
    s_waitcnt lgkmcnt(0)
    v_mfma_f32_32x32x16_bf16 v[16:31], v[48:51], v[44:47], v[16:31]
    s_nop 11
    v_cvt_pk_bf16_f32 v32, v16, v17
    v_cvt_pk_bf16_f32 v33, v18, v19
    v_cvt_pk_bf16_f32 v34, v20, v21
    v_cvt_pk_bf16_f32 v35, v22, v23
    v_cvt_pk_bf16_f32 v36, v24, v25
    v_cvt_pk_bf16_f32 v37, v26, v27
    v_cvt_pk_bf16_f32 v38, v28, v29
    v_cvt_pk_bf16_f32 v39, v30, v31
    s_nop 1
    v_permlane32_swap_b32 v32, v34
    v_permlane32_swap_b32 v33, v35
    v_permlane32_swap_b32 v36, v38
    v_permlane32_swap_b32 v37, v39
    buffer_store_dwordx4 v[32:35], v12, s[24:27], s14 offen offset:0
    buffer_store_dwordx4 v[36:39], v12, s[24:27], s14 offen offset:32
    s_endpgm
gated_mix__softmax_full_mha__glu_gated_glu__prompt_kernel_end:
    s_endpgm
.section .rodata,"a"
.p2align 6
.amdhsa_kernel gated_mix__softmax_full_mha__glu_gated_glu__prompt_kernel
  .amdhsa_next_free_vgpr 168
  .amdhsa_next_free_sgpr 102
  .amdhsa_accum_offset 168
  .amdhsa_group_segment_fixed_size 0
  .amdhsa_kernarg_size 88
  .amdhsa_user_sgpr_count 2
  .amdhsa_user_sgpr_kernarg_segment_ptr 1
  .amdhsa_system_sgpr_workgroup_id_x 1
.end_amdhsa_kernel
```
